```python
import torch

def _softmax(x, axis=-1):
    return torch.softmax(x, dim=axis)
def _gelu(x):
    return torch.nn.functional.gelu(x, approximate="tanh")
def _silu(x):
    return torch.nn.functional.silu(x)
def _sigmoid(x):
    return torch.sigmoid(x)
def _layernorm(x, axis=-1, eps=1e-5):
    m = x.mean(dim=axis, keepdim=True)
    v = x.var(dim=axis, keepdim=True, unbiased=False)
    return (x - m) / torch.sqrt(v + eps)
def _scatter_add(tgt, idx, src, axis=0):
    return tgt.clone().index_add_(axis, idx, src)
def _segment_sum(src, seg, n):
    out = torch.zeros((n,) + src.shape[1:], dtype=src.dtype)
    return out.index_add_(0, seg, src)
def _pad(x, pw):
    flat = tuple(v for pair in reversed(pw) for v in pair)
    return torch.nn.functional.pad(x, flat)

kernel_name = 'recurrent_scan__sliding_block_cached__moe_arch_mod__prompt'

def setup_inputs():

    _w = (lambda a: (lambda t: t.to(torch.bfloat16) if t.is_floating_point() else t)(torch.as_tensor(a)))
    def _A_setup():
        B, Sq, D = 1, 2048, 448
        Hq, Hkv, Sk, Dh = 16, 8, 2048, 256
        assert Hq % Hkv == 0, (Hq, Hkv)
        return {
            "x": _w((lambda *s: torch.randn(*s, dtype=torch.bfloat16) * 0.05)(B, Sq, D)),
            "k_cache": _w((lambda *s: torch.randn(*s, dtype=torch.bfloat16) * 0.8)(B, Hkv, Sk, Dh)),
            "v_cache": _w((lambda *s: torch.randn(*s, dtype=torch.bfloat16) * 0.2)(B, Hkv, Sk, Dh)),
            "wq": _w((lambda *s: torch.randn(*s, dtype=torch.bfloat16) * 0.8)(D, Hq * Dh) * (D ** -0.5)),
            "wo": _w((lambda *s: torch.randn(*s, dtype=torch.bfloat16) * 0.2)(Hq * Dh, D) * ((Hq * Dh) ** -0.5)),
        }
    _A_in = _A_setup()

    def _B_setup():
        B, S, D, F, C = 1, 2048, 448, 1792, 2
        return {
            "x": _w((lambda *s: torch.randn(*s, dtype=torch.bfloat16) * 0.05)(B, S, D)),
            "w_r": _w((lambda *s: torch.randn(*s, dtype=torch.bfloat16) * 0.2)(D)),
            "w_gate": _w((lambda *s: torch.randn(*s, dtype=torch.bfloat16) * 0.1)(D, F)),
            "w_up": _w((lambda *s: torch.randn(*s, dtype=torch.bfloat16) * 0.1)(D, F)),
            "w_down": _w((lambda *s: torch.randn(*s, dtype=torch.bfloat16) * 0.1)(F, D)),
        }
    _B_in = _B_setup()

    return {
        "A_x": _A_in["x"],
        "A_k_cache": _A_in["k_cache"],
        "A_v_cache": _A_in["v_cache"],
        "A_wq": _A_in["wq"],
        "A_wo": _A_in["wo"],
        "B_x": _B_in["x"],
        "B_w_r": _B_in["w_r"],
        "B_w_gate": _B_in["w_gate"],
        "B_w_up": _B_in["w_up"],
        "B_w_down": _B_in["w_down"],
    }

def reference(A_x, A_k_cache, A_v_cache, A_wq, A_wo, B_x, B_w_r, B_w_gate, B_w_up, B_w_down):
    def _A_ref(x, k_cache, v_cache, wq, wo):
        B, Sq, D = x.shape
        Hq, Dh = 16, 256
        Hkv, Sk = k_cache.shape[1], k_cache.shape[2]
        W = min(4096, max(256, Sk // 4))
        rep = Hq // Hkv
        q = (lambda x, *d: x.permute(*d))((x @ wq).reshape(B, Sq, Hq, Dh), 0, 2, 1, 3)
        k = (lambda x, n, axis: torch.repeat_interleave(x, n, dim=axis))(k_cache[:, :, Sk - W:, :], rep, axis=1)
        v = (lambda x, n, axis: torch.repeat_interleave(x, n, dim=axis))(v_cache[:, :, Sk - W:, :], rep, axis=1)
        scores = torch.einsum("bhqd,bhkd->bhqk", q, k) * (Dh ** -0.5)
        p = _softmax(scores, axis=-1)
        o = torch.einsum("bhqk,bhkd->bhqd", p, v)
        return (lambda x, *d: x.permute(*d))(o, 0, 2, 1, 3).reshape(B, Sq, Hq * Dh) @ wo

    def _B_ref(x, w_r, w_gate, w_up, w_down):
        B, S, D = x.shape
        C = 2
        r = x @ w_r
        idx = torch.argsort(-r, axis=-1)[:, :C]
        idx_e = (lambda x, n, axis: torch.repeat_interleave(x, n, dim=axis))(idx.reshape(B, C, 1), D, axis=2)
        x_sel = (lambda x, i, axis: torch.take_along_dim(x, i, dim=axis))(x, idx_e, axis=1)
        g = _silu(x_sel @ w_gate)
        u = x_sel @ w_up
        y = (g * u) @ w_down
        r_sel = _sigmoid((lambda x, i, axis: torch.take_along_dim(x, i, dim=axis))(r, idx, axis=1))
        y = y * r_sel.reshape(B, C, 1)
        b_off = (torch.arange(B) * S).reshape(B, 1)
        flat_idx = (idx + b_off).reshape(B * C)
        zero = (x * 0.0).reshape(B * S, D)
        upd = _scatter_add(zero, flat_idx, y.reshape(B * C, D), axis=0)
        return x + upd.reshape(B, S, D)

    x = A_x
    xn = _layernorm(x, axis=-1)
    s = _A_ref(xn, A_k_cache, A_v_cache, A_wq, A_wo)
    g = _silu(_B_ref(xn, B_w_r, B_w_gate, B_w_up, B_w_down))
    return x + s * g
```

```asm
; @launch grid=(256,1,1) block=(256,1,1) lds=163840
.amdgcn_target "amdgcn-amd-amdhsa--gfx950"
.text
.globl recurrent_scan__sliding_block_cached__moe_arch_mod__prompt_kernel
.p2align 8
.type recurrent_scan__sliding_block_cached__moe_arch_mod__prompt_kernel,@function
recurrent_scan__sliding_block_cached__moe_arch_mod__prompt_kernel:
s_cmp_ge_u32 s2, 256
s_cbranch_scc1 recurrent_scan__sliding_block_cached__moe_arch_mod__prompt_kernel_exit
s_nop 0
s_load_dwordx16 s[8:23], s[0:1], 0
s_load_dwordx8 s[24:31], s[0:1], 64
s_load_dwordx2 s[32:33], s[0:1], 96
s_memrealtime s[88:89]
s_getpc_b64 s[34:35]
v_lshrrev_b32 v1, 6, v0
v_and_b32 v0, 63, v0
s_lshr_b32 s77, s2, 3
v_lshl_add_u32 v15, s77, 2, v1
v_min_u32 v14, 3, v0
v_mad_u32_u24 v15, v15, 4, v14
v_readfirstlane_b32 s66, v1
v_lshlrev_b32 v15, 7, v15
s_and_b32 s76, s2, 7
global_load_dword a255, v15, s[34:35]
s_lshr_b32 s75, s77, 1
s_and_b32 s64, s76, 6
s_lshl1_add_u32 s65, s64, s75
s_and_b32 s65, s65, 15
s_and_b32 s3, s76, 1
s_lshl4_add_u32 s65, s3, s65
s_and_b32 s78, s77, 1
s_add_u32 s64, s64, s78
s_mul_i32 s79, s75, 14
s_lshr_b32 s79, s79, 3
v_lshrrev_b32 v10, 5, v0
v_and_b32 v11, 31, v0
v_lshl_add_u32 v19, s79, 1, v0
v_subrev_u32 v18, 56, v19
v_min_u32 v19, v19, v18
v_lshlrev_b32 v19, 4, v19
v_add_u32 v18, 16, v19
v_add_u32_e64 v17, 32, v19
v_add_u32 v16, 48, v19
s_lshl_b32 s3, s65, 6
s_lshl_b32 s4, s66, 4
s_add_u32 s3, s3, s4
s_lshl_b32 s5, s78, 3
s_xor_b32 s6, s5, 8
s_add_u32 s7, s3, s5
s_add_u32 s34, s3, s6
s_mul_i32 s7, s7, 896
s_mul_i32 s34, s34, 896
s_add_u32 s5, s5, s4
s_add_u32 s6, s6, s4
s_mul_i32 s69, s5, 912
s_mul_i32 s70, s6, 912
s_add_u32 s69, s69, 17408
s_add_u32 s70, s70, 17408
s_mov_b32 s39, 0x20000
s_mov_b32 s63, 0x20000
s_mov_b32 s38, 1835056
s_mov_b32 s62, 896
s_mov_b32 m0, s69
s_and_b32 s67, s66, 1
s_lshr_b32 s68, s66, 1
s_lshl_b32 s2, s65, 3
s_add_u32 s2, s2, s64
v_lshlrev_b32 v4, 4, v0
v_add_u32 v9, 0x20000, v4
v_mov_b32 v240, 0x3f803f80
v_mov_b32 v241, 0x3f803f80
v_mov_b32 v242, 0x3f803f80
v_mov_b32 v243, 0x3f803f80
v_mov_b32 v244, 0
v_mov_b32 v245, 0
v_mov_b32 v246, 0
v_mov_b32 v247, 0
s_add_u32 s3, s7, 3584
s_mov_b32 exec_hi, 0xffffff
ds_write_b128 v9, v[240:243] offset:30976
ds_write_b128 v9, v[244:247] offset:31872
s_waitcnt lgkmcnt(0)
s_sub_u32 s36, s8, 48
s_subb_u32 s37, s9, 0
s_nop 0
buffer_load_dwordx4 v16, s[36:39], s7 offen offset:0 lds
buffer_load_dwordx4 v17, s[36:39], s7 offen offset:912 lds
buffer_load_dwordx4 v18, s[36:39], s7 offen offset:1824 lds
buffer_load_dwordx4 v19, s[36:39], s7 offen offset:2736 lds
s_add_u32 m0, s69, 3648
s_mov_b32 s60, s20
s_mov_b32 s61, s21
buffer_load_dwordx4 v16, s[36:39], s3 offen offset:0 lds
buffer_load_dwordx4 v17, s[36:39], s3 offen offset:912 lds
buffer_load_dwordx4 v18, s[36:39], s3 offen offset:1824 lds
buffer_load_dwordx4 v19, s[36:39], s3 offen offset:2736 lds
s_mov_b32 m0, 161152
s_nop 0
buffer_load_dwordx4 v19, s[60:63], 0 offen lds
buffer_load_dwordx4 v[244:247], v4, s[60:63], 0 offen
s_mov_b32 exec_hi, -1
s_lshl_b32 s3, s65, 6
s_lshl_b32 s4, s68, 5
s_add_u32 s4, s3, s4
v_add_u32 v12, s4, v11
v_add_u32 v5, 7104, v4
v_add_u32 v6, 14208, v4
v_add_u32 v7, 21312, v4
v_add_u32 v14, s79, v0
v_subrev_u32 v20, 28, v14
v_min_u32_e64 v14, v14, v20
v_lshlrev_b32 v14, 17, v14
s_mul_i32 s71, s66, 4352
s_mul_i32 s72, s66, 4160
s_lshl_b32 s73, s66, 12
s_mov_b32 s43, 0x20000
s_mov_b32 s47, 0x20000
s_mov_b32 s51, 0x20000
s_mov_b32 s55, 0x20000
s_mov_b32 s59, 0x20000
s_mov_b32 s58, 67108864
s_mov_b32 s74, 0xffff0000
s_lshl_b32 s3, s64, 10
s_lshl_b32 s4, s66, 15
s_add_u32 s3, s3, s4
s_sub_u32 s42, 3670016, s3
s_add_u32 s40, s14, s3
s_addc_u32 s41, s15, 0
s_lshl_b32 s4, s64, 20
s_lshl_b32 s5, s66, 11
s_add_u32 s5, s5, s4
s_add_u32 s5, s5, 784848
s_sub_u32 s46, 8388608, s5
s_lshl_b32 s6, s66, 12
s_add_u32 s6, s6, s4
s_add_u32 s6, s6, 784704
s_sub_u32 s50, 8388608, s6
s_add_u32 s44, s10, s5
s_addc_u32 s45, s11, 0
s_add_u32 s48, s12, s6
s_addc_u32 s49, s13, 0
s_add_u32 s56, s32, 0
s_addc_u32 s57, s33, 0
s_lshr_b32 s3, s65, 1
s_and_b32 s3, s3, 6
s_sub_u32 s32, s64, s3
s_sub_u32 s32, s32, 1
s_and_b32 s32, s32, 7
s_lshl_b32 s3, s67, 1
s_lshl2_add_u32 s3, s32, s3
s_sub_u32 s3, s3, s79
s_add_u32 s4, s3, 28
s_min_u32 s3, s3, s4
s_add_u32 s4, s3, 1
s_sub_u32 s5, s3, 27
s_min_u32 s4, s4, s5
s_lshl_b32 s19, s3, 5
s_lshl_b32 s21, s4, 5
s_add_u32 s32, s32, 1
s_and_b32 s3, s65, 1
s_mul_i32 s3, s3, 19
s_lshr_b64 s[88:89], s[88:89], s3
s_lshl_b32 s33, s88, 13
s_or_b32 s33, s33, 1
s_nop 0
s_mul_i32 s3, s64, 458752
s_sub_u32 s54, 3670016, s3
s_add_u32 s52, s16, s3
s_addc_u32 s53, s17, 0
s_and_b32 s0, s75, 15
s_lshl_b32 s0, s0, 14
s_lshl_b32 s1, s75, 2
s_add_u32 s1, s1, s66
s_mul_i32 s1, s1, 7168
v_bfe_u32 v15, v0, 2, 2
v_lshl_add_u32 v15, v10, 3, v15
v_mul_u32_u24 v1, 1088, v15
v_bfe_u32 v15, v0, 4, 1
v_lshl_add_u32 v1, v15, 5, v1
v_and_b32_e64 v20, 1, v0
v_lshl_add_u32 v1, v20, 4, v1
v_bfe_u32 v13, v0, 1, 1
v_lshl_add_u32 v1, v13, 3, v1
s_lshl_b32 s3, s67, 9
v_add_u32 v1, s3, v1
v_add_u32 v2, 0x10000, v1
v_add_u32 v3, 0x20000, v1

v_cmp_eq_u32 vcc, v20, v15
v_sub_u32 v13, 1, v13
v_mov_b32 v20, 2
v_cndmask_b32 v13, v20, v13, vcc
v_mul_u32_u24 v13, 896, v13
v_lshl_add_u32 v13, v10, 4, v13
v_add_u32 v13, 161152, v13
v_cmp_eq_u32 s[4:5], 1, v15
s_mul_i32 s3, s68, 29184
v_mul_u32_u24 v249, 912, v11
v_lshl_add_u32 v249, v10, 4, v249
s_add_u32 s3, s3, 17408
v_add_u32 v249, s3, v249
v_lshlrev_b32 v239, 4, v11
v_lshl_add_u32 v239, v10, 13, v239
v_add_u32 v238, 528, v239
v_add_u32 v237, 1056, v239
v_add_u32 v236, 1584, v239
s_lshl4_add_u32 s77, s78, s75
s_cmp_lt_u32 s77, 4
s_cselect_b32 s62, 0, 56
s_cselect_b32 s14, 0, 1605632
s_max_u32 s3, s77, 4
s_sub_u32 s3, s3, 4
s_lshl_b32 s77, s77, 1
s_add_u32 s77, s77, s68
s_mul_i32 s6, s77, 25088
s_mul_i32 s77, s76, 28
s_add_u32 s77, s77, s3
s_lshl_b32 s77, s77, 4
s_mul_i32 s76, s76, 448
s_and_b32 s76, s76, -128
s_add_u32 s76, s76, s6
s_lshl_b32 s75, s67, 13
s_xor_b32 s75, s75, 0x2000
s_lshl_b32 s78, s66, 10
s_xor_b32 s79, s78, 1024
s_add_u32 s78, s78, 121856
s_add_u32 s79, s79, 121856
s_mul_i32 s7, s65, 196
s_add_u32 s7, s7, s66
s_mul_i32 s7, s7, 2304
v_add_u32 v254, s19, v249
v_add_u32 v255, s21, v249
s_mov_b32 s6, 0x37800000
v_mov_b32_e64 v250, 0
v_accvgpr_write_b32 a227, v12
s_mov_b32 s8, s30
s_mov_b32 s9, s31
s_mov_b32 s10, 256
s_mov_b32 s11, 0x20000
s_mov_b32 s12, s26
s_mov_b32 s13, s27
s_mov_b32 s15, 0x20000
s_and_b32 s3, s65, 7
s_cmp_eq_u32 s3, s64
s_cselect_b32 s16, 0, 2130706432
s_lshl_b32 s3, s65, 3
s_add_u32 s3, s3, s16
s_lshl_b32 s35, s65, 10
s_lshl_b32 s17, s64, 2
s_add_u32 s35, s35, s17
v_lshl_add_u32 v248, s66, 6, v0
v_mov_b32 v12, 2130706432
v_mov_b32 v15, s3
v_cmp_eq_u32 vcc, 0, v248
s_nop 1
v_cndmask_b32_e64 v248, v12, v15, vcc
v_accvgpr_write_b32 a228, v248
v_mov_b32 v15, s35
v_cndmask_b32 v248, v12, v15, vcc
v_accvgpr_write_b32 a229, v248
s_mov_b32 s18, s70
s_add_u32 s3, s34, 3584
s_mov_b32 m0, s18
s_mov_b32 exec_hi, 0xffffff
buffer_load_dwordx4 v16, s[36:39], s34 offen offset:0 lds
buffer_load_dwordx4 v17, s[36:39], s34 offen offset:912 lds
buffer_load_dwordx4 v18, s[36:39], s34 offen offset:1824 lds
buffer_load_dwordx4 v19, s[36:39], s34 offen offset:2736 lds
s_add_u32 m0, s18, 3648
s_nop 0
buffer_load_dwordx4 v16, s[36:39], s3 offen offset:0 lds
buffer_load_dwordx4 v17, s[36:39], s3 offen offset:912 lds
buffer_load_dwordx4 v18, s[36:39], s3 offen offset:1824 lds
buffer_load_dwordx4 v19, s[36:39], s3 offen offset:2736 lds
s_mov_b32 exec_hi, -1
s_waitcnt vmcnt(8)
s_add_u32 m0, s71, 87040
v_readlane_b32 s69, v14, 0
s_nop 4
buffer_load_dwordx4 v4, s[40:43], s69 offen offset:0 lds
v_readlane_b32 s70, v14, 1
ds_read_b128 a[0:3], v13 offset:0
ds_read_b128 a[4:7], v13 offset:32
ds_read_b128 a[8:11], v13 offset:64
buffer_load_dwordx4 v5, s[40:43], s69 offen offset:1088 lds
ds_read_b128 a[12:15], v13 offset:96
ds_read_b128 a[16:19], v13 offset:128
ds_read_b128 a[20:23], v13 offset:160
buffer_load_dwordx4 v6, s[40:43], s69 offen offset:2176 lds
ds_read_b128 a[24:27], v13 offset:192
ds_read_b128 a[28:31], v13 offset:224
ds_read_b128 a[32:35], v13 offset:256
buffer_load_dwordx4 v7, s[40:43], s69 offen offset:3264 lds
ds_read_b128 a[36:39], v13 offset:288
ds_read_b128 a[40:43], v13 offset:320
ds_read_b128 a[44:47], v13 offset:352
s_add_u32 m0, s71, 104448
s_nop 0
s_nop 0
buffer_load_dwordx4 v4, s[40:43], s70 offen offset:0 lds
v_readlane_b32 s69, v14, 2
ds_read_b128 a[48:51], v13 offset:384
ds_read_b128 a[52:55], v13 offset:416
v_dot2_f32_bf16 v250, v244, v240, v250
v_dot2_f32_bf16 v250, v245, v240, v250
v_dot2_f32_bf16 v250, v246, v240, v250
v_dot2_f32_bf16 v250, v247, v240, v250
s_nop 2
v_add_f32_dpp v250, v250, v250 row_shr:1 bound_ctrl:0
s_nop 1
v_add_f32_dpp v250, v250, v250 row_shr:2 bound_ctrl:0
s_nop 1
v_add_f32_dpp v250, v250, v250 row_shr:4 bound_ctrl:0
s_nop 1
v_add_f32_dpp v250, v250, v250 row_shr:8 bound_ctrl:0
s_nop 1
v_add_f32_dpp v250, v250, v250 row_bcast:15 row_mask:0xa
s_nop 1
v_add_f32_dpp v250, v250, v250 row_bcast:31 row_mask:0xc
s_nop 0
v_readlane_b32 s35, v250, 63
s_waitcnt lgkmcnt(1)
ds_read_b128 a[56:59], v13 offset:448
buffer_load_dwordx4 v5, s[40:43], s70 offen offset:1088 lds
ds_read_b128 a[60:63], v13 offset:480
ds_read_b128 a[64:67], v13 offset:512
ds_read_b128 a[68:71], v13 offset:544
buffer_load_dwordx4 v6, s[40:43], s70 offen offset:2176 lds
ds_read_b128 a[72:75], v13 offset:576
ds_read_b128 a[76:79], v13 offset:608
ds_read_b128 a[80:83], v13 offset:640
buffer_load_dwordx4 v7, s[40:43], s70 offen offset:3264 lds
ds_read_b128 a[84:87], v13 offset:672
ds_read_b128 a[88:91], v13 offset:704
ds_read_b128 a[92:95], v13 offset:736
ds_read_b128 a[96:99], v13 offset:768
ds_read_b128 a[100:103], v13 offset:800
ds_read_b128 a[104:107], v13 offset:832
ds_read_b128 a[108:111], v13 offset:864
s_waitcnt vmcnt(8) lgkmcnt(0)
s_barrier
ds_read_b128 v[16:19], v249 offset:0
ds_read_b128 v[20:23], v249 offset:32
ds_read_b128 v[24:27], v249 offset:64
ds_read_b128 v[28:31], v249 offset:96
ds_read_b128 v[32:35], v249 offset:128
ds_read_b128 v[36:39], v249 offset:160
ds_read_b128 v[40:43], v249 offset:192
ds_read_b128 v[44:47], v249 offset:224
ds_read_b128 v[48:51], v249 offset:256
ds_read_b128 v[52:55], v249 offset:288
ds_read_b128 v[56:59], v249 offset:320
ds_read_b128 v[60:63], v249 offset:352
ds_read_b128 v[64:67], v249 offset:384
ds_read_b128 v[68:71], v249 offset:416
s_add_u32 m0, s71, 121856
s_nop 0
s_nop 0
buffer_load_dwordx4 v4, s[40:43], s69 offen offset:0 lds
v_readlane_b32 s70, v14, 3
buffer_load_dwordx4 v5, s[40:43], s69 offen offset:1088 lds
buffer_load_dwordx4 v6, s[40:43], s69 offen offset:2176 lds
buffer_load_dwordx4 v7, s[40:43], s69 offen offset:3264 lds
v_mov_b32 v250, 0
v_mov_b32 v251, 0
v_mov_b32 v252, 0
v_mov_b32 v253, 0
s_waitcnt lgkmcnt(12)
ds_read_b128 v[72:75], v249 offset:448
ds_read_b128 v[76:79], v249 offset:480
v_dot2c_f32_bf16 v250, v16, v16
v_dot2c_f32_bf16 v251, v17, v17
v_dot2c_f32_bf16 v252, v18, v18
v_dot2c_f32_bf16 v253, v19, v19
v_dot2c_f32_bf16 v250, v20, v20
v_dot2c_f32_bf16 v251, v21, v21
v_dot2c_f32_bf16 v252, v22, v22
v_dot2c_f32_bf16 v253, v23, v23
s_waitcnt lgkmcnt(12)
ds_read_b128 v[80:83], v249 offset:512
ds_read_b128 v[84:87], v249 offset:544
v_dot2c_f32_bf16 v250, v24, v24
v_dot2c_f32_bf16 v251, v25, v25
v_dot2c_f32_bf16 v252, v26, v26
v_dot2c_f32_bf16 v253, v27, v27
v_dot2c_f32_bf16 v250, v28, v28
v_dot2c_f32_bf16 v251, v29, v29
v_dot2c_f32_bf16 v252, v30, v30
v_dot2c_f32_bf16 v253, v31, v31
s_waitcnt lgkmcnt(12)
ds_read_b128 v[88:91], v249 offset:576
ds_read_b128 v[92:95], v249 offset:608
v_dot2c_f32_bf16 v250, v32, v32
v_dot2c_f32_bf16 v251, v33, v33
v_dot2c_f32_bf16 v252, v34, v34
v_dot2c_f32_bf16 v253, v35, v35
v_dot2c_f32_bf16 v250, v36, v36
v_dot2c_f32_bf16 v251, v37, v37
v_dot2c_f32_bf16 v252, v38, v38
v_dot2c_f32_bf16 v253, v39, v39
s_waitcnt lgkmcnt(12)
ds_read_b128 v[96:99], v249 offset:640
ds_read_b128 v[100:103], v249 offset:672
v_dot2c_f32_bf16 v250, v40, v40
v_dot2c_f32_bf16 v251, v41, v41
v_dot2c_f32_bf16 v252, v42, v42
v_dot2c_f32_bf16 v253, v43, v43
v_dot2c_f32_bf16 v250, v44, v44
v_dot2c_f32_bf16 v251, v45, v45
v_dot2c_f32_bf16 v252, v46, v46
v_dot2c_f32_bf16 v253, v47, v47
v_mfma_f32_16x16x32_bf16 v[244:247], a[0:3], v[16:19], 0
v_mfma_f32_16x16x32_bf16 v[244:247], a[4:7], v[20:23], v[244:247]
v_mfma_f32_16x16x32_bf16 v[244:247], a[8:11], v[24:27], v[244:247]
v_mfma_f32_16x16x32_bf16 v[244:247], a[12:15], v[28:31], v[244:247]
v_mfma_f32_16x16x32_bf16 v[244:247], a[16:19], v[32:35], v[244:247]
v_mfma_f32_16x16x32_bf16 v[244:247], a[20:23], v[36:39], v[244:247]
v_mfma_f32_16x16x32_bf16 v[244:247], a[24:27], v[40:43], v[244:247]
v_mfma_f32_16x16x32_bf16 v[244:247], a[28:31], v[44:47], v[244:247]
s_waitcnt lgkmcnt(12)
s_nop 0
ds_read_b128 v[104:107], v249 offset:704
ds_read_b128 v[108:111], v249 offset:736
v_dot2c_f32_bf16 v250, v48, v48
v_dot2c_f32_bf16 v251, v49, v49
v_dot2c_f32_bf16 v252, v50, v50
v_dot2c_f32_bf16 v253, v51, v51
v_dot2c_f32_bf16 v250, v52, v52
v_dot2c_f32_bf16 v251, v53, v53
v_dot2c_f32_bf16 v252, v54, v54
v_dot2c_f32_bf16 v253, v55, v55
s_waitcnt lgkmcnt(12)
ds_read_b128 v[112:115], v249 offset:768
ds_read_b128 v[116:119], v249 offset:800
v_dot2c_f32_bf16 v250, v56, v56
v_dot2c_f32_bf16 v251, v57, v57
v_dot2c_f32_bf16 v252, v58, v58
v_dot2c_f32_bf16 v253, v59, v59
v_dot2c_f32_bf16 v250, v60, v60
v_dot2c_f32_bf16 v251, v61, v61
v_dot2c_f32_bf16 v252, v62, v62
v_dot2c_f32_bf16 v253, v63, v63
s_waitcnt lgkmcnt(12)
ds_read_b128 v[120:123], v249 offset:832
ds_read_b128 v[124:127], v249 offset:864
ds_read_b128 a[240:243], v254
ds_read_b128 a[244:247], v255
v_dot2c_f32_bf16 v250, v64, v64
v_dot2c_f32_bf16 v251, v65, v65
v_dot2c_f32_bf16 v252, v66, v66
v_dot2c_f32_bf16 v253, v67, v67
v_dot2c_f32_bf16 v250, v68, v68
v_dot2c_f32_bf16 v251, v69, v69
v_dot2c_f32_bf16 v252, v70, v70
v_dot2c_f32_bf16 v253, v71, v71
s_waitcnt lgkmcnt(14)
v_dot2c_f32_bf16 v250, v72, v72
v_dot2c_f32_bf16 v251, v73, v73
v_dot2c_f32_bf16 v252, v74, v74
v_dot2c_f32_bf16 v253, v75, v75
v_dot2c_f32_bf16 v250, v76, v76
v_dot2c_f32_bf16 v251, v77, v77
v_dot2c_f32_bf16 v252, v78, v78
v_dot2c_f32_bf16 v253, v79, v79
v_mfma_f32_16x16x32_bf16 v[244:247], a[32:35], v[48:51], v[244:247]
s_add_u32 m0, s71, 139264
s_nop 0
buffer_load_dwordx4 v4, s[40:43], s70 offen offset:0 lds
v_readlane_b32 s69, v14, 4
v_mfma_f32_16x16x32_bf16 v[244:247], a[36:39], v[52:55], v[244:247]
buffer_load_dwordx4 v5, s[40:43], s70 offen offset:1088 lds
v_mfma_f32_16x16x32_bf16 v[244:247], a[40:43], v[56:59], v[244:247]
buffer_load_dwordx4 v6, s[40:43], s70 offen offset:2176 lds
v_mfma_f32_16x16x32_bf16 v[244:247], a[44:47], v[60:63], v[244:247]
buffer_load_dwordx4 v7, s[40:43], s70 offen offset:3264 lds
v_mfma_f32_16x16x32_bf16 v[244:247], a[48:51], v[64:67], v[244:247]
v_mfma_f32_16x16x32_bf16 v[244:247], a[52:55], v[68:71], v[244:247]
v_mfma_f32_16x16x32_bf16 v[244:247], a[56:59], v[72:75], v[244:247]
v_mfma_f32_16x16x32_bf16 v[244:247], a[60:63], v[76:79], v[244:247]
s_waitcnt lgkmcnt(12)
v_dot2c_f32_bf16 v250, v80, v80
v_dot2c_f32_bf16 v251, v81, v81
v_dot2c_f32_bf16 v252, v82, v82
v_dot2c_f32_bf16 v253, v83, v83
v_dot2c_f32_bf16 v250, v84, v84
v_dot2c_f32_bf16 v251, v85, v85
v_dot2c_f32_bf16 v252, v86, v86
v_dot2c_f32_bf16 v253, v87, v87
s_waitcnt lgkmcnt(10)
v_dot2c_f32_bf16 v250, v88, v88
v_dot2c_f32_bf16 v251, v89, v89
v_dot2c_f32_bf16 v252, v90, v90
v_dot2c_f32_bf16 v253, v91, v91
v_dot2c_f32_bf16 v250, v92, v92
v_dot2c_f32_bf16 v251, v93, v93
v_dot2c_f32_bf16 v252, v94, v94
v_dot2c_f32_bf16 v253, v95, v95
s_waitcnt lgkmcnt(8)
v_dot2c_f32_bf16 v250, v96, v96
v_dot2c_f32_bf16 v251, v97, v97
v_dot2c_f32_bf16 v252, v98, v98
v_dot2c_f32_bf16 v253, v99, v99
v_dot2c_f32_bf16 v250, v100, v100
v_dot2c_f32_bf16 v251, v101, v101
v_dot2c_f32_bf16 v252, v102, v102
v_dot2c_f32_bf16 v253, v103, v103
s_waitcnt lgkmcnt(6)
v_dot2c_f32_bf16 v250, v104, v104
v_dot2c_f32_bf16 v251, v105, v105
v_dot2c_f32_bf16 v252, v106, v106
v_dot2c_f32_bf16 v253, v107, v107
v_dot2c_f32_bf16 v250, v108, v108
v_dot2c_f32_bf16 v251, v109, v109
v_dot2c_f32_bf16 v252, v110, v110
v_dot2c_f32_bf16 v253, v111, v111
v_mfma_f32_16x16x32_bf16 v[244:247], a[64:67], v[80:83], v[244:247]
v_mfma_f32_16x16x32_bf16 v[244:247], a[68:71], v[84:87], v[244:247]
v_mfma_f32_16x16x32_bf16 v[244:247], a[72:75], v[88:91], v[244:247]
v_mfma_f32_16x16x32_bf16 v[244:247], a[76:79], v[92:95], v[244:247]
v_mfma_f32_16x16x32_bf16 v[244:247], a[80:83], v[96:99], v[244:247]
v_mfma_f32_16x16x32_bf16 v[244:247], a[84:87], v[100:103], v[244:247]
v_mfma_f32_16x16x32_bf16 v[244:247], a[88:91], v[104:107], v[244:247]
v_mfma_f32_16x16x32_bf16 v[244:247], a[92:95], v[108:111], v[244:247]
s_waitcnt lgkmcnt(4)
v_dot2c_f32_bf16 v250, v112, v112
v_dot2c_f32_bf16 v251, v113, v113
v_dot2c_f32_bf16 v252, v114, v114
v_dot2c_f32_bf16 v253, v115, v115
v_dot2c_f32_bf16 v250, v116, v116
v_dot2c_f32_bf16 v251, v117, v117
v_dot2c_f32_bf16 v252, v118, v118
v_dot2c_f32_bf16 v253, v119, v119
s_waitcnt lgkmcnt(2)
v_dot2c_f32_bf16 v250, v120, v120
v_dot2c_f32_bf16 v251, v121, v121
v_dot2c_f32_bf16 v252, v122, v122
v_dot2c_f32_bf16 v253, v123, v123
v_dot2c_f32_bf16 v250, v124, v124
v_dot2c_f32_bf16 v251, v125, v125
v_dot2c_f32_bf16 v252, v126, v126
v_dot2c_f32_bf16 v253, v127, v127
v_mfma_f32_16x16x32_bf16 v[244:247], a[96:99], v[112:115], v[244:247]
v_mfma_f32_16x16x32_bf16 v[244:247], a[100:103], v[116:119], v[244:247]
v_mfma_f32_16x16x32_bf16 v[244:247], a[104:107], v[120:123], v[244:247]
v_mfma_f32_16x16x32_bf16 v[244:247], a[108:111], v[124:127], v[244:247]
s_add_u32 m0, s71, 0
s_nop 0
buffer_load_dwordx4 v4, s[40:43], s69 offen offset:0 lds
buffer_load_dwordx4 v5, s[40:43], s69 offen offset:1088 lds
buffer_load_dwordx4 v6, s[40:43], s69 offen offset:2176 lds
buffer_load_dwordx4 v7, s[40:43], s69 offen offset:3264 lds
s_waitcnt lgkmcnt(0)
v_add_f32 v250, v250, v251
v_add_f32 v252, v252, v253
v_add_f32 v251, v250, v252
v_cndmask_b32 v250, v244, v245, s[4:5]
v_mov_b32_e64 v241, v251
v_cndmask_b32 v252, v246, v247, s[4:5]
v_mul_f32 v250, 0x3b124925, v250
v_permlane32_swap_b32 v251, v241
v_add_f32 v251, v251, v241
v_mul_f32 v251, 0x3b124925, v251
v_fma_f32 v251, -v250, v250, v251
v_max_f32_e64 v251, 0, v251
v_cvt_pk_bf16_f32 v240, v250, v251
v_and_b32_e64 v251, s74, v240
v_add_f32 v251, 0x3727c5ac, v251
v_cvt_pk_bf16_f32 v251, v251, v251
v_and_b32 v251, s74, v251
v_sqrt_f32 v251, v251
v_lshlrev_b32_e64 v250, 16, v240
v_cvt_pk_bf16_f32 v251, v251, v251
v_and_b32 v251, s74, v251
v_rcp_f32 v241, v251
v_accvgpr_write_b32 a224, v250
v_mul_f32 v8, 0x3db8aa3b, v241
v_mul_f32_e64 v9, v250, v8
v_accvgpr_write_b32 a225, v251
v_accvgpr_write_b32 a226, v252
s_waitcnt vmcnt(12)
s_barrier
ds_read_b64_tr_b16 a[128:129], v2 offset:21504
ds_read_b64_tr_b16 a[130:131], v2 offset:25856
v_readlane_b32 s70, v14, 5
v_lshlrev_b32 v10, 16, v16
v_and_b32 v11, s74, v16
v_fma_f32 v10, v10, v8, -v9
v_fma_f32 v11, v11, v8, -v9
v_cvt_pk_bf16_f32 v16, v10, v11
v_lshlrev_b32 v12, 16, v17
v_and_b32 v13, s74, v17
v_fma_f32 v12, v12, v8, -v9
ds_read_b64_tr_b16 a[132:133], v2 offset:21568
ds_read_b64_tr_b16 a[134:135], v2 offset:25920
v_fma_f32 v13, v13, v8, -v9
v_cvt_pk_bf16_f32 v17, v12, v13
v_lshlrev_b32 v10, 16, v18
v_and_b32 v11, s74, v18
v_fma_f32 v10, v10, v8, -v9
v_fma_f32 v11, v11, v8, -v9
v_cvt_pk_bf16_f32 v18, v10, v11
v_lshlrev_b32_e64 v12, 16, v19
s_add_u32 m0, s71, 17408
ds_read_b64_tr_b16 a[136:137], v2 offset:21632
ds_read_b64_tr_b16 a[138:139], v2 offset:25984
buffer_load_dwordx4 v4, s[40:43], s70 offen offset:0 lds
v_and_b32_e64 v13, s74, v19
v_fma_f32 v12, v12, v8, -v9
v_fma_f32 v13, v13, v8, -v9
v_cvt_pk_bf16_f32 v19, v12, v13
v_lshlrev_b32 v10, 16, v20
v_and_b32 v11, s74, v20
v_fma_f32 v10, v10, v8, -v9
v_fma_f32 v11, v11, v8, -v9
ds_read_b64_tr_b16 a[140:141], v2 offset:21696
ds_read_b64_tr_b16 a[142:143], v2 offset:26048
v_cvt_pk_bf16_f32 v20, v10, v11
v_lshlrev_b32 v12, 16, v21
v_and_b32 v13, s74, v21
v_fma_f32 v12, v12, v8, -v9
v_fma_f32 v13, v13, v8, -v9
v_cvt_pk_bf16_f32 v21, v12, v13
v_lshlrev_b32 v10, 16, v22
v_and_b32 v11, s74, v22
ds_read_b64_tr_b16 a[144:145], v2 offset:21760
ds_read_b64_tr_b16 a[146:147], v2 offset:26112
buffer_load_dwordx4 v5, s[40:43], s70 offen offset:1088 lds
v_fma_f32 v10, v10, v8, -v9
v_fma_f32 v11, v11, v8, -v9
v_cvt_pk_bf16_f32 v22, v10, v11
v_lshlrev_b32 v12, 16, v23
v_and_b32 v13, s74, v23
v_fma_f32 v12, v12, v8, -v9
v_fma_f32 v13, v13, v8, -v9
v_cvt_pk_bf16_f32 v23, v12, v13
s_waitcnt lgkmcnt(6)
ds_read_b64_tr_b16 a[148:149], v2 offset:21824
ds_read_b64_tr_b16 a[150:151], v2 offset:26176
buffer_load_dwordx4 v6, s[40:43], s70 offen offset:2176 lds
v_lshlrev_b32 v10, 16, v24
v_and_b32_e64 v11, s74, v24
v_mfma_f32_32x32x16_bf16 v[128:143], a[128:131], v[16:19], 0
ds_read_b64_tr_b16 a[152:153], v2 offset:21888
ds_read_b64_tr_b16 a[154:155], v2 offset:26240
v_fma_f32 v10, v10, v8, -v9
v_fma_f32 v11, v11, v8, -v9
v_cvt_pk_bf16_f32 v24, v10, v11
v_lshlrev_b32 v12, 16, v25
v_mfma_f32_32x32x16_bf16 v[144:159], a[132:135], v[16:19], 0
s_waitcnt lgkmcnt(6)
ds_read_b64_tr_b16 a[156:157], v2 offset:21952
ds_read_b64_tr_b16 a[158:159], v2 offset:26304
buffer_load_dwordx4 v7, s[40:43], s70 offen offset:3264 lds
v_and_b32_e64 v13, s74, v25
v_fma_f32 v12, v12, v8, -v9
v_mfma_f32_32x32x16_bf16 v[160:175], a[136:139], v[16:19], 0
v_readlane_b32 s69, v14, 6
ds_read_b64_tr_b16 a[128:129], v2 offset:38912
ds_read_b64_tr_b16 a[130:131], v2 offset:43264
s_add_u32 m0, s71, 34816
v_fma_f32 v13, v13, v8, -v9
v_cvt_pk_bf16_f32 v25, v12, v13
v_lshlrev_b32 v10, 16, v26
v_mfma_f32_32x32x16_bf16 v[176:191], a[140:143], v[16:19], 0
s_waitcnt lgkmcnt(6)
ds_read_b64_tr_b16 a[132:133], v2 offset:38976
ds_read_b64_tr_b16 a[134:135], v2 offset:43328
buffer_load_dwordx4 v4, s[40:43], s69 offen offset:0 lds
v_and_b32_e64 v11, s74, v26
v_fma_f32 v10, v10, v8, -v9
v_mfma_f32_32x32x16_bf16 v[192:207], a[144:147], v[16:19], 0
ds_read_b64_tr_b16 a[136:137], v2 offset:39040
ds_read_b64_tr_b16 a[138:139], v2 offset:43392
v_fma_f32 v11, v11, v8, -v9
v_cvt_pk_bf16_f32 v26, v10, v11
v_lshlrev_b32_e64 v12, 16, v27
v_and_b32 v13, s74, v27
v_mfma_f32_32x32x16_bf16 v[208:223], a[148:151], v[16:19], 0
s_waitcnt lgkmcnt(6)
ds_read_b64_tr_b16 a[140:141], v2 offset:39104
ds_read_b64_tr_b16 a[142:143], v2 offset:43456
buffer_load_dwordx4 v5, s[40:43], s69 offen offset:1088 lds
v_fma_f32 v12, v12, v8, -v9
v_fma_f32 v13, v13, v8, -v9
v_cvt_pk_bf16_f32 v27, v12, v13
v_mfma_f32_32x32x16_bf16 v[224:239], a[152:155], v[16:19], 0
ds_read_b64_tr_b16 a[144:145], v2 offset:39168
ds_read_b64_tr_b16 a[146:147], v2 offset:43520
v_lshlrev_b32_e64 v10, 16, v28
v_and_b32 v11, s74, v28
v_fma_f32 v10, v10, v8, -v9
v_fma_f32 v11, v11, v8, -v9
v_mfma_f32_32x32x16_bf16 v[240:255], a[156:159], v[16:19], 0
s_waitcnt lgkmcnt(6)
ds_read_b64_tr_b16 a[148:149], v2 offset:39232
ds_read_b64_tr_b16 a[150:151], v2 offset:43584
buffer_load_dwordx4 v6, s[40:43], s69 offen offset:2176 lds
v_cvt_pk_bf16_f32 v28, v10, v11
v_lshlrev_b32_e64 v12, 16, v29
v_mfma_f32_32x32x16_bf16 v[128:143], a[128:131], v[20:23], v[128:143]
v_readlane_b32 s70, v14, 7
ds_read_b64_tr_b16 a[152:153], v2 offset:39296
ds_read_b64_tr_b16 a[154:155], v2 offset:43648
v_and_b32_e64 v13, s74, v29
v_fma_f32 v12, v12, v8, -v9
v_fma_f32 v13, v13, v8, -v9
v_cvt_pk_bf16_f32 v29, v12, v13
v_mfma_f32_32x32x16_bf16 v[144:159], a[132:135], v[20:23], v[144:159]
s_waitcnt lgkmcnt(8)
ds_read_b64_tr_b16 a[156:157], v2 offset:39360
ds_read_b64_tr_b16 a[158:159], v2 offset:43712
buffer_load_dwordx4 v7, s[40:43], s69 offen offset:3264 lds
v_lshlrev_b32 v10, 16, v30
v_and_b32_e64 v11, s74, v30
v_mfma_f32_32x32x16_bf16 v[160:175], a[136:139], v[20:23], v[160:175]
s_waitcnt vmcnt(12) lgkmcnt(8)
s_barrier
ds_read_b64_tr_b16 a[128:129], v2 offset:56320
ds_read_b64_tr_b16 a[130:131], v2 offset:60672
s_add_u32 m0, s71, 52224
v_mfma_f32_32x32x16_bf16 v[176:191], a[140:143], v[20:23], v[176:191]
s_waitcnt lgkmcnt(6)
s_nop 0
ds_read_b64_tr_b16 a[132:133], v2 offset:56384
ds_read_b64_tr_b16 a[134:135], v2 offset:60736
buffer_load_dwordx4 v4, s[40:43], s70 offen offset:0 lds
v_fma_f32 v10, v10, v8, -v9
v_fma_f32 v11, v11, v8, -v9
v_mfma_f32_32x32x16_bf16 v[192:207], a[144:147], v[20:23], v[192:207]
ds_read_b64_tr_b16 a[136:137], v2 offset:56448
ds_read_b64_tr_b16 a[138:139], v2 offset:60800
v_cvt_pk_bf16_f32 v30, v10, v11
v_lshlrev_b32_e64 v12, 16, v31
v_and_b32 v13, s74, v31
v_fma_f32 v12, v12, v8, -v9
v_mfma_f32_32x32x16_bf16 v[208:223], a[148:151], v[20:23], v[208:223]
s_waitcnt lgkmcnt(6)
ds_read_b64_tr_b16 a[140:141], v2 offset:56512
ds_read_b64_tr_b16 a[142:143], v2 offset:60864
buffer_load_dwordx4 v5, s[40:43], s70 offen offset:1088 lds
v_fma_f32 v13, v13, v8, -v9
v_cvt_pk_bf16_f32 v31, v12, v13
v_mfma_f32_32x32x16_bf16 v[224:239], a[152:155], v[20:23], v[224:239]
ds_read_b64_tr_b16 a[144:145], v2 offset:56576
ds_read_b64_tr_b16 a[146:147], v2 offset:60928
v_lshlrev_b32_e64 v10, 16, v32
v_and_b32 v11, s74, v32
v_fma_f32 v10, v10, v8, -v9
v_fma_f32 v11, v11, v8, -v9
v_mfma_f32_32x32x16_bf16 v[240:255], a[156:159], v[20:23], v[240:255]
s_waitcnt lgkmcnt(6)
ds_read_b64_tr_b16 a[148:149], v2 offset:56640
ds_read_b64_tr_b16 a[150:151], v2 offset:60992
buffer_load_dwordx4 v6, s[40:43], s70 offen offset:2176 lds
v_cvt_pk_bf16_f32 v32, v10, v11
v_lshlrev_b32_e64 v12, 16, v33
v_mfma_f32_32x32x16_bf16 v[128:143], a[128:131], v[24:27], v[128:143]
ds_read_b64_tr_b16 a[152:153], v2 offset:56704
ds_read_b64_tr_b16 a[154:155], v2 offset:61056
v_and_b32 v13, s74, v33
v_fma_f32 v12, v12, v8, -v9
v_fma_f32 v13, v13, v8, -v9
v_mfma_f32_32x32x16_bf16 v[144:159], a[132:135], v[24:27], v[144:159]
s_waitcnt lgkmcnt(6)
ds_read_b64_tr_b16 a[156:157], v2 offset:56768
ds_read_b64_tr_b16 a[158:159], v2 offset:61120
buffer_load_dwordx4 v7, s[40:43], s70 offen offset:3264 lds
v_cvt_pk_bf16_f32 v33, v12, v13
v_lshlrev_b32_e64 v10, 16, v34
v_mfma_f32_32x32x16_bf16 v[160:175], a[136:139], v[24:27], v[160:175]
v_readlane_b32 s69, v14, 8
ds_read_b64_tr_b16 a[128:129], v3 offset:8192
ds_read_b64_tr_b16 a[130:131], v3 offset:12544
s_add_u32 m0, s71, 69632
v_and_b32 v11, s74, v34
v_fma_f32 v10, v10, v8, -v9
v_fma_f32 v11, v11, v8, -v9
v_mfma_f32_32x32x16_bf16 v[176:191], a[140:143], v[24:27], v[176:191]
s_waitcnt lgkmcnt(6)
ds_read_b64_tr_b16 a[132:133], v3 offset:8256
ds_read_b64_tr_b16 a[134:135], v3 offset:12608
buffer_load_dwordx4 v4, s[40:43], s69 offen offset:0 lds
v_cvt_pk_bf16_f32 v34, v10, v11
v_lshlrev_b32_e64 v12, 16, v35
v_mfma_f32_32x32x16_bf16 v[192:207], a[144:147], v[24:27], v[192:207]
ds_read_b64_tr_b16 a[136:137], v3 offset:8320
ds_read_b64_tr_b16 a[138:139], v3 offset:12672
v_and_b32_e64 v13, s74, v35
v_fma_f32 v12, v12, v8, -v9
v_fma_f32 v13, v13, v8, -v9
v_cvt_pk_bf16_f32 v35, v12, v13
v_mfma_f32_32x32x16_bf16 v[208:223], a[148:151], v[24:27], v[208:223]
s_waitcnt lgkmcnt(6)
ds_read_b64_tr_b16 a[140:141], v3 offset:8384
ds_read_b64_tr_b16 a[142:143], v3 offset:12736
buffer_load_dwordx4 v5, s[40:43], s69 offen offset:1088 lds
v_lshlrev_b32 v10, 16, v36
v_mfma_f32_32x32x16_bf16 v[224:239], a[152:155], v[24:27], v[224:239]
ds_read_b64_tr_b16 a[144:145], v3 offset:8448
ds_read_b64_tr_b16 a[146:147], v3 offset:12800
v_and_b32_e64 v11, s74, v36
v_fma_f32 v10, v10, v8, -v9
v_fma_f32 v11, v11, v8, -v9
v_cvt_pk_bf16_f32 v36, v10, v11
v_mfma_f32_32x32x16_bf16 v[240:255], a[156:159], v[24:27], v[240:255]
s_waitcnt lgkmcnt(6)
ds_read_b64_tr_b16 a[148:149], v3 offset:8512
ds_read_b64_tr_b16 a[150:151], v3 offset:12864
buffer_load_dwordx4 v6, s[40:43], s69 offen offset:2176 lds
v_lshlrev_b32 v12, 16, v37
v_and_b32_e64 v13, s74, v37
v_mfma_f32_32x32x16_bf16 v[128:143], a[128:131], v[28:31], v[128:143]
v_readlane_b32 s70, v14, 9
ds_read_b64_tr_b16 a[152:153], v3 offset:8576
ds_read_b64_tr_b16 a[154:155], v3 offset:12928
v_fma_f32 v12, v12, v8, -v9
v_fma_f32 v13, v13, v8, -v9
v_cvt_pk_bf16_f32 v37, v12, v13
v_lshlrev_b32 v10, 16, v38
v_mfma_f32_32x32x16_bf16 v[144:159], a[132:135], v[28:31], v[144:159]
s_waitcnt lgkmcnt(8)
ds_read_b64_tr_b16 a[156:157], v3 offset:8640
ds_read_b64_tr_b16 a[158:159], v3 offset:12992
buffer_load_dwordx4 v7, s[40:43], s69 offen offset:3264 lds
v_and_b32_e64 v11, s74, v38
v_fma_f32 v10, v10, v8, -v9
v_mfma_f32_32x32x16_bf16 v[160:175], a[136:139], v[28:31], v[160:175]
s_waitcnt vmcnt(12) lgkmcnt(8)
s_barrier
ds_read_b64_tr_b16 a[128:129], v1 offset:0
ds_read_b64_tr_b16 a[130:131], v1 offset:4352
s_add_u32 m0, s71, 87040
v_mfma_f32_32x32x16_bf16 v[176:191], a[140:143], v[28:31], v[176:191]
s_waitcnt lgkmcnt(6)
s_nop 0
ds_read_b64_tr_b16 a[132:133], v1 offset:64
ds_read_b64_tr_b16 a[134:135], v1 offset:4416
buffer_load_dwordx4 v4, s[40:43], s70 offen offset:0 lds
v_fma_f32 v11, v11, v8, -v9
v_mfma_f32_32x32x16_bf16 v[192:207], a[144:147], v[28:31], v[192:207]
ds_read_b64_tr_b16 a[136:137], v1 offset:128
ds_read_b64_tr_b16 a[138:139], v1 offset:4480
v_cvt_pk_bf16_f32 v38, v10, v11
v_lshlrev_b32_e64 v12, 16, v39
v_and_b32 v13, s74, v39
v_fma_f32 v12, v12, v8, -v9
v_mfma_f32_32x32x16_bf16 v[208:223], a[148:151], v[28:31], v[208:223]
s_waitcnt lgkmcnt(6)
ds_read_b64_tr_b16 a[140:141], v1 offset:192
ds_read_b64_tr_b16 a[142:143], v1 offset:4544
buffer_load_dwordx4 v5, s[40:43], s70 offen offset:1088 lds
v_fma_f32 v13, v13, v8, -v9
v_cvt_pk_bf16_f32 v39, v12, v13
v_mfma_f32_32x32x16_bf16 v[224:239], a[152:155], v[28:31], v[224:239]
ds_read_b64_tr_b16 a[144:145], v1 offset:256
ds_read_b64_tr_b16 a[146:147], v1 offset:4608
v_lshlrev_b32_e64 v10, 16, v40
v_and_b32 v11, s74, v40
v_fma_f32 v10, v10, v8, -v9
v_fma_f32 v11, v11, v8, -v9
v_mfma_f32_32x32x16_bf16 v[240:255], a[156:159], v[28:31], v[240:255]
s_waitcnt lgkmcnt(6)
ds_read_b64_tr_b16 a[148:149], v1 offset:320
ds_read_b64_tr_b16 a[150:151], v1 offset:4672
buffer_load_dwordx4 v6, s[40:43], s70 offen offset:2176 lds
v_cvt_pk_bf16_f32 v40, v10, v11
v_lshlrev_b32_e64 v12, 16, v41
v_mfma_f32_32x32x16_bf16 v[128:143], a[128:131], v[32:35], v[128:143]
ds_read_b64_tr_b16 a[152:153], v1 offset:384
ds_read_b64_tr_b16 a[154:155], v1 offset:4736
v_and_b32 v13, s74, v41
v_fma_f32 v12, v12, v8, -v9
v_fma_f32 v13, v13, v8, -v9
v_mfma_f32_32x32x16_bf16 v[144:159], a[132:135], v[32:35], v[144:159]
s_waitcnt lgkmcnt(6)
ds_read_b64_tr_b16 a[156:157], v1 offset:448
ds_read_b64_tr_b16 a[158:159], v1 offset:4800
buffer_load_dwordx4 v7, s[40:43], s70 offen offset:3264 lds
v_cvt_pk_bf16_f32 v41, v12, v13
v_lshlrev_b32_e64 v10, 16, v42
v_mfma_f32_32x32x16_bf16 v[160:175], a[136:139], v[32:35], v[160:175]
v_readlane_b32 s69, v14, 10
ds_read_b64_tr_b16 a[128:129], v1 offset:17408
ds_read_b64_tr_b16 a[130:131], v1 offset:21760
s_add_u32 m0, s71, 104448
v_and_b32 v11, s74, v42
v_fma_f32 v10, v10, v8, -v9
v_fma_f32 v11, v11, v8, -v9
v_mfma_f32_32x32x16_bf16 v[176:191], a[140:143], v[32:35], v[176:191]
s_waitcnt lgkmcnt(6)
ds_read_b64_tr_b16 a[132:133], v1 offset:17472
ds_read_b64_tr_b16 a[134:135], v1 offset:21824
buffer_load_dwordx4 v4, s[40:43], s69 offen offset:0 lds
v_cvt_pk_bf16_f32 v42, v10, v11
v_lshlrev_b32_e64 v12, 16, v43
v_mfma_f32_32x32x16_bf16 v[192:207], a[144:147], v[32:35], v[192:207]
ds_read_b64_tr_b16 a[136:137], v1 offset:17536
ds_read_b64_tr_b16 a[138:139], v1 offset:21888
v_and_b32_e64 v13, s74, v43
v_fma_f32 v12, v12, v8, -v9
v_fma_f32 v13, v13, v8, -v9
v_cvt_pk_bf16_f32 v43, v12, v13
v_mfma_f32_32x32x16_bf16 v[208:223], a[148:151], v[32:35], v[208:223]
s_waitcnt lgkmcnt(6)
ds_read_b64_tr_b16 a[140:141], v1 offset:17600
ds_read_b64_tr_b16 a[142:143], v1 offset:21952
buffer_load_dwordx4 v5, s[40:43], s69 offen offset:1088 lds
v_lshlrev_b32 v10, 16, v44
v_mfma_f32_32x32x16_bf16 v[224:239], a[152:155], v[32:35], v[224:239]
ds_read_b64_tr_b16 a[144:145], v1 offset:17664
ds_read_b64_tr_b16 a[146:147], v1 offset:22016
v_and_b32_e64 v11, s74, v44
v_fma_f32 v10, v10, v8, -v9
v_fma_f32 v11, v11, v8, -v9
v_cvt_pk_bf16_f32 v44, v10, v11
v_mfma_f32_32x32x16_bf16 v[240:255], a[156:159], v[32:35], v[240:255]
s_waitcnt lgkmcnt(6)
ds_read_b64_tr_b16 a[148:149], v1 offset:17728
ds_read_b64_tr_b16 a[150:151], v1 offset:22080
buffer_load_dwordx4 v6, s[40:43], s69 offen offset:2176 lds
v_lshlrev_b32 v12, 16, v45
v_and_b32_e64 v13, s74, v45
v_mfma_f32_32x32x16_bf16 v[128:143], a[128:131], v[36:39], v[128:143]
v_readlane_b32 s70, v14, 11
ds_read_b64_tr_b16 a[152:153], v1 offset:17792
ds_read_b64_tr_b16 a[154:155], v1 offset:22144
v_fma_f32 v12, v12, v8, -v9
v_fma_f32 v13, v13, v8, -v9
v_cvt_pk_bf16_f32 v45, v12, v13
v_lshlrev_b32 v10, 16, v46
v_mfma_f32_32x32x16_bf16 v[144:159], a[132:135], v[36:39], v[144:159]
s_waitcnt lgkmcnt(8)
ds_read_b64_tr_b16 a[156:157], v1 offset:17856
ds_read_b64_tr_b16 a[158:159], v1 offset:22208
buffer_load_dwordx4 v7, s[40:43], s69 offen offset:3264 lds
v_and_b32_e64 v11, s74, v46
v_fma_f32 v10, v10, v8, -v9
v_mfma_f32_32x32x16_bf16 v[160:175], a[136:139], v[36:39], v[160:175]
s_waitcnt vmcnt(12) lgkmcnt(8)
s_barrier
ds_read_b64_tr_b16 a[128:129], v1 offset:34816
ds_read_b64_tr_b16 a[130:131], v1 offset:39168
s_add_u32 m0, s71, 121856
v_mfma_f32_32x32x16_bf16 v[176:191], a[140:143], v[36:39], v[176:191]
s_waitcnt lgkmcnt(6)
s_nop 0
ds_read_b64_tr_b16 a[132:133], v1 offset:34880
ds_read_b64_tr_b16 a[134:135], v1 offset:39232
buffer_load_dwordx4 v4, s[40:43], s70 offen offset:0 lds
v_fma_f32 v11, v11, v8, -v9
v_mfma_f32_32x32x16_bf16 v[192:207], a[144:147], v[36:39], v[192:207]
ds_read_b64_tr_b16 a[136:137], v1 offset:34944
ds_read_b64_tr_b16 a[138:139], v1 offset:39296
v_cvt_pk_bf16_f32 v46, v10, v11
v_lshlrev_b32_e64 v12, 16, v47
v_and_b32 v13, s74, v47
v_fma_f32 v12, v12, v8, -v9
v_mfma_f32_32x32x16_bf16 v[208:223], a[148:151], v[36:39], v[208:223]
s_waitcnt lgkmcnt(6)
ds_read_b64_tr_b16 a[140:141], v1 offset:35008
ds_read_b64_tr_b16 a[142:143], v1 offset:39360
buffer_load_dwordx4 v5, s[40:43], s70 offen offset:1088 lds
v_fma_f32 v13, v13, v8, -v9
v_cvt_pk_bf16_f32 v47, v12, v13
v_mfma_f32_32x32x16_bf16 v[224:239], a[152:155], v[36:39], v[224:239]
ds_read_b64_tr_b16 a[144:145], v1 offset:35072
ds_read_b64_tr_b16 a[146:147], v1 offset:39424
v_lshlrev_b32_e64 v10, 16, v48
v_and_b32 v11, s74, v48
v_fma_f32 v10, v10, v8, -v9
v_fma_f32 v11, v11, v8, -v9
v_mfma_f32_32x32x16_bf16 v[240:255], a[156:159], v[36:39], v[240:255]
s_waitcnt lgkmcnt(6)
ds_read_b64_tr_b16 a[148:149], v1 offset:35136
ds_read_b64_tr_b16 a[150:151], v1 offset:39488
buffer_load_dwordx4 v6, s[40:43], s70 offen offset:2176 lds
v_cvt_pk_bf16_f32 v48, v10, v11
v_lshlrev_b32_e64 v12, 16, v49
v_mfma_f32_32x32x16_bf16 v[128:143], a[128:131], v[40:43], v[128:143]
ds_read_b64_tr_b16 a[152:153], v1 offset:35200
ds_read_b64_tr_b16 a[154:155], v1 offset:39552
v_and_b32_e64 v13, s74, v49
v_fma_f32 v12, v12, v8, -v9
v_fma_f32 v13, v13, v8, -v9
v_cvt_pk_bf16_f32 v49, v12, v13
v_lshlrev_b32 v10, 16, v50
v_mfma_f32_32x32x16_bf16 v[144:159], a[132:135], v[40:43], v[144:159]
s_waitcnt lgkmcnt(6)
ds_read_b64_tr_b16 a[156:157], v1 offset:35264
ds_read_b64_tr_b16 a[158:159], v1 offset:39616
buffer_load_dwordx4 v7, s[40:43], s70 offen offset:3264 lds
v_and_b32_e64 v11, s74, v50
v_fma_f32 v10, v10, v8, -v9
v_mfma_f32_32x32x16_bf16 v[160:175], a[136:139], v[40:43], v[160:175]
v_readlane_b32 s69, v14, 12
ds_read_b64_tr_b16 a[128:129], v1 offset:52224
ds_read_b64_tr_b16 a[130:131], v1 offset:56576
s_add_u32 m0, s71, 139264
v_fma_f32 v11, v11, v8, -v9
v_cvt_pk_bf16_f32 v50, v10, v11
v_lshlrev_b32 v12, 16, v51
v_mfma_f32_32x32x16_bf16 v[176:191], a[140:143], v[40:43], v[176:191]
s_waitcnt lgkmcnt(6)
ds_read_b64_tr_b16 a[132:133], v1 offset:52288
ds_read_b64_tr_b16 a[134:135], v1 offset:56640
buffer_load_dwordx4 v4, s[40:43], s69 offen offset:0 lds
v_and_b32_e64 v13, s74, v51
v_fma_f32 v12, v12, v8, -v9
v_mfma_f32_32x32x16_bf16 v[192:207], a[144:147], v[40:43], v[192:207]
ds_read_b64_tr_b16 a[136:137], v1 offset:52352
ds_read_b64_tr_b16 a[138:139], v1 offset:56704
v_fma_f32 v13, v13, v8, -v9
v_cvt_pk_bf16_f32 v51, v12, v13
v_lshlrev_b32_e64 v10, 16, v52
v_and_b32 v11, s74, v52
v_mfma_f32_32x32x16_bf16 v[208:223], a[148:151], v[40:43], v[208:223]
s_waitcnt lgkmcnt(6)
ds_read_b64_tr_b16 a[140:141], v1 offset:52416
ds_read_b64_tr_b16 a[142:143], v1 offset:56768
buffer_load_dwordx4 v5, s[40:43], s69 offen offset:1088 lds
v_fma_f32 v10, v10, v8, -v9
v_fma_f32 v11, v11, v8, -v9
v_cvt_pk_bf16_f32 v52, v10, v11
v_mfma_f32_32x32x16_bf16 v[224:239], a[152:155], v[40:43], v[224:239]
ds_read_b64_tr_b16 a[144:145], v1 offset:52480
ds_read_b64_tr_b16 a[146:147], v1 offset:56832
v_lshlrev_b32_e64 v12, 16, v53
v_and_b32 v13, s74, v53
v_fma_f32 v12, v12, v8, -v9
v_fma_f32 v13, v13, v8, -v9
v_mfma_f32_32x32x16_bf16 v[240:255], a[156:159], v[40:43], v[240:255]
s_waitcnt lgkmcnt(6)
ds_read_b64_tr_b16 a[148:149], v1 offset:52544
ds_read_b64_tr_b16 a[150:151], v1 offset:56896
buffer_load_dwordx4 v6, s[40:43], s69 offen offset:2176 lds
v_cvt_pk_bf16_f32 v53, v12, v13
v_lshlrev_b32_e64 v10, 16, v54
v_mfma_f32_32x32x16_bf16 v[128:143], a[128:131], v[44:47], v[128:143]
v_readlane_b32 s70, v14, 13
ds_read_b64_tr_b16 a[152:153], v1 offset:52608
ds_read_b64_tr_b16 a[154:155], v1 offset:56960
v_and_b32_e64 v11, s74, v54
v_fma_f32 v10, v10, v8, -v9
v_fma_f32 v11, v11, v8, -v9
v_cvt_pk_bf16_f32 v54, v10, v11
v_mfma_f32_32x32x16_bf16 v[144:159], a[132:135], v[44:47], v[144:159]
s_waitcnt lgkmcnt(8)
ds_read_b64_tr_b16 a[156:157], v1 offset:52672
ds_read_b64_tr_b16 a[158:159], v1 offset:57024
buffer_load_dwordx4 v7, s[40:43], s69 offen offset:3264 lds
v_lshlrev_b32 v12, 16, v55
v_and_b32_e64 v13, s74, v55
v_mfma_f32_32x32x16_bf16 v[160:175], a[136:139], v[44:47], v[160:175]
s_waitcnt vmcnt(12) lgkmcnt(8)
s_barrier
ds_read_b64_tr_b16 a[128:129], v2 offset:4096
ds_read_b64_tr_b16 a[130:131], v2 offset:8448
s_add_u32 m0, s71, 0
v_mfma_f32_32x32x16_bf16 v[176:191], a[140:143], v[44:47], v[176:191]
s_waitcnt lgkmcnt(6)
ds_read_b64_tr_b16 a[132:133], v2 offset:4160
ds_read_b64_tr_b16 a[134:135], v2 offset:8512
buffer_load_dwordx4 v4, s[40:43], s70 offen offset:0 lds
v_fma_f32 v12, v12, v8, -v9
v_fma_f32 v13, v13, v8, -v9
v_cvt_pk_bf16_f32 v55, v12, v13
v_mfma_f32_32x32x16_bf16 v[192:207], a[144:147], v[44:47], v[192:207]
ds_read_b64_tr_b16 a[136:137], v2 offset:4224
ds_read_b64_tr_b16 a[138:139], v2 offset:8576
v_and_b32 v15, 31, v0
v_lshlrev_b32 v15, 4, v15
v_lshrrev_b32 v30, 5, v0
v_lshl_add_u32 v19, v30, 13, v15
v_mfma_f32_32x32x16_bf16 v[208:223], a[148:151], v[44:47], v[208:223]
s_waitcnt lgkmcnt(6)
ds_read_b64_tr_b16 a[140:141], v2 offset:4288
ds_read_b64_tr_b16 a[142:143], v2 offset:8640
buffer_load_dwordx4 v5, s[40:43], s70 offen offset:1088 lds
v_add_u32 v18, 528, v19
v_add_u32 v17, 1056, v19
v_mfma_f32_32x32x16_bf16 v[224:239], a[152:155], v[44:47], v[224:239]
ds_read_b64_tr_b16 a[144:145], v2 offset:4352
ds_read_b64_tr_b16 a[146:147], v2 offset:8704
v_lshlrev_b32_e64 v10, 16, v56
v_and_b32 v11, s74, v56
v_fma_f32 v10, v10, v8, -v9
v_fma_f32 v11, v11, v8, -v9
v_mfma_f32_32x32x16_bf16 v[240:255], a[156:159], v[44:47], v[240:255]
s_waitcnt lgkmcnt(6)
ds_read_b64_tr_b16 a[148:149], v2 offset:4416
ds_read_b64_tr_b16 a[150:151], v2 offset:8768
buffer_load_dwordx4 v6, s[40:43], s70 offen offset:2176 lds
v_cvt_pk_bf16_f32 v56, v10, v11
v_lshlrev_b32_e64 v12, 16, v57
v_mfma_f32_32x32x16_bf16 v[128:143], a[128:131], v[48:51], v[128:143]
ds_read_b64_tr_b16 a[152:153], v2 offset:4480
ds_read_b64_tr_b16 a[154:155], v2 offset:8832
v_and_b32_e64 v13, s74, v57
v_fma_f32 v12, v12, v8, -v9
v_fma_f32 v13, v13, v8, -v9
v_cvt_pk_bf16_f32 v57, v12, v13
v_lshlrev_b32 v10, 16, v58
v_mfma_f32_32x32x16_bf16 v[144:159], a[132:135], v[48:51], v[144:159]
s_waitcnt lgkmcnt(6)
ds_read_b64_tr_b16 a[156:157], v2 offset:4544
ds_read_b64_tr_b16 a[158:159], v2 offset:8896
buffer_load_dwordx4 v7, s[40:43], s70 offen offset:3264 lds
v_and_b32_e64 v11, s74, v58
v_fma_f32 v10, v10, v8, -v9
v_mfma_f32_32x32x16_bf16 v[160:175], a[136:139], v[48:51], v[160:175]
v_readlane_b32 s69, v14, 14
ds_read_b64_tr_b16 a[128:129], v2 offset:21504
ds_read_b64_tr_b16 a[130:131], v2 offset:25856
s_add_u32 m0, s71, 17408
v_fma_f32 v11, v11, v8, -v9
v_cvt_pk_bf16_f32 v58, v10, v11
v_lshlrev_b32 v12, 16, v59
v_mfma_f32_32x32x16_bf16 v[176:191], a[140:143], v[48:51], v[176:191]
s_waitcnt lgkmcnt(6)
ds_read_b64_tr_b16 a[132:133], v2 offset:21568
ds_read_b64_tr_b16 a[134:135], v2 offset:25920
buffer_load_dwordx4 v4, s[40:43], s69 offen offset:0 lds
v_and_b32_e64 v13, s74, v59
v_fma_f32 v12, v12, v8, -v9
v_mfma_f32_32x32x16_bf16 v[192:207], a[144:147], v[48:51], v[192:207]
ds_read_b64_tr_b16 a[136:137], v2 offset:21632
ds_read_b64_tr_b16 a[138:139], v2 offset:25984
v_fma_f32 v13, v13, v8, -v9
v_cvt_pk_bf16_f32 v59, v12, v13
v_lshlrev_b32_e64 v10, 16, v60
v_and_b32 v11, s74, v60
v_mfma_f32_32x32x16_bf16 v[208:223], a[148:151], v[48:51], v[208:223]
s_waitcnt lgkmcnt(6)
ds_read_b64_tr_b16 a[140:141], v2 offset:21696
ds_read_b64_tr_b16 a[142:143], v2 offset:26048
buffer_load_dwordx4 v5, s[40:43], s69 offen offset:1088 lds
v_fma_f32 v10, v10, v8, -v9
v_fma_f32 v11, v11, v8, -v9
v_cvt_pk_bf16_f32 v60, v10, v11
v_mfma_f32_32x32x16_bf16 v[224:239], a[152:155], v[48:51], v[224:239]
ds_read_b64_tr_b16 a[144:145], v2 offset:21760
ds_read_b64_tr_b16 a[146:147], v2 offset:26112
v_lshlrev_b32_e64 v12, 16, v61
v_and_b32 v13, s74, v61
v_fma_f32 v12, v12, v8, -v9
v_fma_f32 v13, v13, v8, -v9
v_mfma_f32_32x32x16_bf16 v[240:255], a[156:159], v[48:51], v[240:255]
s_waitcnt lgkmcnt(6)
ds_read_b64_tr_b16 a[148:149], v2 offset:21824
ds_read_b64_tr_b16 a[150:151], v2 offset:26176
buffer_load_dwordx4 v6, s[40:43], s69 offen offset:2176 lds
v_cvt_pk_bf16_f32 v61, v12, v13
v_lshlrev_b32_e64 v10, 16, v62
v_mfma_f32_32x32x16_bf16 v[128:143], a[128:131], v[52:55], v[128:143]
v_readlane_b32 s70, v14, 15
ds_read_b64_tr_b16 a[152:153], v2 offset:21888
ds_read_b64_tr_b16 a[154:155], v2 offset:26240
v_and_b32_e64 v11, s74, v62
v_fma_f32 v10, v10, v8, -v9
v_fma_f32 v11, v11, v8, -v9
v_cvt_pk_bf16_f32 v62, v10, v11
v_mfma_f32_32x32x16_bf16 v[144:159], a[132:135], v[52:55], v[144:159]
s_waitcnt lgkmcnt(8)
ds_read_b64_tr_b16 a[156:157], v2 offset:21952
ds_read_b64_tr_b16 a[158:159], v2 offset:26304
buffer_load_dwordx4 v7, s[40:43], s69 offen offset:3264 lds
v_lshlrev_b32 v12, 16, v63
v_and_b32_e64 v13, s74, v63
v_mfma_f32_32x32x16_bf16 v[160:175], a[136:139], v[52:55], v[160:175]
s_waitcnt vmcnt(12) lgkmcnt(8)
s_barrier
ds_read_b64_tr_b16 a[128:129], v2 offset:38912
ds_read_b64_tr_b16 a[130:131], v2 offset:43264
s_add_u32 m0, s71, 34816
v_mfma_f32_32x32x16_bf16 v[176:191], a[140:143], v[52:55], v[176:191]
s_waitcnt lgkmcnt(6)
s_nop 0
ds_read_b64_tr_b16 a[132:133], v2 offset:38976
ds_read_b64_tr_b16 a[134:135], v2 offset:43328
buffer_load_dwordx4 v4, s[40:43], s70 offen offset:0 lds
v_fma_f32 v12, v12, v8, -v9
v_fma_f32 v13, v13, v8, -v9
v_cvt_pk_bf16_f32 v63, v12, v13
v_mfma_f32_32x32x16_bf16 v[192:207], a[144:147], v[52:55], v[192:207]
ds_read_b64_tr_b16 a[136:137], v2 offset:39040
ds_read_b64_tr_b16 a[138:139], v2 offset:43392
v_add_u32 v16, 1584, v19
v_lshl_add_u32 v23, v30, 11, v15
v_add_u32 v22, 576, v23
v_add_u32 v21, 1152, v23
v_mfma_f32_32x32x16_bf16 v[208:223], a[148:151], v[52:55], v[208:223]
s_waitcnt lgkmcnt(6)
ds_read_b64_tr_b16 a[140:141], v2 offset:39104
ds_read_b64_tr_b16 a[142:143], v2 offset:43456
buffer_load_dwordx4 v5, s[40:43], s70 offen offset:1088 lds
v_add_u32 v20, 1728, v23
v_and_b32 v15, 15, v0
v_mfma_f32_32x32x16_bf16 v[224:239], a[152:155], v[52:55], v[224:239]
ds_read_b64_tr_b16 a[144:145], v2 offset:39168
ds_read_b64_tr_b16 a[146:147], v2 offset:43520
v_lshlrev_b32_e64 v10, 16, v64
v_and_b32 v11, s74, v64
v_fma_f32 v10, v10, v8, -v9
v_fma_f32 v11, v11, v8, -v9
v_mfma_f32_32x32x16_bf16 v[240:255], a[156:159], v[52:55], v[240:255]
s_waitcnt lgkmcnt(6)
ds_read_b64_tr_b16 a[148:149], v2 offset:39232
ds_read_b64_tr_b16 a[150:151], v2 offset:43584
buffer_load_dwordx4 v6, s[40:43], s70 offen offset:2176 lds
v_cvt_pk_bf16_f32 v64, v10, v11
v_lshlrev_b32_e64 v12, 16, v65
v_mfma_f32_32x32x16_bf16 v[128:143], a[128:131], v[56:59], v[128:143]
ds_read_b64_tr_b16 a[152:153], v2 offset:39296
ds_read_b64_tr_b16 a[154:155], v2 offset:43648
v_and_b32_e64 v13, s74, v65
v_fma_f32 v12, v12, v8, -v9
v_fma_f32 v13, v13, v8, -v9
v_cvt_pk_bf16_f32 v65, v12, v13
v_lshlrev_b32 v10, 16, v66
v_mfma_f32_32x32x16_bf16 v[144:159], a[132:135], v[56:59], v[144:159]
s_waitcnt lgkmcnt(6)
ds_read_b64_tr_b16 a[156:157], v2 offset:39360
ds_read_b64_tr_b16 a[158:159], v2 offset:43712
buffer_load_dwordx4 v7, s[40:43], s70 offen offset:3264 lds
v_and_b32_e64 v11, s74, v66
v_fma_f32 v10, v10, v8, -v9
v_mfma_f32_32x32x16_bf16 v[160:175], a[136:139], v[56:59], v[160:175]
v_readlane_b32 s69, v14, 16
ds_read_b64_tr_b16 a[128:129], v2 offset:56320
ds_read_b64_tr_b16 a[130:131], v2 offset:60672
s_add_u32 m0, s71, 52224
v_fma_f32 v11, v11, v8, -v9
v_cvt_pk_bf16_f32 v66, v10, v11
v_lshlrev_b32 v12, 16, v67
v_mfma_f32_32x32x16_bf16 v[176:191], a[140:143], v[56:59], v[176:191]
s_waitcnt lgkmcnt(6)
ds_read_b64_tr_b16 a[132:133], v2 offset:56384
ds_read_b64_tr_b16 a[134:135], v2 offset:60736
buffer_load_dwordx4 v4, s[40:43], s69 offen offset:0 lds
v_and_b32_e64 v13, s74, v67
v_fma_f32 v12, v12, v8, -v9
v_mfma_f32_32x32x16_bf16 v[192:207], a[144:147], v[56:59], v[192:207]
ds_read_b64_tr_b16 a[136:137], v2 offset:56448
ds_read_b64_tr_b16 a[138:139], v2 offset:60800
v_fma_f32 v13, v13, v8, -v9
v_cvt_pk_bf16_f32 v67, v12, v13
v_lshlrev_b32_e64 v10, 16, v68
v_and_b32 v11, s74, v68
v_mfma_f32_32x32x16_bf16 v[208:223], a[148:151], v[56:59], v[208:223]
s_waitcnt lgkmcnt(6)
ds_read_b64_tr_b16 a[140:141], v2 offset:56512
ds_read_b64_tr_b16 a[142:143], v2 offset:60864
buffer_load_dwordx4 v5, s[40:43], s69 offen offset:1088 lds
v_fma_f32 v10, v10, v8, -v9
v_fma_f32 v11, v11, v8, -v9
v_cvt_pk_bf16_f32 v68, v10, v11
v_mfma_f32_32x32x16_bf16 v[224:239], a[152:155], v[56:59], v[224:239]
ds_read_b64_tr_b16 a[144:145], v2 offset:56576
ds_read_b64_tr_b16 a[146:147], v2 offset:60928
v_lshlrev_b32_e64 v12, 16, v69
v_and_b32 v13, s74, v69
v_fma_f32 v12, v12, v8, -v9
v_fma_f32 v13, v13, v8, -v9
v_mfma_f32_32x32x16_bf16 v[240:255], a[156:159], v[56:59], v[240:255]
s_waitcnt lgkmcnt(6)
ds_read_b64_tr_b16 a[148:149], v2 offset:56640
ds_read_b64_tr_b16 a[150:151], v2 offset:60992
buffer_load_dwordx4 v6, s[40:43], s69 offen offset:2176 lds
v_cvt_pk_bf16_f32 v69, v12, v13
v_lshlrev_b32_e64 v10, 16, v70
v_mfma_f32_32x32x16_bf16 v[128:143], a[128:131], v[60:63], v[128:143]
v_readlane_b32 s70, v14, 17
ds_read_b64_tr_b16 a[152:153], v2 offset:56704
ds_read_b64_tr_b16 a[154:155], v2 offset:61056
v_and_b32_e64 v11, s74, v70
v_fma_f32 v10, v10, v8, -v9
v_fma_f32 v11, v11, v8, -v9
v_cvt_pk_bf16_f32 v70, v10, v11
v_mfma_f32_32x32x16_bf16 v[144:159], a[132:135], v[60:63], v[144:159]
s_waitcnt lgkmcnt(8)
ds_read_b64_tr_b16 a[156:157], v2 offset:56768
ds_read_b64_tr_b16 a[158:159], v2 offset:61120
buffer_load_dwordx4 v7, s[40:43], s69 offen offset:3264 lds
v_lshlrev_b32 v12, 16, v71
v_and_b32_e64 v13, s74, v71
v_mfma_f32_32x32x16_bf16 v[160:175], a[136:139], v[60:63], v[160:175]
s_waitcnt vmcnt(12) lgkmcnt(8)
s_barrier
ds_read_b64_tr_b16 a[128:129], v3 offset:8192
ds_read_b64_tr_b16 a[130:131], v3 offset:12544
s_add_u32 m0, s71, 69632
v_mfma_f32_32x32x16_bf16 v[176:191], a[140:143], v[60:63], v[176:191]
s_waitcnt lgkmcnt(6)
s_nop 0
ds_read_b64_tr_b16 a[132:133], v3 offset:8256
ds_read_b64_tr_b16 a[134:135], v3 offset:12608
buffer_load_dwordx4 v4, s[40:43], s70 offen offset:0 lds
v_fma_f32 v12, v12, v8, -v9
v_fma_f32 v13, v13, v8, -v9
v_cvt_pk_bf16_f32 v71, v12, v13
v_mfma_f32_32x32x16_bf16 v[192:207], a[144:147], v[60:63], v[192:207]
ds_read_b64_tr_b16 a[136:137], v3 offset:8320
ds_read_b64_tr_b16 a[138:139], v3 offset:12672
v_mul_u32_u24 v24, 1040, v15
v_bfe_u32 v31, v0, 4, 1
v_lshl_add_u32 v24, v31, 9, v24
v_lshl_add_u32 v24, v30, 4, v24
v_mfma_f32_32x32x16_bf16 v[208:223], a[148:151], v[60:63], v[208:223]
s_waitcnt lgkmcnt(6)
s_nop 0
ds_read_b64_tr_b16 a[140:141], v3 offset:8384
ds_read_b64_tr_b16 a[142:143], v3 offset:12736
buffer_load_dwordx4 v5, s[40:43], s70 offen offset:1088 lds
v_add_u32 v25, 0x10000, v24
v_add_u32 v26, 0x20000, v24
v_mfma_f32_32x32x16_bf16 v[224:239], a[152:155], v[60:63], v[224:239]
ds_read_b64_tr_b16 a[144:145], v3 offset:8448
ds_read_b64_tr_b16 a[146:147], v3 offset:12800
v_lshlrev_b32_e64 v10, 16, v72
v_and_b32 v11, s74, v72
v_fma_f32 v10, v10, v8, -v9
v_fma_f32 v11, v11, v8, -v9
v_mfma_f32_32x32x16_bf16 v[240:255], a[156:159], v[60:63], v[240:255]
s_waitcnt lgkmcnt(6)
ds_read_b64_tr_b16 a[148:149], v3 offset:8512
ds_read_b64_tr_b16 a[150:151], v3 offset:12864
buffer_load_dwordx4 v6, s[40:43], s70 offen offset:2176 lds
v_cvt_pk_bf16_f32 v72, v10, v11
v_lshlrev_b32_e64 v12, 16, v73
v_mfma_f32_32x32x16_bf16 v[128:143], a[128:131], v[64:67], v[128:143]
ds_read_b64_tr_b16 a[152:153], v3 offset:8576
ds_read_b64_tr_b16 a[154:155], v3 offset:12928
v_and_b32_e64 v13, s74, v73
v_fma_f32 v12, v12, v8, -v9
v_fma_f32 v13, v13, v8, -v9
v_cvt_pk_bf16_f32 v73, v12, v13
v_lshlrev_b32 v10, 16, v74
v_mfma_f32_32x32x16_bf16 v[144:159], a[132:135], v[64:67], v[144:159]
s_waitcnt lgkmcnt(6)
ds_read_b64_tr_b16 a[156:157], v3 offset:8640
ds_read_b64_tr_b16 a[158:159], v3 offset:12992
buffer_load_dwordx4 v7, s[40:43], s70 offen offset:3264 lds
v_and_b32_e64 v11, s74, v74
v_fma_f32 v10, v10, v8, -v9
v_mfma_f32_32x32x16_bf16 v[160:175], a[136:139], v[64:67], v[160:175]
v_readlane_b32 s69, v14, 18
ds_read_b64_tr_b16 a[128:129], v1 offset:0
ds_read_b64_tr_b16 a[130:131], v1 offset:4352
s_add_u32 m0, s71, 87040
v_fma_f32 v11, v11, v8, -v9
v_cvt_pk_bf16_f32 v74, v10, v11
v_lshlrev_b32 v12, 16, v75
v_mfma_f32_32x32x16_bf16 v[176:191], a[140:143], v[64:67], v[176:191]
s_waitcnt lgkmcnt(6)
ds_read_b64_tr_b16 a[132:133], v1 offset:64
ds_read_b64_tr_b16 a[134:135], v1 offset:4416
buffer_load_dwordx4 v4, s[40:43], s69 offen offset:0 lds
v_and_b32_e64 v13, s74, v75
v_fma_f32 v12, v12, v8, -v9
v_mfma_f32_32x32x16_bf16 v[192:207], a[144:147], v[64:67], v[192:207]
ds_read_b64_tr_b16 a[136:137], v1 offset:128
ds_read_b64_tr_b16 a[138:139], v1 offset:4480
v_fma_f32 v13, v13, v8, -v9
v_cvt_pk_bf16_f32 v75, v12, v13
v_lshlrev_b32_e64 v10, 16, v76
v_and_b32 v11, s74, v76
v_mfma_f32_32x32x16_bf16 v[208:223], a[148:151], v[64:67], v[208:223]
s_waitcnt lgkmcnt(6)
ds_read_b64_tr_b16 a[140:141], v1 offset:192
ds_read_b64_tr_b16 a[142:143], v1 offset:4544
buffer_load_dwordx4 v5, s[40:43], s69 offen offset:1088 lds
v_fma_f32 v10, v10, v8, -v9
v_fma_f32 v11, v11, v8, -v9
v_cvt_pk_bf16_f32 v76, v10, v11
v_mfma_f32_32x32x16_bf16 v[224:239], a[152:155], v[64:67], v[224:239]
ds_read_b64_tr_b16 a[144:145], v1 offset:256
ds_read_b64_tr_b16 a[146:147], v1 offset:4608
v_lshlrev_b32_e64 v12, 16, v77
v_and_b32 v13, s74, v77
v_fma_f32 v12, v12, v8, -v9
v_fma_f32 v13, v13, v8, -v9
v_mfma_f32_32x32x16_bf16 v[240:255], a[156:159], v[64:67], v[240:255]
s_waitcnt lgkmcnt(6)
ds_read_b64_tr_b16 a[148:149], v1 offset:320
ds_read_b64_tr_b16 a[150:151], v1 offset:4672
buffer_load_dwordx4 v6, s[40:43], s69 offen offset:2176 lds
v_cvt_pk_bf16_f32 v77, v12, v13
v_lshlrev_b32_e64 v10, 16, v78
v_mfma_f32_32x32x16_bf16 v[128:143], a[128:131], v[68:71], v[128:143]
v_readlane_b32 s70, v14, 19
ds_read_b64_tr_b16 a[152:153], v1 offset:384
ds_read_b64_tr_b16 a[154:155], v1 offset:4736
v_and_b32_e64 v11, s74, v78
v_fma_f32 v10, v10, v8, -v9
v_fma_f32 v11, v11, v8, -v9
v_cvt_pk_bf16_f32 v78, v10, v11
v_mfma_f32_32x32x16_bf16 v[144:159], a[132:135], v[68:71], v[144:159]
s_waitcnt lgkmcnt(8)
ds_read_b64_tr_b16 a[156:157], v1 offset:448
ds_read_b64_tr_b16 a[158:159], v1 offset:4800
buffer_load_dwordx4 v7, s[40:43], s69 offen offset:3264 lds
v_lshlrev_b32 v12, 16, v79
v_and_b32_e64 v13, s74, v79
v_mfma_f32_32x32x16_bf16 v[160:175], a[136:139], v[68:71], v[160:175]
s_waitcnt vmcnt(12) lgkmcnt(8)
s_barrier
ds_read_b64_tr_b16 a[128:129], v1 offset:17408
ds_read_b64_tr_b16 a[130:131], v1 offset:21760
s_add_u32 m0, s71, 104448
v_mfma_f32_32x32x16_bf16 v[176:191], a[140:143], v[68:71], v[176:191]
s_waitcnt lgkmcnt(6)
s_nop 0
ds_read_b64_tr_b16 a[132:133], v1 offset:17472
ds_read_b64_tr_b16 a[134:135], v1 offset:21824
buffer_load_dwordx4 v4, s[40:43], s70 offen offset:0 lds
v_fma_f32 v12, v12, v8, -v9
v_fma_f32 v13, v13, v8, -v9
v_cvt_pk_bf16_f32 v79, v12, v13
v_mfma_f32_32x32x16_bf16 v[192:207], a[144:147], v[68:71], v[192:207]
ds_read_b64_tr_b16 a[136:137], v1 offset:17536
ds_read_b64_tr_b16 a[138:139], v1 offset:21888
v_lshrrev_b32_e64 v15, 2, v15
v_mul_u32_u24 v27, 1088, v15
v_lshl_add_u32 v27, v30, 9, v27
v_lshl_add_u32 v27, v31, 5, v27
v_mfma_f32_32x32x16_bf16 v[208:223], a[148:151], v[68:71], v[208:223]
s_waitcnt lgkmcnt(6)
ds_read_b64_tr_b16 a[140:141], v1 offset:17600
ds_read_b64_tr_b16 a[142:143], v1 offset:21952
buffer_load_dwordx4 v5, s[40:43], s70 offen offset:1088 lds
v_and_b32 v28, 3, v0
v_lshl_add_u32 v27, v28, 3, v27
v_mfma_f32_32x32x16_bf16 v[224:239], a[152:155], v[68:71], v[224:239]
ds_read_b64_tr_b16 a[144:145], v1 offset:17664
ds_read_b64_tr_b16 a[146:147], v1 offset:22016
v_lshlrev_b32_e64 v10, 16, v80
v_and_b32 v11, s74, v80
v_fma_f32 v10, v10, v8, -v9
v_fma_f32 v11, v11, v8, -v9
v_mfma_f32_32x32x16_bf16 v[240:255], a[156:159], v[68:71], v[240:255]
s_waitcnt lgkmcnt(6)
ds_read_b64_tr_b16 a[148:149], v1 offset:17728
ds_read_b64_tr_b16 a[150:151], v1 offset:22080
buffer_load_dwordx4 v6, s[40:43], s70 offen offset:2176 lds
v_cvt_pk_bf16_f32 v80, v10, v11
v_lshlrev_b32_e64 v12, 16, v81
v_mfma_f32_32x32x16_bf16 v[128:143], a[128:131], v[72:75], v[128:143]
ds_read_b64_tr_b16 a[152:153], v1 offset:17792
ds_read_b64_tr_b16 a[154:155], v1 offset:22144
v_and_b32_e64 v13, s74, v81
v_fma_f32 v12, v12, v8, -v9
v_fma_f32 v13, v13, v8, -v9
v_cvt_pk_bf16_f32 v81, v12, v13
v_mfma_f32_32x32x16_bf16 v[144:159], a[132:135], v[72:75], v[144:159]
s_waitcnt lgkmcnt(6)
ds_read_b64_tr_b16 a[156:157], v1 offset:17856
ds_read_b64_tr_b16 a[158:159], v1 offset:22208
buffer_load_dwordx4 v7, s[40:43], s70 offen offset:3264 lds
v_lshlrev_b32 v10, 16, v82
v_and_b32_e64 v11, s74, v82
v_mfma_f32_32x32x16_bf16 v[160:175], a[136:139], v[72:75], v[160:175]
v_readlane_b32 s69, v14, 20
ds_read_b64_tr_b16 a[128:129], v1 offset:34816
ds_read_b64_tr_b16 a[130:131], v1 offset:39168
s_add_u32 m0, s71, 121856
v_fma_f32 v10, v10, v8, -v9
v_fma_f32 v11, v11, v8, -v9
v_cvt_pk_bf16_f32 v82, v10, v11
v_mfma_f32_32x32x16_bf16 v[176:191], a[140:143], v[72:75], v[176:191]
s_waitcnt lgkmcnt(6)
ds_read_b64_tr_b16 a[132:133], v1 offset:34880
ds_read_b64_tr_b16 a[134:135], v1 offset:39232
buffer_load_dwordx4 v4, s[40:43], s69 offen offset:0 lds
v_lshlrev_b32 v12, 16, v83
v_and_b32_e64 v13, s74, v83
v_mfma_f32_32x32x16_bf16 v[192:207], a[144:147], v[72:75], v[192:207]
ds_read_b64_tr_b16 a[136:137], v1 offset:34944
ds_read_b64_tr_b16 a[138:139], v1 offset:39296
v_fma_f32 v12, v12, v8, -v9
v_fma_f32 v13, v13, v8, -v9
v_cvt_pk_bf16_f32 v83, v12, v13
v_lshlrev_b32 v10, 16, v84
v_mfma_f32_32x32x16_bf16 v[208:223], a[148:151], v[72:75], v[208:223]
s_waitcnt lgkmcnt(6)
ds_read_b64_tr_b16 a[140:141], v1 offset:35008
ds_read_b64_tr_b16 a[142:143], v1 offset:39360
buffer_load_dwordx4 v5, s[40:43], s69 offen offset:1088 lds
v_and_b32_e64 v11, s74, v84
v_fma_f32 v10, v10, v8, -v9
v_mfma_f32_32x32x16_bf16 v[224:239], a[152:155], v[72:75], v[224:239]
ds_read_b64_tr_b16 a[144:145], v1 offset:35072
ds_read_b64_tr_b16 a[146:147], v1 offset:39424
v_fma_f32 v11, v11, v8, -v9
v_cvt_pk_bf16_f32 v84, v10, v11
v_lshlrev_b32_e64 v12, 16, v85
v_and_b32 v13, s74, v85
v_mfma_f32_32x32x16_bf16 v[240:255], a[156:159], v[72:75], v[240:255]
s_waitcnt lgkmcnt(6)
ds_read_b64_tr_b16 a[148:149], v1 offset:35136
ds_read_b64_tr_b16 a[150:151], v1 offset:39488
buffer_load_dwordx4 v6, s[40:43], s69 offen offset:2176 lds
v_fma_f32 v12, v12, v8, -v9
v_fma_f32 v13, v13, v8, -v9
v_mfma_f32_32x32x16_bf16 v[128:143], a[128:131], v[76:79], v[128:143]
v_readlane_b32 s70, v14, 21
ds_read_b64_tr_b16 a[152:153], v1 offset:35200
ds_read_b64_tr_b16 a[154:155], v1 offset:39552
v_cvt_pk_bf16_f32 v85, v12, v13
v_lshlrev_b32_e64 v10, 16, v86
v_and_b32 v11, s74, v86
v_fma_f32 v10, v10, v8, -v9
v_mfma_f32_32x32x16_bf16 v[144:159], a[132:135], v[76:79], v[144:159]
s_waitcnt lgkmcnt(8)
ds_read_b64_tr_b16 a[156:157], v1 offset:35264
ds_read_b64_tr_b16 a[158:159], v1 offset:39616
buffer_load_dwordx4 v7, s[40:43], s69 offen offset:3264 lds
v_fma_f32 v11, v11, v8, -v9
v_cvt_pk_bf16_f32 v86, v10, v11
v_mfma_f32_32x32x16_bf16 v[160:175], a[136:139], v[76:79], v[160:175]
s_waitcnt vmcnt(12) lgkmcnt(8)
s_barrier
ds_read_b64_tr_b16 a[128:129], v1 offset:52224
ds_read_b64_tr_b16 a[130:131], v1 offset:56576
s_add_u32 m0, s71, 139264
v_mfma_f32_32x32x16_bf16 v[176:191], a[140:143], v[76:79], v[176:191]
s_waitcnt lgkmcnt(6)
ds_read_b64_tr_b16 a[132:133], v1 offset:52288
ds_read_b64_tr_b16 a[134:135], v1 offset:56640
buffer_load_dwordx4 v4, s[40:43], s70 offen offset:0 lds
v_lshlrev_b32 v12, 16, v87
v_and_b32_e64 v13, s74, v87
v_mfma_f32_32x32x16_bf16 v[192:207], a[144:147], v[76:79], v[192:207]
ds_read_b64_tr_b16 a[136:137], v1 offset:52352
ds_read_b64_tr_b16 a[138:139], v1 offset:56704
v_fma_f32 v12, v12, v8, -v9
v_fma_f32 v13, v13, v8, -v9
v_cvt_pk_bf16_f32 v87, v12, v13
v_add_u32 v28, 0x10000, v27
v_mfma_f32_32x32x16_bf16 v[208:223], a[148:151], v[76:79], v[208:223]
s_waitcnt lgkmcnt(6)
ds_read_b64_tr_b16 a[140:141], v1 offset:52416
ds_read_b64_tr_b16 a[142:143], v1 offset:56768
buffer_load_dwordx4 v5, s[40:43], s70 offen offset:1088 lds
v_add_u32 v29, 0x20000, v27
v_mov_b32 v30, 0
v_mfma_f32_32x32x16_bf16 v[224:239], a[152:155], v[76:79], v[224:239]
ds_read_b64_tr_b16 a[144:145], v1 offset:52480
ds_read_b64_tr_b16 a[146:147], v1 offset:56832
v_lshlrev_b32_e64 v10, 16, v88
v_and_b32 v11, s74, v88
v_fma_f32 v10, v10, v8, -v9
v_fma_f32 v11, v11, v8, -v9
v_mfma_f32_32x32x16_bf16 v[240:255], a[156:159], v[76:79], v[240:255]
s_waitcnt lgkmcnt(6)
ds_read_b64_tr_b16 a[148:149], v1 offset:52544
ds_read_b64_tr_b16 a[150:151], v1 offset:56896
buffer_load_dwordx4 v6, s[40:43], s70 offen offset:2176 lds
v_cvt_pk_bf16_f32 v88, v10, v11
v_lshlrev_b32_e64 v12, 16, v89
v_mfma_f32_32x32x16_bf16 v[128:143], a[128:131], v[80:83], v[128:143]
ds_read_b64_tr_b16 a[152:153], v1 offset:52608
ds_read_b64_tr_b16 a[154:155], v1 offset:56960
v_and_b32 v13, s74, v89
v_fma_f32 v12, v12, v8, -v9
v_fma_f32 v13, v13, v8, -v9
v_mfma_f32_32x32x16_bf16 v[144:159], a[132:135], v[80:83], v[144:159]
s_waitcnt lgkmcnt(6)
ds_read_b64_tr_b16 a[156:157], v1 offset:52672
ds_read_b64_tr_b16 a[158:159], v1 offset:57024
buffer_load_dwordx4 v7, s[40:43], s70 offen offset:3264 lds
v_cvt_pk_bf16_f32 v89, v12, v13
v_lshlrev_b32_e64 v10, 16, v90
v_mfma_f32_32x32x16_bf16 v[160:175], a[136:139], v[80:83], v[160:175]
v_readlane_b32 s69, v14, 22
ds_read_b64_tr_b16 a[128:129], v2 offset:4096
ds_read_b64_tr_b16 a[130:131], v2 offset:8448
s_add_u32 m0, s71, 0
v_and_b32 v11, s74, v90
v_fma_f32 v10, v10, v8, -v9
v_fma_f32 v11, v11, v8, -v9
v_mfma_f32_32x32x16_bf16 v[176:191], a[140:143], v[80:83], v[176:191]
s_waitcnt lgkmcnt(6)
ds_read_b64_tr_b16 a[132:133], v2 offset:4160
ds_read_b64_tr_b16 a[134:135], v2 offset:8512
buffer_load_dwordx4 v4, s[40:43], s69 offen offset:0 lds
v_cvt_pk_bf16_f32 v90, v10, v11
v_lshlrev_b32 v12, 16, v91
v_mfma_f32_32x32x16_bf16 v[192:207], a[144:147], v[80:83], v[192:207]
ds_read_b64_tr_b16 a[136:137], v2 offset:4224
ds_read_b64_tr_b16 a[138:139], v2 offset:8576
v_and_b32_e64 v13, s74, v91
v_fma_f32 v12, v12, v8, -v9
v_fma_f32 v13, v13, v8, -v9
v_cvt_pk_bf16_f32 v91, v12, v13
v_mfma_f32_32x32x16_bf16 v[208:223], a[148:151], v[80:83], v[208:223]
s_waitcnt lgkmcnt(6)
ds_read_b64_tr_b16 a[140:141], v2 offset:4288
ds_read_b64_tr_b16 a[142:143], v2 offset:8640
buffer_load_dwordx4 v5, s[40:43], s69 offen offset:1088 lds
v_lshlrev_b32 v10, 16, v92
v_mfma_f32_32x32x16_bf16 v[224:239], a[152:155], v[80:83], v[224:239]
ds_read_b64_tr_b16 a[144:145], v2 offset:4352
ds_read_b64_tr_b16 a[146:147], v2 offset:8704
v_and_b32_e64 v11, s74, v92
v_fma_f32 v10, v10, v8, -v9
v_fma_f32 v11, v11, v8, -v9
v_cvt_pk_bf16_f32 v92, v10, v11
v_mfma_f32_32x32x16_bf16 v[240:255], a[156:159], v[80:83], v[240:255]
s_waitcnt lgkmcnt(6)
ds_read_b64_tr_b16 a[148:149], v2 offset:4416
ds_read_b64_tr_b16 a[150:151], v2 offset:8768
buffer_load_dwordx4 v6, s[40:43], s69 offen offset:2176 lds
v_lshlrev_b32 v12, 16, v93
v_and_b32_e64 v13, s74, v93
v_mfma_f32_32x32x16_bf16 v[128:143], a[128:131], v[84:87], v[128:143]
v_readlane_b32 s70, v14, 23
ds_read_b64_tr_b16 a[152:153], v2 offset:4480
ds_read_b64_tr_b16 a[154:155], v2 offset:8832
v_fma_f32 v12, v12, v8, -v9
v_fma_f32 v13, v13, v8, -v9
v_cvt_pk_bf16_f32 v93, v12, v13
v_lshlrev_b32 v10, 16, v94
v_mfma_f32_32x32x16_bf16 v[144:159], a[132:135], v[84:87], v[144:159]
s_waitcnt lgkmcnt(8)
ds_read_b64_tr_b16 a[156:157], v2 offset:4544
ds_read_b64_tr_b16 a[158:159], v2 offset:8896
buffer_load_dwordx4 v7, s[40:43], s69 offen offset:3264 lds
v_and_b32_e64 v11, s74, v94
v_fma_f32 v10, v10, v8, -v9
v_mfma_f32_32x32x16_bf16 v[160:175], a[136:139], v[84:87], v[160:175]
s_waitcnt vmcnt(12) lgkmcnt(8)
s_barrier
ds_read_b64_tr_b16 a[128:129], v2 offset:21504
ds_read_b64_tr_b16 a[130:131], v2 offset:25856
s_add_u32 m0, s71, 17408
v_mfma_f32_32x32x16_bf16 v[176:191], a[140:143], v[84:87], v[176:191]
s_waitcnt lgkmcnt(6)
s_nop 0
ds_read_b64_tr_b16 a[132:133], v2 offset:21568
ds_read_b64_tr_b16 a[134:135], v2 offset:25920
buffer_load_dwordx4 v4, s[40:43], s70 offen offset:0 lds
v_fma_f32 v11, v11, v8, -v9
v_mfma_f32_32x32x16_bf16 v[192:207], a[144:147], v[84:87], v[192:207]
ds_read_b64_tr_b16 a[136:137], v2 offset:21632
ds_read_b64_tr_b16 a[138:139], v2 offset:25984
v_cvt_pk_bf16_f32 v94, v10, v11
v_lshlrev_b32_e64 v12, 16, v95
v_and_b32 v13, s74, v95
v_fma_f32 v12, v12, v8, -v9
v_mfma_f32_32x32x16_bf16 v[208:223], a[148:151], v[84:87], v[208:223]
s_waitcnt lgkmcnt(6)
ds_read_b64_tr_b16 a[140:141], v2 offset:21696
ds_read_b64_tr_b16 a[142:143], v2 offset:26048
buffer_load_dwordx4 v5, s[40:43], s70 offen offset:1088 lds
v_fma_f32 v13, v13, v8, -v9
v_cvt_pk_bf16_f32 v95, v12, v13
v_mfma_f32_32x32x16_bf16 v[224:239], a[152:155], v[84:87], v[224:239]
ds_read_b64_tr_b16 a[144:145], v2 offset:21760
ds_read_b64_tr_b16 a[146:147], v2 offset:26112
v_lshlrev_b32_e64 v10, 16, v96
v_and_b32 v11, s74, v96
v_fma_f32 v10, v10, v8, -v9
v_fma_f32 v11, v11, v8, -v9
v_mfma_f32_32x32x16_bf16 v[240:255], a[156:159], v[84:87], v[240:255]
s_waitcnt lgkmcnt(6)
ds_read_b64_tr_b16 a[148:149], v2 offset:21824
ds_read_b64_tr_b16 a[150:151], v2 offset:26176
buffer_load_dwordx4 v6, s[40:43], s70 offen offset:2176 lds
v_cvt_pk_bf16_f32 v96, v10, v11
v_lshlrev_b32_e64 v12, 16, v97
v_mfma_f32_32x32x16_bf16 v[128:143], a[128:131], v[88:91], v[128:143]
ds_read_b64_tr_b16 a[152:153], v2 offset:21888
ds_read_b64_tr_b16 a[154:155], v2 offset:26240
v_and_b32 v13, s74, v97
v_fma_f32 v12, v12, v8, -v9
v_fma_f32 v13, v13, v8, -v9
v_mfma_f32_32x32x16_bf16 v[144:159], a[132:135], v[88:91], v[144:159]
s_waitcnt lgkmcnt(6)
ds_read_b64_tr_b16 a[156:157], v2 offset:21952
ds_read_b64_tr_b16 a[158:159], v2 offset:26304
buffer_load_dwordx4 v7, s[40:43], s70 offen offset:3264 lds
v_cvt_pk_bf16_f32 v97, v12, v13
v_lshlrev_b32_e64 v10, 16, v98
v_mfma_f32_32x32x16_bf16 v[160:175], a[136:139], v[88:91], v[160:175]
v_readlane_b32 s69, v14, 24
ds_read_b64_tr_b16 a[128:129], v2 offset:38912
ds_read_b64_tr_b16 a[130:131], v2 offset:43264
s_add_u32 m0, s71, 34816
v_and_b32 v11, s74, v98
v_fma_f32 v10, v10, v8, -v9
v_fma_f32 v11, v11, v8, -v9
v_mfma_f32_32x32x16_bf16 v[176:191], a[140:143], v[88:91], v[176:191]
s_waitcnt lgkmcnt(6)
ds_read_b64_tr_b16 a[132:133], v2 offset:38976
ds_read_b64_tr_b16 a[134:135], v2 offset:43328
buffer_load_dwordx4 v4, s[40:43], s69 offen offset:0 lds
v_cvt_pk_bf16_f32 v98, v10, v11
v_lshlrev_b32_e64 v12, 16, v99
v_mfma_f32_32x32x16_bf16 v[192:207], a[144:147], v[88:91], v[192:207]
ds_read_b64_tr_b16 a[136:137], v2 offset:39040
ds_read_b64_tr_b16 a[138:139], v2 offset:43392
v_and_b32_e64 v13, s74, v99
v_fma_f32 v12, v12, v8, -v9
v_fma_f32 v13, v13, v8, -v9
v_cvt_pk_bf16_f32 v99, v12, v13
v_mfma_f32_32x32x16_bf16 v[208:223], a[148:151], v[88:91], v[208:223]
s_waitcnt lgkmcnt(6)
ds_read_b64_tr_b16 a[140:141], v2 offset:39104
ds_read_b64_tr_b16 a[142:143], v2 offset:43456
buffer_load_dwordx4 v5, s[40:43], s69 offen offset:1088 lds
v_lshlrev_b32 v10, 16, v100
v_mfma_f32_32x32x16_bf16 v[224:239], a[152:155], v[88:91], v[224:239]
ds_read_b64_tr_b16 a[144:145], v2 offset:39168
ds_read_b64_tr_b16 a[146:147], v2 offset:43520
v_and_b32_e64 v11, s74, v100
v_fma_f32 v10, v10, v8, -v9
v_fma_f32 v11, v11, v8, -v9
v_cvt_pk_bf16_f32 v100, v10, v11
v_mfma_f32_32x32x16_bf16 v[240:255], a[156:159], v[88:91], v[240:255]
s_waitcnt lgkmcnt(6)
ds_read_b64_tr_b16 a[148:149], v2 offset:39232
ds_read_b64_tr_b16 a[150:151], v2 offset:43584
buffer_load_dwordx4 v6, s[40:43], s69 offen offset:2176 lds
v_lshlrev_b32 v12, 16, v101
v_and_b32_e64 v13, s74, v101
v_mfma_f32_32x32x16_bf16 v[128:143], a[128:131], v[92:95], v[128:143]
v_readlane_b32 s70, v14, 25
ds_read_b64_tr_b16 a[152:153], v2 offset:39296
ds_read_b64_tr_b16 a[154:155], v2 offset:43648
v_fma_f32 v12, v12, v8, -v9
v_fma_f32 v13, v13, v8, -v9
v_cvt_pk_bf16_f32 v101, v12, v13
v_lshlrev_b32 v10, 16, v102
v_mfma_f32_32x32x16_bf16 v[144:159], a[132:135], v[92:95], v[144:159]
s_waitcnt lgkmcnt(8)
ds_read_b64_tr_b16 a[156:157], v2 offset:39360
ds_read_b64_tr_b16 a[158:159], v2 offset:43712
buffer_load_dwordx4 v7, s[40:43], s69 offen offset:3264 lds
v_and_b32_e64 v11, s74, v102
v_fma_f32 v10, v10, v8, -v9
v_mfma_f32_32x32x16_bf16 v[160:175], a[136:139], v[92:95], v[160:175]
s_waitcnt vmcnt(12) lgkmcnt(8)
s_barrier
ds_read_b64_tr_b16 a[128:129], v2 offset:56320
ds_read_b64_tr_b16 a[130:131], v2 offset:60672
s_add_u32 m0, s71, 52224
v_mfma_f32_32x32x16_bf16 v[176:191], a[140:143], v[92:95], v[176:191]
s_waitcnt lgkmcnt(6)
s_nop 0
ds_read_b64_tr_b16 a[132:133], v2 offset:56384
ds_read_b64_tr_b16 a[134:135], v2 offset:60736
buffer_load_dwordx4 v4, s[40:43], s70 offen offset:0 lds
v_fma_f32 v11, v11, v8, -v9
v_mfma_f32_32x32x16_bf16 v[192:207], a[144:147], v[92:95], v[192:207]
ds_read_b64_tr_b16 a[136:137], v2 offset:56448
ds_read_b64_tr_b16 a[138:139], v2 offset:60800
v_cvt_pk_bf16_f32 v102, v10, v11
v_lshlrev_b32_e64 v12, 16, v103
v_and_b32 v13, s74, v103
v_fma_f32 v12, v12, v8, -v9
v_mfma_f32_32x32x16_bf16 v[208:223], a[148:151], v[92:95], v[208:223]
s_waitcnt lgkmcnt(6)
ds_read_b64_tr_b16 a[140:141], v2 offset:56512
ds_read_b64_tr_b16 a[142:143], v2 offset:60864
buffer_load_dwordx4 v5, s[40:43], s70 offen offset:1088 lds
v_fma_f32 v13, v13, v8, -v9
v_cvt_pk_bf16_f32 v103, v12, v13
v_mfma_f32_32x32x16_bf16 v[224:239], a[152:155], v[92:95], v[224:239]
ds_read_b64_tr_b16 a[144:145], v2 offset:56576
ds_read_b64_tr_b16 a[146:147], v2 offset:60928
v_lshlrev_b32_e64 v10, 16, v104
v_and_b32 v11, s74, v104
v_fma_f32 v10, v10, v8, -v9
v_fma_f32 v11, v11, v8, -v9
v_mfma_f32_32x32x16_bf16 v[240:255], a[156:159], v[92:95], v[240:255]
s_waitcnt lgkmcnt(6)
ds_read_b64_tr_b16 a[148:149], v2 offset:56640
ds_read_b64_tr_b16 a[150:151], v2 offset:60992
buffer_load_dwordx4 v6, s[40:43], s70 offen offset:2176 lds
v_cvt_pk_bf16_f32 v104, v10, v11
v_lshlrev_b32_e64 v12, 16, v105
v_mfma_f32_32x32x16_bf16 v[128:143], a[128:131], v[96:99], v[128:143]
ds_read_b64_tr_b16 a[152:153], v2 offset:56704
ds_read_b64_tr_b16 a[154:155], v2 offset:61056
v_and_b32 v13, s74, v105
v_fma_f32 v12, v12, v8, -v9
v_fma_f32 v13, v13, v8, -v9
v_mfma_f32_32x32x16_bf16 v[144:159], a[132:135], v[96:99], v[144:159]
s_waitcnt lgkmcnt(6)
ds_read_b64_tr_b16 a[156:157], v2 offset:56768
ds_read_b64_tr_b16 a[158:159], v2 offset:61120
buffer_load_dwordx4 v7, s[40:43], s70 offen offset:3264 lds
v_cvt_pk_bf16_f32 v105, v12, v13
v_lshlrev_b32_e64 v10, 16, v106
v_mfma_f32_32x32x16_bf16 v[160:175], a[136:139], v[96:99], v[160:175]
v_readlane_b32 s69, v14, 26
ds_read_b64_tr_b16 a[128:129], v3 offset:8192
ds_read_b64_tr_b16 a[130:131], v3 offset:12544
s_add_u32 m0, s71, 69632
v_and_b32 v11, s74, v106
v_fma_f32 v10, v10, v8, -v9
v_fma_f32 v11, v11, v8, -v9
v_mfma_f32_32x32x16_bf16 v[176:191], a[140:143], v[96:99], v[176:191]
s_waitcnt lgkmcnt(6)
ds_read_b64_tr_b16 a[132:133], v3 offset:8256
ds_read_b64_tr_b16 a[134:135], v3 offset:12608
buffer_load_dwordx4 v4, s[40:43], s69 offen offset:0 lds
v_cvt_pk_bf16_f32 v106, v10, v11
v_lshlrev_b32_e64 v12, 16, v107
v_mfma_f32_32x32x16_bf16 v[192:207], a[144:147], v[96:99], v[192:207]
ds_read_b64_tr_b16 a[136:137], v3 offset:8320
ds_read_b64_tr_b16 a[138:139], v3 offset:12672
v_and_b32_e64 v13, s74, v107
v_fma_f32 v12, v12, v8, -v9
v_fma_f32 v13, v13, v8, -v9
v_cvt_pk_bf16_f32 v107, v12, v13
v_mfma_f32_32x32x16_bf16 v[208:223], a[148:151], v[96:99], v[208:223]
s_waitcnt lgkmcnt(6)
ds_read_b64_tr_b16 a[140:141], v3 offset:8384
ds_read_b64_tr_b16 a[142:143], v3 offset:12736
buffer_load_dwordx4 v5, s[40:43], s69 offen offset:1088 lds
v_lshlrev_b32 v10, 16, v108
v_mfma_f32_32x32x16_bf16 v[224:239], a[152:155], v[96:99], v[224:239]
ds_read_b64_tr_b16 a[144:145], v3 offset:8448
ds_read_b64_tr_b16 a[146:147], v3 offset:12800
v_and_b32_e64 v11, s74, v108
v_fma_f32 v10, v10, v8, -v9
v_fma_f32 v11, v11, v8, -v9
v_cvt_pk_bf16_f32 v108, v10, v11
v_mfma_f32_32x32x16_bf16 v[240:255], a[156:159], v[96:99], v[240:255]
s_waitcnt lgkmcnt(6)
ds_read_b64_tr_b16 a[148:149], v3 offset:8512
ds_read_b64_tr_b16 a[150:151], v3 offset:12864
buffer_load_dwordx4 v6, s[40:43], s69 offen offset:2176 lds
v_lshlrev_b32 v12, 16, v109
v_and_b32_e64 v13, s74, v109
v_mfma_f32_32x32x16_bf16 v[128:143], a[128:131], v[100:103], v[128:143]
v_readlane_b32 s70, v14, 27
ds_read_b64_tr_b16 a[152:153], v3 offset:8576
ds_read_b64_tr_b16 a[154:155], v3 offset:12928
v_fma_f32 v12, v12, v8, -v9
v_fma_f32 v13, v13, v8, -v9
v_cvt_pk_bf16_f32 v109, v12, v13
v_lshlrev_b32 v10, 16, v110
v_mfma_f32_32x32x16_bf16 v[144:159], a[132:135], v[100:103], v[144:159]
s_waitcnt lgkmcnt(8)
ds_read_b64_tr_b16 a[156:157], v3 offset:8640
ds_read_b64_tr_b16 a[158:159], v3 offset:12992
buffer_load_dwordx4 v7, s[40:43], s69 offen offset:3264 lds
v_and_b32_e64 v11, s74, v110
v_fma_f32 v10, v10, v8, -v9
v_mfma_f32_32x32x16_bf16 v[160:175], a[136:139], v[100:103], v[160:175]
s_waitcnt vmcnt(12) lgkmcnt(8)
s_barrier
ds_read_b64_tr_b16 a[128:129], v1 offset:0
ds_read_b64_tr_b16 a[130:131], v1 offset:4352
s_add_u32 m0, s71, 87040
v_mfma_f32_32x32x16_bf16 v[176:191], a[140:143], v[100:103], v[176:191]
s_waitcnt lgkmcnt(6)
s_nop 0
ds_read_b64_tr_b16 a[132:133], v1 offset:64
ds_read_b64_tr_b16 a[134:135], v1 offset:4416
buffer_load_dwordx4 v4, s[40:43], s70 offen offset:0 lds
v_fma_f32 v11, v11, v8, -v9
v_mfma_f32_32x32x16_bf16 v[192:207], a[144:147], v[100:103], v[192:207]
ds_read_b64_tr_b16 a[136:137], v1 offset:128
ds_read_b64_tr_b16 a[138:139], v1 offset:4480
v_cvt_pk_bf16_f32 v110, v10, v11
v_lshlrev_b32_e64 v12, 16, v111
v_and_b32 v13, s74, v111
v_fma_f32 v12, v12, v8, -v9
v_mfma_f32_32x32x16_bf16 v[208:223], a[148:151], v[100:103], v[208:223]
s_waitcnt lgkmcnt(6)
ds_read_b64_tr_b16 a[140:141], v1 offset:192
ds_read_b64_tr_b16 a[142:143], v1 offset:4544
buffer_load_dwordx4 v5, s[40:43], s70 offen offset:1088 lds
v_fma_f32 v13, v13, v8, -v9
v_cvt_pk_bf16_f32 v111, v12, v13
v_mfma_f32_32x32x16_bf16 v[224:239], a[152:155], v[100:103], v[224:239]
ds_read_b64_tr_b16 a[144:145], v1 offset:256
ds_read_b64_tr_b16 a[146:147], v1 offset:4608
v_lshlrev_b32_e64 v10, 16, v112
v_and_b32 v11, s74, v112
v_fma_f32 v10, v10, v8, -v9
v_fma_f32 v11, v11, v8, -v9
v_mfma_f32_32x32x16_bf16 v[240:255], a[156:159], v[100:103], v[240:255]
s_waitcnt lgkmcnt(6)
ds_read_b64_tr_b16 a[148:149], v1 offset:320
ds_read_b64_tr_b16 a[150:151], v1 offset:4672
buffer_load_dwordx4 v6, s[40:43], s70 offen offset:2176 lds
v_cvt_pk_bf16_f32 v112, v10, v11
v_lshlrev_b32_e64 v12, 16, v113
v_mfma_f32_32x32x16_bf16 v[128:143], a[128:131], v[104:107], v[128:143]
ds_read_b64_tr_b16 a[152:153], v1 offset:384
ds_read_b64_tr_b16 a[154:155], v1 offset:4736
v_and_b32 v13, s74, v113
v_fma_f32 v12, v12, v8, -v9
v_fma_f32 v13, v13, v8, -v9
v_mfma_f32_32x32x16_bf16 v[144:159], a[132:135], v[104:107], v[144:159]
s_waitcnt lgkmcnt(6)
ds_read_b64_tr_b16 a[156:157], v1 offset:448
ds_read_b64_tr_b16 a[158:159], v1 offset:4800
buffer_load_dwordx4 v7, s[40:43], s70 offen offset:3264 lds
v_cvt_pk_bf16_f32 v113, v12, v13
v_lshlrev_b32 v10, 16, v114
v_mfma_f32_32x32x16_bf16 v[160:175], a[136:139], v[104:107], v[160:175]
s_xor_b32 s69, s0, 0
ds_read_b64_tr_b16 a[128:129], v1 offset:17408
ds_read_b64_tr_b16 a[130:131], v1 offset:21760
s_add_u32 m0, s72, 104448
v_and_b32 v11, s74, v114
v_fma_f32 v10, v10, v8, -v9
v_fma_f32 v11, v11, v8, -v9
v_mfma_f32_32x32x16_bf16 v[176:191], a[140:143], v[104:107], v[176:191]
s_waitcnt lgkmcnt(6)
ds_read_b64_tr_b16 a[132:133], v1 offset:17472
ds_read_b64_tr_b16 a[134:135], v1 offset:21824
buffer_load_dwordx4 v16, s[44:47], s69 offen offset:0 lds
v_cvt_pk_bf16_f32 v114, v10, v11
v_lshlrev_b32_e64 v12, 16, v115
v_mfma_f32_32x32x16_bf16 v[192:207], a[144:147], v[104:107], v[192:207]
ds_read_b64_tr_b16 a[136:137], v1 offset:17536
ds_read_b64_tr_b16 a[138:139], v1 offset:21888
v_and_b32_e64 v13, s74, v115
v_fma_f32 v12, v12, v8, -v9
v_fma_f32 v13, v13, v8, -v9
v_cvt_pk_bf16_f32 v115, v12, v13
v_mfma_f32_32x32x16_bf16 v[208:223], a[148:151], v[104:107], v[208:223]
s_waitcnt lgkmcnt(6)
ds_read_b64_tr_b16 a[140:141], v1 offset:17600
ds_read_b64_tr_b16 a[142:143], v1 offset:21952
buffer_load_dwordx4 v17, s[44:47], s69 offen offset:1040 lds
v_lshlrev_b32 v10, 16, v116
v_mfma_f32_32x32x16_bf16 v[224:239], a[152:155], v[104:107], v[224:239]
ds_read_b64_tr_b16 a[144:145], v1 offset:17664
ds_read_b64_tr_b16 a[146:147], v1 offset:22016
v_and_b32_e64 v11, s74, v116
v_fma_f32 v10, v10, v8, -v9
v_fma_f32 v11, v11, v8, -v9
v_cvt_pk_bf16_f32 v116, v10, v11
v_mfma_f32_32x32x16_bf16 v[240:255], a[156:159], v[104:107], v[240:255]
s_waitcnt lgkmcnt(6)
ds_read_b64_tr_b16 a[148:149], v1 offset:17728
ds_read_b64_tr_b16 a[150:151], v1 offset:22080
buffer_load_dwordx4 v18, s[44:47], s69 offen offset:2080 lds
v_lshlrev_b32 v12, 16, v117
v_and_b32_e64 v13, s74, v117
v_mfma_f32_32x32x16_bf16 v[128:143], a[128:131], v[108:111], v[128:143]
s_xor_b32 s70, s0, 16384
ds_read_b64_tr_b16 a[152:153], v1 offset:17792
ds_read_b64_tr_b16 a[154:155], v1 offset:22144
v_fma_f32 v12, v12, v8, -v9
v_fma_f32 v13, v13, v8, -v9
v_cvt_pk_bf16_f32 v117, v12, v13
v_lshlrev_b32 v10, 16, v118
v_mfma_f32_32x32x16_bf16 v[144:159], a[132:135], v[108:111], v[144:159]
s_waitcnt lgkmcnt(8)
ds_read_b64_tr_b16 a[156:157], v1 offset:17856
ds_read_b64_tr_b16 a[158:159], v1 offset:22208
buffer_load_dwordx4 v19, s[44:47], s69 offen offset:3120 lds
v_and_b32_e64 v11, s74, v118
v_fma_f32 v10, v10, v8, -v9
v_mfma_f32_32x32x16_bf16 v[160:175], a[136:139], v[108:111], v[160:175]
s_waitcnt vmcnt(12) lgkmcnt(8)
s_barrier
ds_read_b64_tr_b16 a[128:129], v1 offset:34816
ds_read_b64_tr_b16 a[130:131], v1 offset:39168
s_add_u32 m0, s72, 121856
v_mfma_f32_32x32x16_bf16 v[176:191], a[140:143], v[108:111], v[176:191]
s_waitcnt lgkmcnt(6)
s_nop 0
ds_read_b64_tr_b16 a[132:133], v1 offset:34880
ds_read_b64_tr_b16 a[134:135], v1 offset:39232
buffer_load_dwordx4 v16, s[44:47], s70 offen offset:0 lds
v_fma_f32 v11, v11, v8, -v9
v_mfma_f32_32x32x16_bf16 v[192:207], a[144:147], v[108:111], v[192:207]
ds_read_b64_tr_b16 a[136:137], v1 offset:34944
ds_read_b64_tr_b16 a[138:139], v1 offset:39296
v_cvt_pk_bf16_f32 v118, v10, v11
v_lshlrev_b32_e64 v12, 16, v119
v_and_b32 v13, s74, v119
v_fma_f32 v12, v12, v8, -v9
v_mfma_f32_32x32x16_bf16 v[208:223], a[148:151], v[108:111], v[208:223]
s_waitcnt lgkmcnt(6)
ds_read_b64_tr_b16 a[140:141], v1 offset:35008
ds_read_b64_tr_b16 a[142:143], v1 offset:39360
buffer_load_dwordx4 v17, s[44:47], s70 offen offset:1040 lds
v_fma_f32 v13, v13, v8, -v9
v_cvt_pk_bf16_f32 v119, v12, v13
v_mfma_f32_32x32x16_bf16 v[224:239], a[152:155], v[108:111], v[224:239]
ds_read_b64_tr_b16 a[144:145], v1 offset:35072
ds_read_b64_tr_b16 a[146:147], v1 offset:39424
v_lshlrev_b32_e64 v10, 16, v120
v_and_b32 v11, s74, v120
v_fma_f32 v10, v10, v8, -v9
v_fma_f32 v11, v11, v8, -v9
v_mfma_f32_32x32x16_bf16 v[240:255], a[156:159], v[108:111], v[240:255]
s_waitcnt lgkmcnt(6)
ds_read_b64_tr_b16 a[148:149], v1 offset:35136
ds_read_b64_tr_b16 a[150:151], v1 offset:39488
buffer_load_dwordx4 v18, s[44:47], s70 offen offset:2080 lds
v_cvt_pk_bf16_f32 v120, v10, v11
v_lshlrev_b32_e64 v12, 16, v121
v_mfma_f32_32x32x16_bf16 v[128:143], a[128:131], v[112:115], v[128:143]
ds_read_b64_tr_b16 a[152:153], v1 offset:35200
ds_read_b64_tr_b16 a[154:155], v1 offset:39552
v_and_b32 v13, s74, v121
v_fma_f32 v12, v12, v8, -v9
v_fma_f32 v13, v13, v8, -v9
v_mfma_f32_32x32x16_bf16 v[144:159], a[132:135], v[112:115], v[144:159]
s_waitcnt lgkmcnt(6)
ds_read_b64_tr_b16 a[156:157], v1 offset:35264
ds_read_b64_tr_b16 a[158:159], v1 offset:39616
buffer_load_dwordx4 v19, s[44:47], s70 offen offset:3120 lds
v_cvt_pk_bf16_f32 v121, v12, v13
v_lshlrev_b32_e64 v10, 16, v122
v_mfma_f32_32x32x16_bf16 v[160:175], a[136:139], v[112:115], v[160:175]
s_xor_b32 s69, s0, 32768
ds_read_b64_tr_b16 a[128:129], v1 offset:52224
ds_read_b64_tr_b16 a[130:131], v1 offset:56576
s_add_u32 m0, s72, 139264
v_and_b32 v11, s74, v122
v_fma_f32 v10, v10, v8, -v9
v_fma_f32 v11, v11, v8, -v9
v_mfma_f32_32x32x16_bf16 v[176:191], a[140:143], v[112:115], v[176:191]
s_waitcnt lgkmcnt(6)
ds_read_b64_tr_b16 a[132:133], v1 offset:52288
ds_read_b64_tr_b16 a[134:135], v1 offset:56640
buffer_load_dwordx4 v16, s[44:47], s69 offen offset:0 lds
v_cvt_pk_bf16_f32 v122, v10, v11
v_lshlrev_b32_e64 v12, 16, v123
v_mfma_f32_32x32x16_bf16 v[192:207], a[144:147], v[112:115], v[192:207]
ds_read_b64_tr_b16 a[136:137], v1 offset:52352
ds_read_b64_tr_b16 a[138:139], v1 offset:56704
v_and_b32_e64 v13, s74, v123
v_fma_f32 v12, v12, v8, -v9
v_fma_f32 v13, v13, v8, -v9
v_cvt_pk_bf16_f32 v123, v12, v13
v_mfma_f32_32x32x16_bf16 v[208:223], a[148:151], v[112:115], v[208:223]
s_waitcnt lgkmcnt(6)
ds_read_b64_tr_b16 a[140:141], v1 offset:52416
ds_read_b64_tr_b16 a[142:143], v1 offset:56768
buffer_load_dwordx4 v17, s[44:47], s69 offen offset:1040 lds
v_lshlrev_b32 v10, 16, v124
v_mfma_f32_32x32x16_bf16 v[224:239], a[152:155], v[112:115], v[224:239]
ds_read_b64_tr_b16 a[144:145], v1 offset:52480
ds_read_b64_tr_b16 a[146:147], v1 offset:56832
v_and_b32_e64 v11, s74, v124
v_fma_f32 v10, v10, v8, -v9
v_fma_f32 v11, v11, v8, -v9
v_cvt_pk_bf16_f32 v124, v10, v11
v_mfma_f32_32x32x16_bf16 v[240:255], a[156:159], v[112:115], v[240:255]
s_waitcnt lgkmcnt(6)
ds_read_b64_tr_b16 a[148:149], v1 offset:52544
ds_read_b64_tr_b16 a[150:151], v1 offset:56896
buffer_load_dwordx4 v18, s[44:47], s69 offen offset:2080 lds
v_lshlrev_b32 v12, 16, v125
v_and_b32_e64 v13, s74, v125
v_mfma_f32_32x32x16_bf16 v[128:143], a[128:131], v[116:119], v[128:143]
s_xor_b32 s70, s0, 49152
ds_read_b64_tr_b16 a[152:153], v1 offset:52608
ds_read_b64_tr_b16 a[154:155], v1 offset:56960
v_fma_f32 v12, v12, v8, -v9
v_fma_f32 v13, v13, v8, -v9
v_cvt_pk_bf16_f32 v125, v12, v13
v_lshlrev_b32 v10, 16, v126
v_mfma_f32_32x32x16_bf16 v[144:159], a[132:135], v[116:119], v[144:159]
s_waitcnt lgkmcnt(8)
ds_read_b64_tr_b16 a[156:157], v1 offset:52672
ds_read_b64_tr_b16 a[158:159], v1 offset:57024
buffer_load_dwordx4 v19, s[44:47], s69 offen offset:3120 lds
v_and_b32_e64 v11, s74, v126
v_fma_f32 v10, v10, v8, -v9
v_mfma_f32_32x32x16_bf16 v[160:175], a[136:139], v[116:119], v[160:175]
s_waitcnt vmcnt(12) lgkmcnt(8)
s_barrier
ds_read_b64_tr_b16 a[128:129], v2 offset:4096
ds_read_b64_tr_b16 a[130:131], v2 offset:8448
s_add_u32 m0, s72, 0
v_mfma_f32_32x32x16_bf16 v[176:191], a[140:143], v[116:119], v[176:191]
s_waitcnt lgkmcnt(6)
ds_read_b64_tr_b16 a[132:133], v2 offset:21504
ds_read_b64_tr_b16 a[134:135], v2 offset:25856
buffer_load_dwordx4 v16, s[44:47], s70 offen offset:0 lds
v_fma_f32 v11, v11, v8, -v9
v_mfma_f32_32x32x16_bf16 v[192:207], a[144:147], v[116:119], v[192:207]
ds_read_b64_tr_b16 a[136:137], v2 offset:4160
ds_read_b64_tr_b16 a[138:139], v2 offset:8512
v_cvt_pk_bf16_f32 v126, v10, v11
v_lshlrev_b32_e64 v12, 16, v127
v_and_b32 v13, s74, v127
v_fma_f32 v12, v12, v8, -v9
v_mfma_f32_32x32x16_bf16 v[208:223], a[148:151], v[116:119], v[208:223]
s_waitcnt lgkmcnt(6)
ds_read_b64_tr_b16 a[140:141], v2 offset:21568
ds_read_b64_tr_b16 a[142:143], v2 offset:25920
buffer_load_dwordx4 v17, s[44:47], s70 offen offset:1040 lds
v_fma_f32 v13, v13, v8, -v9
v_cvt_pk_bf16_f32 v127, v12, v13
v_mfma_f32_32x32x16_bf16 v[224:239], a[152:155], v[116:119], v[224:239]
ds_read_b64_tr_b16 a[144:145], v2 offset:4224
ds_read_b64_tr_b16 a[146:147], v2 offset:8576
v_mfma_f32_32x32x16_bf16 v[240:255], a[156:159], v[116:119], v[240:255]
s_waitcnt lgkmcnt(6)
s_nop 0
ds_read_b64_tr_b16 a[148:149], v2 offset:21632
ds_read_b64_tr_b16 a[150:151], v2 offset:25984
buffer_load_dwordx4 v18, s[44:47], s70 offen offset:2080 lds
v_accvgpr_read_b32 v10, a224
v_mfma_f32_32x32x16_bf16 v[128:143], a[128:131], v[120:123], v[128:143]
ds_read_b64_tr_b16 a[152:153], v2 offset:4288
ds_read_b64_tr_b16 a[154:155], v2 offset:8640
v_accvgpr_read_b32 v11, a225
v_accvgpr_read_b32 v12, a226
v_accvgpr_read_b32 v13, a227
v_mfma_f32_32x32x16_bf16 v[128:143], a[132:135], v[124:127], v[128:143]
s_waitcnt lgkmcnt(6)
ds_read_b64_tr_b16 a[156:157], v2 offset:21696
ds_read_b64_tr_b16 a[158:159], v2 offset:26048
buffer_load_dwordx4 v19, s[44:47], s70 offen offset:3120 lds
v_rcp_f32 v14, v11
v_mfma_f32_32x32x16_bf16 v[144:159], a[136:139], v[120:123], v[144:159]
s_xor_b32 s69, s0, 0
ds_read_b64_tr_b16 a[128:129], v2 offset:4352
ds_read_b64_tr_b16 a[130:131], v2 offset:8704
s_add_u32 m0, s71, 17408
v_fma_f32 v12, -v10, s35, v12
v_mfma_f32_32x32x16_bf16 v[144:159], a[140:143], v[124:127], v[144:159]
s_waitcnt lgkmcnt(6)
ds_read_b64_tr_b16 a[132:133], v2 offset:21760
ds_read_b64_tr_b16 a[134:135], v2 offset:26112
buffer_load_dwordx4 v20, s[48:51], s69 offen offset:0 lds
v_cvt_pk_bf16_f32 v32, v128, v129
v_cvt_pk_bf16_f32 v33, v130, v131
v_cvt_pk_bf16_f32 v34, v132, v133
v_mfma_f32_32x32x16_bf16 v[160:175], a[144:147], v[120:123], v[160:175]
ds_read_b64_tr_b16 a[136:137], v2 offset:4416
ds_read_b64_tr_b16 a[138:139], v2 offset:8768
v_cvt_pk_bf16_f32 v35, v134, v135
v_cvt_pk_bf16_f32 v36, v136, v137
v_cvt_pk_bf16_f32 v37, v138, v139
v_cvt_pk_bf16_f32 v38, v140, v141
v_cvt_pk_bf16_f32 v39, v142, v143
v_mfma_f32_32x32x16_bf16 v[160:175], a[148:151], v[124:127], v[160:175]
s_waitcnt lgkmcnt(6)
s_nop 0
ds_read_b64_tr_b16 a[140:141], v2 offset:21824
ds_read_b64_tr_b16 a[142:143], v2 offset:26176
buffer_load_dwordx4 v21, s[48:51], s69 offen offset:1088 lds
v_cvt_pk_bf16_f32 v40, v144, v145
v_cvt_pk_bf16_f32 v41, v146, v147
v_cvt_pk_bf16_f32 v42, v148, v149
v_mfma_f32_32x32x16_bf16 v[176:191], a[152:155], v[120:123], v[176:191]
ds_read_b64_tr_b16 a[144:145], v2 offset:4480
ds_read_b64_tr_b16 a[146:147], v2 offset:8832
v_cvt_pk_bf16_f32 v43, v150, v151
v_cvt_pk_bf16_f32 v44, v152, v153
v_cvt_pk_bf16_f32 v45, v154, v155
v_cvt_pk_bf16_f32 v46, v156, v157
v_cvt_pk_bf16_f32 v47, v158, v159
v_mfma_f32_32x32x16_bf16 v[176:191], a[156:159], v[124:127], v[176:191]
s_waitcnt lgkmcnt(6)
s_nop 0
ds_read_b64_tr_b16 a[148:149], v2 offset:21888
ds_read_b64_tr_b16 a[150:151], v2 offset:26240
buffer_load_dwordx4 v22, s[48:51], s69 offen offset:2176 lds
v_cvt_pk_bf16_f32 v48, v160, v161
v_cvt_pk_bf16_f32 v49, v162, v163
v_cvt_pk_bf16_f32 v50, v164, v165
v_mfma_f32_32x32x16_bf16 v[192:207], a[128:131], v[120:123], v[192:207]
ds_read_b64_tr_b16 a[152:153], v2 offset:4544
ds_read_b64_tr_b16 a[154:155], v2 offset:8896
v_cvt_pk_bf16_f32 v51, v166, v167
v_cvt_pk_bf16_f32 v52, v168, v169
v_cvt_pk_bf16_f32 v53, v170, v171
v_cvt_pk_bf16_f32 v54, v172, v173
v_cvt_pk_bf16_f32 v55, v174, v175
v_mfma_f32_32x32x16_bf16 v[192:207], a[132:135], v[124:127], v[192:207]
s_waitcnt lgkmcnt(8)
s_nop 0
ds_read_b64_tr_b16 a[156:157], v2 offset:21952
ds_read_b64_tr_b16 a[158:159], v2 offset:26304
buffer_load_dwordx4 v23, s[48:51], s69 offen offset:3264 lds
v_cvt_pk_bf16_f32 v56, v176, v177
v_cvt_pk_bf16_f32 v57, v178, v179
v_cvt_pk_bf16_f32 v58, v180, v181
v_cvt_pk_bf16_f32 v59, v182, v183
v_cvt_pk_bf16_f32 v60, v184, v185
v_mfma_f32_32x32x16_bf16 v[208:223], a[136:139], v[120:123], v[208:223]
s_waitcnt vmcnt(16) lgkmcnt(8)
s_barrier
ds_read_b128 a[128:131], v25 offset:38912
v_cvt_pk_bf16_f32 v61, v186, v187
v_cvt_pk_bf16_f32 v62, v188, v189
v_cvt_pk_bf16_f32 v63, v190, v191
v_mfma_f32_32x32x16_bf16 v[208:223], a[140:143], v[124:127], v[208:223]
s_waitcnt lgkmcnt(5)
s_nop 0
ds_read_b128 a[132:135], v25 offset:38944
v_cvt_pk_bf16_f32 v64, v192, v193
v_cvt_pk_bf16_f32 v65, v194, v195
v_cvt_pk_bf16_f32 v66, v196, v197
v_cvt_pk_bf16_f32 v67, v198, v199
v_mfma_f32_32x32x16_bf16 v[224:239], a[144:147], v[120:123], v[224:239]
ds_read_b128 a[136:139], v25 offset:38976
v_cvt_pk_bf16_f32 v68, v200, v201
v_cvt_pk_bf16_f32 v69, v202, v203
v_cvt_pk_bf16_f32 v70, v204, v205
v_cvt_pk_bf16_f32 v71, v206, v207
v_mfma_f32_32x32x16_bf16 v[224:239], a[148:151], v[124:127], v[224:239]
s_waitcnt lgkmcnt(3)
s_nop 0
ds_read_b128 a[140:143], v25 offset:39008
v_cvt_pk_bf16_f32 v72, v208, v209
v_cvt_pk_bf16_f32 v73, v210, v211
v_cvt_pk_bf16_f32 v74, v212, v213
v_cvt_pk_bf16_f32 v75, v214, v215
v_mfma_f32_32x32x16_bf16 v[240:255], a[152:155], v[120:123], v[240:255]
ds_read_b128 a[144:147], v25 offset:39040
v_cvt_pk_bf16_f32 v76, v216, v217
v_cvt_pk_bf16_f32 v77, v218, v219
v_cvt_pk_bf16_f32 v78, v220, v221
v_cvt_pk_bf16_f32 v79, v222, v223
v_mfma_f32_32x32x16_bf16 v[240:255], a[156:159], v[124:127], v[240:255]
s_waitcnt lgkmcnt(3)
s_nop 0
ds_read_b128 a[148:151], v25 offset:39072
v_cvt_pk_bf16_f32 v80, v224, v225
v_cvt_pk_bf16_f32 v81, v226, v227
v_cvt_pk_bf16_f32 v82, v228, v229
v_cvt_pk_bf16_f32 v83, v230, v231
v_mfma_f32_32x32x16_bf16 v[96:111], a[128:131], v[32:35], 0
ds_read_b128 a[152:155], v25 offset:39104
v_cvt_pk_bf16_f32 v84, v232, v233
v_cvt_pk_bf16_f32 v85, v234, v235
v_cvt_pk_bf16_f32 v86, v236, v237
v_cvt_pk_bf16_f32 v87, v238, v239
v_mfma_f32_32x32x16_bf16 v[96:111], a[132:135], v[36:39], v[96:111]
s_waitcnt lgkmcnt(3)
s_nop 0
ds_read_b128 a[156:159], v25 offset:39136
v_cvt_pk_bf16_f32 v88, v240, v241
v_cvt_pk_bf16_f32 v89, v242, v243
v_cvt_pk_bf16_f32 v90, v244, v245
v_cvt_pk_bf16_f32 v91, v246, v247
v_mfma_f32_32x32x16_bf16 v[96:111], a[136:139], v[40:43], v[96:111]
ds_read_b128 a[128:131], v25 offset:39168
v_cvt_pk_bf16_f32 v92, v248, v249
v_cvt_pk_bf16_f32 v93, v250, v251
v_cvt_pk_bf16_f32 v94, v252, v253
v_cvt_pk_bf16_f32 v95, v254, v255
v_mfma_f32_32x32x16_bf16 v[96:111], a[140:143], v[44:47], v[96:111]
s_waitcnt lgkmcnt(3)
ds_read_b128 a[132:135], v25 offset:39200
v_mov_b32 v208, 0
v_lshl_add_u32 v9, v13, 3, s16
s_mov_b32 s20, 16777216
v_mul_f32_e64 v12, v12, v14
v_mfma_f32_32x32x16_bf16 v[96:111], a[144:147], v[48:51], v[96:111]
ds_read_b128 a[136:139], v25 offset:39232
buffer_store_dwordx2 v[10:11], v9, s[56:59], s20 offen sc1
v_mov_b32 v209, 0
v_mfma_f32_32x32x16_bf16 v[96:111], a[148:151], v[52:55], v[96:111]
s_waitcnt lgkmcnt(3)
ds_read_b128 a[140:143], v25 offset:39264
v_mov_b32 v210, 0
v_mov_b32 v211, 0
v_cvt_pk_bf16_f32 v12, v12, v12
v_ashrrev_i32_e64 v15, 31, v12
v_mfma_f32_32x32x16_bf16 v[96:111], a[152:155], v[56:59], v[96:111]
ds_read_b128 a[144:147], v25 offset:39296
v_mov_b32_e64 v212, 0
v_or_b32 v15, 0x80000000, v15
v_xor_b32_e64 v12, v15, v12
v_sub_u32 v14, 6143, v13
v_mfma_f32_32x32x16_bf16 v[96:111], a[156:159], v[60:63], v[96:111]
s_waitcnt lgkmcnt(3)
ds_read_b128 a[148:151], v25 offset:39328
v_mov_b32 v213, 0
v_and_or_b32 v12, v12, s74, v14
v_and_b32 v14, 63, v13
v_lshlrev_b32 v14, 4, v14
v_mfma_f32_32x32x16_bf16 v[96:111], a[128:131], v[64:67], v[96:111]
ds_read_b128 a[152:155], v25 offset:39360
v_mov_b32 v214, 0
v_add_u32 v14, 156672, v14
v_mfma_f32_32x32x16_bf16 v[96:111], a[132:135], v[68:71], v[96:111]
s_waitcnt lgkmcnt(4)
ds_read_b128 a[156:159], v25 offset:39392
ds_write_b96 v14, v[10:12]
v_mov_b32 v215, 0
v_mov_b32 v216, 0
v_mfma_f32_32x32x16_bf16 v[96:111], a[136:139], v[72:75], v[96:111]
s_waitcnt vmcnt(13) lgkmcnt(0)
s_barrier
ds_read_b128 a[128:131], v25 offset:56320
v_mfma_f32_32x32x16_bf16 v[96:111], a[140:143], v[76:79], v[96:111]
ds_read_b128 a[132:135], v25 offset:56352
v_mov_b32_e64 v217, 0
v_mfma_f32_32x32x16_bf16 v[96:111], a[144:147], v[80:83], v[96:111]
ds_read_b128 a[136:139], v25 offset:56384
v_mov_b32_e64 v218, 0
v_mfma_f32_32x32x16_bf16 v[96:111], a[148:151], v[84:87], v[96:111]
ds_read_b128 a[140:143], v25 offset:56416
v_mov_b32_e64 v219, 0
v_mfma_f32_32x32x16_bf16 v[96:111], a[152:155], v[88:91], v[96:111]
ds_read_b128 a[144:147], v25 offset:56448
v_mov_b32 v220, 0
v_mov_b32 v221, 0
v_mfma_f32_32x32x16_bf16 v[96:111], a[156:159], v[92:95], v[96:111]
s_waitcnt lgkmcnt(3)
ds_read_b128 a[148:151], v25 offset:56480
v_mov_b32 v222, 0
v_mfma_f32_32x32x16_bf16 v[112:127], a[128:131], v[32:35], 0
s_add_u32 m0, s71, 34816
ds_read_b128 a[152:155], v25 offset:56512
v_mov_b32 v223, 0
v_mfma_f32_32x32x16_bf16 v[112:127], a[132:135], v[36:39], v[112:127]
s_waitcnt lgkmcnt(3)
ds_read_b128 a[156:159], v25 offset:56544
v_exp_f32 v240, v96
v_exp_f32 v241, v97
v_mfma_f32_32x32x16_bf16 v[112:127], a[136:139], v[40:43], v[112:127]
s_xor_b32 s70, s0, 16384
ds_read_b128 a[128:131], v25 offset:56576
v_nop
v_add_f32 v31, v240, v241
v_cvt_pk_bf16_f32 v128, v240, v241
v_lshlrev_b32 v8, 4, v0
v_add_u32 v9, 156672, v8
v_mfma_f32_32x32x16_bf16 v[112:127], a[140:143], v[44:47], v[112:127]
s_waitcnt lgkmcnt(3)
ds_read_b128 a[132:135], v25 offset:56608
buffer_load_dwordx4 v20, s[48:51], s70 offen offset:0 lds
ds_read_b32 v10, v9 offset:8
v_exp_f32_e64 v242, v98
v_mfma_f32_32x32x16_bf16 v[112:127], a[144:147], v[48:51], v[112:127]
ds_read_b128 a[136:139], v25 offset:56640
v_exp_f32 v243, v99
v_add_f32 v31, v31, v242
v_add_u32_e64 v8, s16, v8
s_lshl_b32 s20, s66, 15
v_mfma_f32_32x32x16_bf16 v[112:127], a[148:151], v[52:55], v[112:127]
s_waitcnt lgkmcnt(4)
ds_read_b128 a[140:143], v25 offset:56672
buffer_load_dwordx4 v21, s[48:51], s70 offen offset:1088 lds
v_add_f32 v31, v31, v243
v_cvt_pk_bf16_f32 v129, v242, v243
s_lshl_b32 s21, s65, 10
v_mfma_f32_32x32x16_bf16 v[112:127], a[152:155], v[56:59], v[112:127]
ds_read_b128 a[144:147], v25 offset:56704
v_exp_f32 v240, v100
v_exp_f32 v241, v101
s_add_u32 s20, s20, s21
s_add_u32 s20, s20, 16908288
v_mfma_f32_32x32x16_bf16 v[112:127], a[156:159], v[60:63], v[112:127]
s_waitcnt lgkmcnt(4)
ds_read_b128 a[148:151], v25 offset:56736
buffer_load_dwordx4 v22, s[48:51], s70 offen offset:2176 lds
v_add_f32_e64 v31, v31, v240
v_mfma_f32_32x32x16_bf16 v[112:127], a[128:131], v[64:67], v[112:127]
s_xor_b32 s69, s0, 65536
ds_read_b128 a[152:155], v25 offset:56768
buffer_store_dwordx4 v[208:211], v8, s[56:59], s20 offen sc1
v_add_f32_e64 v31, v31, v241
v_cvt_pk_bf16_f32 v130, v240, v241
v_exp_f32 v242, v102
v_mfma_f32_32x32x16_bf16 v[112:127], a[132:135], v[68:71], v[112:127]
s_waitcnt lgkmcnt(4)
ds_read_b128 a[156:159], v25 offset:56800
buffer_load_dwordx4 v23, s[48:51], s70 offen offset:3264 lds
v_exp_f32_e64 v243, v103
v_mfma_f32_32x32x16_bf16 v[112:127], a[136:139], v[72:75], v[112:127]
s_waitcnt vmcnt(14) lgkmcnt(4)
s_barrier
ds_read_b128 a[128:131], v26 offset:8192
s_add_u32 m0, s72, 52224
v_mfma_f32_32x32x16_bf16 v[112:127], a[140:143], v[76:79], v[112:127]
s_waitcnt lgkmcnt(3)
ds_read_b128 a[132:135], v26 offset:8224
buffer_load_dwordx4 v16, s[44:47], s69 offen offset:0 lds
v_add_f32 v31, v31, v242
v_mov_b32_e64 v11, v10
v_mfma_f32_32x32x16_bf16 v[112:127], a[144:147], v[80:83], v[112:127]
ds_read_b128 a[136:139], v26 offset:8256
v_add_f32_e64 v31, v31, v243
v_cvt_pk_bf16_f32 v131, v242, v243
v_exp_f32_e64 v240, v104
v_max_u32_dpp v11, v11, v11 row_shr:1 bound_ctrl:0
s_nop 1
v_max_u32_dpp v11, v11, v11 row_shr:2 bound_ctrl:0
v_mfma_f32_32x32x16_bf16 v[112:127], a[148:151], v[84:87], v[112:127]
s_waitcnt lgkmcnt(3)
ds_read_b128 a[140:143], v26 offset:8288
buffer_load_dwordx4 v17, s[44:47], s69 offen offset:1040 lds
v_exp_f32_e64 v241, v105
v_max_u32_dpp v11, v11, v11 row_shr:4 bound_ctrl:0
v_mfma_f32_32x32x16_bf16 v[112:127], a[152:155], v[88:91], v[112:127]
ds_read_b128 a[144:147], v26 offset:8320
v_add_f32 v31, v31, v240
v_add_f32 v31, v31, v241
v_cvt_pk_bf16_f32 v132, v240, v241
v_max_u32_dpp v11, v11, v11 row_shr:8 bound_ctrl:0
s_nop 1
v_max_u32_dpp v11, v11, v11 row_bcast:15 row_mask:0xa
v_mfma_f32_32x32x16_bf16 v[112:127], a[156:159], v[92:95], v[112:127]
s_waitcnt lgkmcnt(3)
ds_read_b128 a[148:151], v26 offset:8352
buffer_load_dwordx4 v18, s[44:47], s69 offen offset:2080 lds
v_exp_f32_e64 v242, v106
v_max_u32_dpp v11, v11, v11 row_bcast:31 row_mask:0xc
v_mfma_f32_32x32x16_bf16 v[176:191], a[128:131], v[32:35], 0
ds_read_b128 a[152:155], v26 offset:8384
v_exp_f32 v243, v107
v_add_f32 v31, v31, v242
v_readlane_b32 s60, v11, 63
s_nop 1
v_cmp_ne_u32 s[18:19], s60, v10
v_mfma_f32_32x32x16_bf16 v[176:191], a[132:135], v[36:39], v[176:191]
s_waitcnt lgkmcnt(3)
ds_read_b128 a[156:159], v26 offset:8416
buffer_load_dwordx4 v19, s[44:47], s69 offen offset:3120 lds
v_add_f32 v31, v31, v243
v_cndmask_b32 v11, 0, v10, s[18:19]
s_nop 1
v_max_u32_dpp v11, v11, v11 row_shr:1 bound_ctrl:0
v_mfma_f32_32x32x16_bf16 v[176:191], a[136:139], v[40:43], v[176:191]
s_xor_b32 s70, s0, 81920
ds_read_b128 a[128:131], v26 offset:8448
s_add_u32 m0, s72, 69632
v_cvt_pk_bf16_f32 v133, v242, v243
v_exp_f32 v240, v108
v_max_u32_dpp v11, v11, v11 row_shr:2 bound_ctrl:0
v_mfma_f32_32x32x16_bf16 v[176:191], a[140:143], v[44:47], v[176:191]
s_waitcnt lgkmcnt(3)
ds_read_b128 a[132:135], v26 offset:8480
buffer_load_dwordx4 v16, s[44:47], s70 offen offset:0 lds
v_exp_f32 v241, v109
v_max_u32_dpp v11, v11, v11 row_shr:4 bound_ctrl:0
s_nop 1
v_max_u32_dpp v11, v11, v11 row_shr:8 bound_ctrl:0
v_mfma_f32_32x32x16_bf16 v[176:191], a[144:147], v[48:51], v[176:191]
ds_read_b128 a[136:139], v26 offset:8512
v_add_f32 v31, v31, v240
v_add_f32 v31, v31, v241
v_cvt_pk_bf16_f32 v134, v240, v241
v_max_u32_dpp v11, v11, v11 row_bcast:15 row_mask:0xa
s_nop 1
v_max_u32_dpp v11, v11, v11 row_bcast:31 row_mask:0xc
v_mfma_f32_32x32x16_bf16 v[176:191], a[148:151], v[52:55], v[176:191]
s_waitcnt lgkmcnt(3)
ds_read_b128 a[140:143], v26 offset:8544
buffer_load_dwordx4 v17, s[44:47], s70 offen offset:1040 lds
v_exp_f32_e64 v242, v110
v_readlane_b32 s61, v11, 63
v_mfma_f32_32x32x16_bf16 v[176:191], a[152:155], v[56:59], v[176:191]
ds_read_b128 a[144:147], v26 offset:8576
v_exp_f32_e64 v243, v111
v_add_f32 v31, v31, v242
s_and_b32 s20, s60, 63
s_and_b32 s21, s61, 63
v_mfma_f32_32x32x16_bf16 v[176:191], a[156:159], v[60:63], v[176:191]
s_waitcnt lgkmcnt(3)
ds_read_b128 a[148:151], v26 offset:8608
buffer_load_dwordx4 v18, s[44:47], s70 offen offset:2080 lds
v_add_f32 v31, v31, v243
v_cvt_pk_bf16_f32 v135, v242, v243
s_lshl_b32 s21, s21, 6
v_mfma_f32_32x32x16_bf16 v[176:191], a[128:131], v[64:67], v[176:191]
s_xor_b32 s69, s0, 32768
ds_read_b128 a[152:155], v26 offset:8640
v_exp_f32 v240, v112
v_exp_f32 v241, v113
s_or_b32 s20, s20, s21
v_mfma_f32_32x32x16_bf16 v[176:191], a[132:135], v[68:71], v[176:191]
s_waitcnt lgkmcnt(4)
ds_read_b128 a[156:159], v26 offset:8672
buffer_load_dwordx4 v19, s[44:47], s70 offen offset:3120 lds
v_add_f32 v31, v31, v240
v_add_f32 v31, v31, v241
s_lshl_b32 s20, s20, 1
s_or_b32 s20, s20, s33
v_mfma_f32_32x32x16_bf16 v[176:191], a[136:139], v[72:75], v[176:191]
s_waitcnt vmcnt(18) lgkmcnt(4)
s_barrier
ds_read_b128 a[128:131], v24 offset:0
s_add_u32 m0, s71, 87040
v_mfma_f32_32x32x16_bf16 v[176:191], a[140:143], v[76:79], v[176:191]
s_waitcnt lgkmcnt(3)
ds_read_b128 a[132:135], v24 offset:32
buffer_load_dwordx4 v20, s[48:51], s69 offen offset:0 lds
v_cvt_pk_bf16_f32 v136, v240, v241
v_exp_f32 v242, v114
v_mfma_f32_32x32x16_bf16 v[176:191], a[144:147], v[80:83], v[176:191]
ds_read_b128 a[136:139], v24 offset:64
v_exp_f32_e64 v243, v115
v_add_f32 v31, v31, v242
s_lshr_b32 s33, s32, 3
s_mul_i32 s33, s33, 6
v_mfma_f32_32x32x16_bf16 v[176:191], a[148:151], v[84:87], v[176:191]
s_waitcnt lgkmcnt(3)
ds_read_b128 a[140:143], v24 offset:96
buffer_load_dwordx4 v21, s[48:51], s69 offen offset:1088 lds
v_add_f32 v31, v31, v243
v_cvt_pk_bf16_f32 v137, v242, v243
s_lshr_b32 s21, s61, 16
v_mfma_f32_32x32x16_bf16 v[176:191], a[152:155], v[88:91], v[176:191]
ds_read_b128 a[144:147], v24 offset:128
v_exp_f32_e64 v240, v116
v_exp_f32 v241, v117
s_and_b32 s60, s60, s74
s_or_b32 s21, s21, s60
v_mfma_f32_32x32x16_bf16 v[176:191], a[156:159], v[92:95], v[176:191]
s_waitcnt lgkmcnt(3)
ds_read_b128 a[148:151], v24 offset:160
buffer_load_dwordx4 v22, s[48:51], s69 offen offset:2176 lds
v_add_f32 v31, v31, v240
v_add_f32 v31, v31, v241
v_mov_b32_e64 v10, s20
v_mfma_f32_32x32x16_bf16 v[192:207], a[128:131], v[32:35], 0
ds_read_b128 a[152:155], v24 offset:192
v_cvt_pk_bf16_f32 v138, v240, v241
v_exp_f32_e64 v242, v118
v_exp_f32 v243, v119
v_mfma_f32_32x32x16_bf16 v[192:207], a[132:135], v[36:39], v[192:207]
s_waitcnt lgkmcnt(3)
ds_read_b128 a[156:159], v24 offset:224
buffer_load_dwordx4 v23, s[48:51], s69 offen offset:3264 lds
v_add_f32 v31, v31, v242
v_mov_b32 v11, s21
v_accvgpr_read_b32 v9, a228
v_mfma_f32_32x32x16_bf16 v[192:207], a[136:139], v[40:43], v[192:207]
s_xor_b32 s70, s0, 49152
ds_read_b128 a[128:131], v24 offset:256
s_add_u32 m0, s71, 104448
v_add_f32_e64 v31, v31, v243
v_cvt_pk_bf16_f32 v139, v242, v243
v_exp_f32 v240, v120
v_mfma_f32_32x32x16_bf16 v[192:207], a[140:143], v[44:47], v[192:207]
s_waitcnt lgkmcnt(3)
ds_read_b128 a[132:135], v24 offset:288
buffer_load_dwordx4 v20, s[48:51], s70 offen offset:0 lds
v_exp_f32_e64 v241, v121
v_mfma_f32_32x32x16_bf16 v[192:207], a[144:147], v[48:51], v[192:207]
ds_read_b128 a[136:139], v24 offset:320
v_add_f32 v31, v31, v240
v_add_f32 v31, v31, v241
v_cvt_pk_bf16_f32 v140, v240, v241
v_mfma_f32_32x32x16_bf16 v[192:207], a[148:151], v[52:55], v[192:207]
s_waitcnt lgkmcnt(3)
ds_read_b128 a[140:143], v24 offset:352
buffer_load_dwordx4 v21, s[48:51], s70 offen offset:1088 lds
v_exp_f32 v242, v122
v_mfma_f32_32x32x16_bf16 v[192:207], a[152:155], v[56:59], v[192:207]
ds_read_b128 a[144:147], v24 offset:384
v_exp_f32 v243, v123
v_add_f32 v31, v31, v242
v_add_f32 v31, v31, v243
v_cvt_pk_bf16_f32 v141, v242, v243
v_mfma_f32_32x32x16_bf16 v[192:207], a[156:159], v[60:63], v[192:207]
s_waitcnt lgkmcnt(3)
ds_read_b128 a[148:151], v24 offset:416
buffer_load_dwordx4 v22, s[48:51], s70 offen offset:2176 lds
v_exp_f32_e64 v240, v124
v_mfma_f32_32x32x16_bf16 v[192:207], a[128:131], v[64:67], v[192:207]
s_xor_b32 s69, s0, 98304
ds_read_b128 a[152:155], v24 offset:448
v_exp_f32 v241, v125
v_add_f32 v31, v31, v240
v_add_f32 v31, v31, v241
v_mfma_f32_32x32x16_bf16 v[192:207], a[132:135], v[68:71], v[192:207]
s_waitcnt lgkmcnt(4)
ds_read_b128 a[156:159], v24 offset:480
buffer_load_dwordx4 v23, s[48:51], s70 offen offset:3264 lds
v_cvt_pk_bf16_f32 v142, v240, v241
v_mfma_f32_32x32x16_bf16 v[192:207], a[136:139], v[72:75], v[192:207]
s_waitcnt vmcnt(17) lgkmcnt(4)
s_barrier
ds_read_b64_tr_b16 a[128:129], v27 offset:17408
ds_read_b64_tr_b16 a[130:131], v27 offset:21760
s_add_u32 m0, s72, 121856
v_mfma_f32_32x32x16_bf16 v[192:207], a[140:143], v[76:79], v[192:207]
s_waitcnt lgkmcnt(4)
ds_read_b64_tr_b16 a[132:133], v27 offset:17472
ds_read_b64_tr_b16 a[134:135], v27 offset:21824
buffer_load_dwordx4 v16, s[44:47], s69 offen offset:0 lds
buffer_store_dwordx2 v[10:11], v9, s[8:11], 0 offen sc1
v_exp_f32 v242, v126
v_mfma_f32_32x32x16_bf16 v[192:207], a[144:147], v[80:83], v[192:207]
ds_read_b64_tr_b16 a[136:137], v27 offset:17536
ds_read_b64_tr_b16 a[138:139], v27 offset:21888
v_exp_f32 v243, v127
v_add_f32 v31, v31, v242
s_mov_b32 s40, s22
v_mfma_f32_32x32x16_bf16 v[192:207], a[148:151], v[84:87], v[192:207]
s_waitcnt lgkmcnt(6)
ds_read_b64_tr_b16 a[140:141], v27 offset:17600
ds_read_b64_tr_b16 a[142:143], v27 offset:21952
buffer_load_dwordx4 v17, s[44:47], s69 offen offset:1040 lds
v_add_f32 v31, v31, v243
s_mov_b32 s41, s23
v_mfma_f32_32x32x16_bf16 v[192:207], a[152:155], v[88:91], v[192:207]
ds_read_b64_tr_b16 a[144:145], v27 offset:17664
ds_read_b64_tr_b16 a[146:147], v27 offset:22016
v_cvt_pk_bf16_f32 v143, v242, v243
v_cmp_nge_f32 vcc, 0x47800000, v31
v_cmp_gt_f32 s[4:5], s6, v31
s_mov_b32 s42, s14
v_mfma_f32_32x32x16_bf16 v[192:207], a[156:159], v[92:95], v[192:207]
s_or_b64 vcc, vcc, s[4:5]
s_cbranch_vccnz recurrent_scan__sliding_block_cached__moe_arch_mod__prompt_kernel_stub0
recurrent_scan__sliding_block_cached__moe_arch_mod__prompt_kernel_back0:
s_waitcnt lgkmcnt(6)
ds_read_b64_tr_b16 a[148:149], v27 offset:17728
ds_read_b64_tr_b16 a[150:151], v27 offset:22080
buffer_load_dwordx4 v18, s[44:47], s69 offen offset:2080 lds
v_add_f32_e64 v30, v30, v31
v_mfma_f32_32x32x16_bf16 a[0:15], a[128:131], v[128:131], 0
ds_read_b64_tr_b16 a[152:153], v27 offset:17792
ds_read_b64_tr_b16 a[154:155], v27 offset:22144
v_exp_f32 v240, v176
v_exp_f32 v241, v177
v_mfma_f32_32x32x16_bf16 a[16:31], a[132:135], v[128:131], 0
s_waitcnt lgkmcnt(6)
ds_read_b64_tr_b16 a[156:157], v27 offset:17856
ds_read_b64_tr_b16 a[158:159], v27 offset:22208
buffer_load_dwordx4 v19, s[44:47], s69 offen offset:3120 lds
v_nop
v_mfma_f32_32x32x16_bf16 a[32:47], a[136:139], v[128:131], 0
s_xor_b32 s70, s0, 114688
ds_read_b64_tr_b16 a[128:129], v27 offset:26112
ds_read_b64_tr_b16 a[130:131], v27 offset:30464
s_add_u32 m0, s72, 139264
v_add_f32_e64 v31, v240, v241
v_cvt_pk_bf16_f32 v144, v240, v241
s_mov_b32 s26, s14
v_mfma_f32_32x32x16_bf16 a[48:63], a[140:143], v[128:131], 0
s_waitcnt lgkmcnt(6)
ds_read_b64_tr_b16 a[132:133], v27 offset:26176
ds_read_b64_tr_b16 a[134:135], v27 offset:30528
buffer_load_dwordx4 v16, s[44:47], s70 offen offset:0 lds
v_exp_f32_e64 v242, v178
v_mfma_f32_32x32x16_bf16 a[64:79], a[144:147], v[128:131], 0
ds_read_b64_tr_b16 a[136:137], v27 offset:26240
ds_read_b64_tr_b16 a[138:139], v27 offset:30592
v_exp_f32 v243, v179
v_add_f32 v31, v31, v242
v_add_f32 v31, v31, v243
v_mfma_f32_32x32x16_bf16 a[80:95], a[148:151], v[128:131], 0
s_waitcnt lgkmcnt(6)
ds_read_b64_tr_b16 a[140:141], v27 offset:26304
ds_read_b64_tr_b16 a[142:143], v27 offset:30656
buffer_load_dwordx4 v17, s[44:47], s70 offen offset:1040 lds
v_cvt_pk_bf16_f32 v145, v242, v243
s_mov_b32 s27, 0x20000
v_mfma_f32_32x32x16_bf16 a[96:111], a[152:155], v[128:131], 0
ds_read_b64_tr_b16 a[144:145], v27 offset:26368
ds_read_b64_tr_b16 a[146:147], v27 offset:30720
v_exp_f32_e64 v240, v180
v_exp_f32 v241, v181
v_mfma_f32_32x32x16_bf16 a[112:127], a[156:159], v[128:131], 0
s_waitcnt lgkmcnt(6)
ds_read_b64_tr_b16 a[148:149], v27 offset:26432
ds_read_b64_tr_b16 a[150:151], v27 offset:30784
buffer_load_dwordx4 v18, s[44:47], s70 offen offset:2080 lds
v_add_f32 v31, v31, v240
v_add_f32 v31, v31, v241
v_mfma_f32_32x32x16_bf16 a[0:15], a[128:131], v[132:135], a[0:15]
s_xor_b32 s69, s0, 65536
ds_read_b64_tr_b16 a[152:153], v27 offset:26496
ds_read_b64_tr_b16 a[154:155], v27 offset:30848
v_cvt_pk_bf16_f32 v146, v240, v241
v_exp_f32_e64 v242, v182
s_lshl_b32 s20, s66, 6
v_mfma_f32_32x32x16_bf16 a[16:31], a[132:135], v[132:135], a[16:31]
s_waitcnt lgkmcnt(8)
ds_read_b64_tr_b16 a[156:157], v27 offset:26560
ds_read_b64_tr_b16 a[158:159], v27 offset:30912
buffer_load_dwordx4 v19, s[44:47], s70 offen offset:3120 lds
v_exp_f32_e64 v243, v183
v_mfma_f32_32x32x16_bf16 a[32:47], a[136:139], v[132:135], a[32:47]
s_waitcnt vmcnt(25) lgkmcnt(8)
s_barrier
ds_read_b64_tr_b16 a[128:129], v27 offset:34816
ds_read_b64_tr_b16 a[130:131], v27 offset:39168
s_add_u32 m0, s71, 0
v_mfma_f32_32x32x16_bf16 a[48:63], a[140:143], v[132:135], a[48:63]
s_waitcnt lgkmcnt(6)
ds_read_b64_tr_b16 a[132:133], v27 offset:34880
ds_read_b64_tr_b16 a[134:135], v27 offset:39232
buffer_load_dwordx4 v20, s[48:51], s69 offen offset:0 lds
v_add_f32 v31, v31, v242
v_add_u32 v12, s20, v0
v_mfma_f32_32x32x16_bf16 a[64:79], a[144:147], v[132:135], a[64:79]
ds_read_b64_tr_b16 a[136:137], v27 offset:34944
ds_read_b64_tr_b16 a[138:139], v27 offset:39296
v_add_f32_e64 v31, v31, v243
v_cvt_pk_bf16_f32 v147, v242, v243
v_exp_f32 v240, v184
v_mfma_f32_32x32x16_bf16 a[80:95], a[148:151], v[132:135], a[80:95]
s_waitcnt lgkmcnt(6)
ds_read_b64_tr_b16 a[140:141], v27 offset:35008
ds_read_b64_tr_b16 a[142:143], v27 offset:39360
buffer_load_dwordx4 v21, s[48:51], s69 offen offset:1088 lds
v_exp_f32_e64 v241, v185
v_mfma_f32_32x32x16_bf16 a[96:111], a[152:155], v[132:135], a[96:111]
ds_read_b64_tr_b16 a[144:145], v27 offset:35072
ds_read_b64_tr_b16 a[146:147], v27 offset:39424
v_add_f32 v31, v31, v240
v_add_f32 v31, v31, v241
v_cvt_pk_bf16_f32 v148, v240, v241
v_mul_u32_u24 v238, 3584, v12
v_mfma_f32_32x32x16_bf16 a[112:127], a[156:159], v[132:135], a[112:127]
s_waitcnt lgkmcnt(6)
ds_read_b64_tr_b16 a[148:149], v27 offset:35136
ds_read_b64_tr_b16 a[150:151], v27 offset:39488
buffer_load_dwordx4 v22, s[48:51], s69 offen offset:2176 lds
v_exp_f32 v242, v186
v_mfma_f32_32x32x16_bf16 a[0:15], a[128:131], v[136:139], a[0:15]
ds_read_b64_tr_b16 a[152:153], v27 offset:35200
ds_read_b64_tr_b16 a[154:155], v27 offset:39552
v_exp_f32_e64 v243, v187
v_add_f32 v31, v31, v242
v_add_u32 v239, 917504, v238
v_mfma_f32_32x32x16_bf16 a[16:31], a[132:135], v[136:139], a[16:31]
s_waitcnt lgkmcnt(6)
ds_read_b64_tr_b16 a[156:157], v27 offset:35264
ds_read_b64_tr_b16 a[158:159], v27 offset:39616
buffer_load_dwordx4 v23, s[48:51], s69 offen offset:3264 lds
v_add_f32_e64 v31, v31, v243
v_cvt_pk_bf16_f32 v149, v242, v243
v_mfma_f32_32x32x16_bf16 a[32:47], a[136:139], v[136:139], a[32:47]
s_xor_b32 s70, s0, 81920
ds_read_b64_tr_b16 a[128:129], v27 offset:43520
ds_read_b64_tr_b16 a[130:131], v27 offset:47872
s_add_u32 m0, s71, 17408
v_exp_f32 v240, v188
v_mfma_f32_32x32x16_bf16 a[48:63], a[140:143], v[136:139], a[48:63]
s_waitcnt lgkmcnt(6)
ds_read_b64_tr_b16 a[132:133], v27 offset:43584
ds_read_b64_tr_b16 a[134:135], v27 offset:47936
buffer_load_dwordx4 v20, s[48:51], s70 offen offset:0 lds
v_exp_f32_e64 v241, v189
v_mfma_f32_32x32x16_bf16 a[64:79], a[144:147], v[136:139], a[64:79]
ds_read_b64_tr_b16 a[136:137], v27 offset:43648
ds_read_b64_tr_b16 a[138:139], v27 offset:48000
v_add_f32 v31, v31, v240
v_add_f32 v31, v31, v241
v_cvt_pk_bf16_f32 v150, v240, v241
v_add_u32 v13, 256, v12
v_mfma_f32_32x32x16_bf16 a[80:95], a[148:151], v[136:139], a[80:95]
s_waitcnt lgkmcnt(6)
ds_read_b64_tr_b16 a[140:141], v27 offset:43712
ds_read_b64_tr_b16 a[142:143], v27 offset:48064
buffer_load_dwordx4 v21, s[48:51], s70 offen offset:1088 lds
v_exp_f32 v242, v190
v_mfma_f32_32x32x16_bf16 a[96:111], a[152:155], v[136:139], a[96:111]
ds_read_b64_tr_b16 a[144:145], v27 offset:43776
ds_read_b64_tr_b16 a[146:147], v27 offset:48128
v_exp_f32_e64 v243, v191
v_add_f32 v31, v31, v242
v_min_u32 v13, 447, v13
v_mfma_f32_32x32x16_bf16 a[112:127], a[156:159], v[136:139], a[112:127]
s_waitcnt lgkmcnt(6)
ds_read_b64_tr_b16 a[148:149], v27 offset:43840
ds_read_b64_tr_b16 a[150:151], v27 offset:48192
buffer_load_dwordx4 v22, s[48:51], s70 offen offset:2176 lds
v_add_f32_e64 v31, v31, v243
v_cvt_pk_bf16_f32 v151, v242, v243
v_mfma_f32_32x32x16_bf16 a[0:15], a[128:131], v[140:143], a[0:15]
ds_read_b64_tr_b16 a[152:153], v27 offset:43904
ds_read_b64_tr_b16 a[154:155], v27 offset:48256
v_exp_f32 v240, v192
v_min_u32 v252, 27, v0
v_lshlrev_b32 v12, 1, v12
v_mfma_f32_32x32x16_bf16 a[16:31], a[132:135], v[140:143], a[16:31]
s_waitcnt lgkmcnt(8)
ds_read_b64_tr_b16 a[156:157], v27 offset:43968
ds_read_b64_tr_b16 a[158:159], v27 offset:48320
buffer_load_dwordx4 v23, s[48:51], s70 offen offset:3264 lds
v_lshrrev_b32 v254, 2, v252
v_lshlrev_b32 v13, 1, v13
v_mfma_f32_32x32x16_bf16 a[32:47], a[136:139], v[140:143], a[32:47]
s_waitcnt vmcnt(25) lgkmcnt(8)
s_barrier
ds_read_b128 a[128:131], v24 offset:52224
s_add_u32 m0, s72, 34816
v_mfma_f32_32x32x16_bf16 a[48:63], a[140:143], v[140:143], a[48:63]
s_waitcnt lgkmcnt(5)
ds_read_b128 a[132:135], v24 offset:52256
v_exp_f32 v241, v193
v_add_f32 v31, v31, v240
v_lshrrev_b32 v8, 1, v0
v_sub_u32 v15, 95, v8
v_mfma_f32_32x32x16_bf16 a[64:79], a[144:147], v[140:143], a[64:79]
s_xor_b32 s69, s0, 131072
ds_read_b128 a[136:139], v24 offset:52288
buffer_load_dwordx4 v16, s[44:47], s69 offen offset:0 lds
v_add_f32_e64 v31, v31, v241
v_mul_u32_u24 v254, 3584, v254
v_lshlrev_b32 v8, 3, v8
v_mfma_f32_32x32x16_bf16 a[80:95], a[148:151], v[140:143], a[80:95]
s_waitcnt lgkmcnt(3)
ds_read_b128 a[140:143], v24 offset:52320
buffer_load_dwordx4 v17, s[44:47], s69 offen offset:1040 lds
v_and_b32_e64 v252, 3, v252
v_lshl_add_u32 v252, v252, 7, v254
v_mfma_f32_32x32x16_bf16 a[96:111], a[152:155], v[140:143], a[96:111]
ds_read_b128 a[144:147], v24 offset:52352
v_cvt_pk_bf16_f32 v152, v240, v241
v_exp_f32 v242, v194
v_add_u32 v252, s76, v252
v_lshlrev_b32 v15, 6, v15
v_mfma_f32_32x32x16_bf16 a[112:127], a[156:159], v[140:143], a[112:127]
s_waitcnt lgkmcnt(3)
ds_read_b128 a[148:151], v24 offset:52384
buffer_load_dwordx4 v18, s[44:47], s69 offen offset:2080 lds
v_exp_f32 v243, v195
v_and_b32 v9, 1, v0
v_mfma_f32_32x32x16_bf16 v[96:111], a[128:131], v[32:35], v[208:223]
s_cmp_eq_u32 s67, 0
s_cselect_b64 s[30:31], s[22:23], s[24:25]
ds_read_b128 a[152:155], v24 offset:52416
v_add_f32 v31, v31, v242
v_add_f32 v31, v31, v243
v_mad_u32_u24 v14, v9, 6, 1
v_lshlrev_b32 v9, 4, v9
v_mfma_f32_32x32x16_bf16 v[96:111], a[132:135], v[36:39], v[96:111]
s_waitcnt lgkmcnt(3)
ds_read_b128 a[156:159], v24 offset:52448
buffer_load_dwordx4 v19, s[44:47], s69 offen offset:3120 lds
v_cvt_pk_bf16_f32 v153, v242, v243
v_mfma_f32_32x32x16_bf16 v[96:111], a[136:139], v[40:43], v[96:111]
ds_read_b128 a[128:131], v24 offset:52480
global_load_dword a255, v252, s[30:31]
v_exp_f32 v240, v196
v_mfma_f32_32x32x16_bf16 v[96:111], a[140:143], v[44:47], v[96:111]
s_waitcnt lgkmcnt(3)
ds_read_b128 a[132:135], v24 offset:52512
v_exp_f32 v241, v197
v_add_f32 v31, v31, v240
v_add_f32_e64 v31, v31, v241
v_mfma_f32_32x32x16_bf16 v[96:111], a[144:147], v[48:51], v[96:111]
ds_read_b128 a[136:139], v24 offset:52544
v_cvt_pk_bf16_f32 v154, v240, v241
v_exp_f32 v242, v198
v_mfma_f32_32x32x16_bf16 v[96:111], a[148:151], v[52:55], v[96:111]
s_waitcnt lgkmcnt(3)
ds_read_b128 a[140:143], v24 offset:52576
v_exp_f32 v243, v199
v_lshlrev_b32 v253, 4, v0
v_mfma_f32_32x32x16_bf16 v[96:111], a[152:155], v[56:59], v[96:111]
ds_read_b128 a[144:147], v24 offset:52608
v_add_f32 v31, v31, v242
v_add_f32 v31, v31, v243
v_cvt_pk_bf16_f32 v155, v242, v243
v_add_u32 v253, s7, v253
v_mfma_f32_32x32x16_bf16 v[96:111], a[156:159], v[60:63], v[96:111]
s_waitcnt lgkmcnt(3)
ds_read_b128 a[148:151], v24 offset:52640
v_exp_f32 v240, v200
v_exp_f32 v241, v201
v_mfma_f32_32x32x16_bf16 v[96:111], a[128:131], v[64:67], v[96:111]
ds_read_b128 a[152:155], v24 offset:52672
v_add_f32 v31, v31, v240
v_add_f32 v31, v31, v241
v_lshl_add_u32 v246, v0, 2, s7
v_mfma_f32_32x32x16_bf16 v[96:111], a[132:135], v[68:71], v[96:111]
s_waitcnt lgkmcnt(3)
ds_read_b128 a[156:159], v24 offset:52704
v_cvt_pk_bf16_f32 v156, v240, v241
v_exp_f32 v242, v202
v_lshrrev_b32_e64 v245, 2, v0
v_mfma_f32_32x32x16_bf16 v[96:111], a[136:139], v[72:75], v[96:111]
ds_read_b128 a[128:131], v25 offset:4096
v_exp_f32 v243, v203
v_add_f32 v31, v31, v242
v_mfma_f32_32x32x16_bf16 v[96:111], a[140:143], v[76:79], v[96:111]
s_waitcnt lgkmcnt(3)
ds_read_b128 a[132:135], v25 offset:4128
v_add_f32 v31, v31, v243
v_cvt_pk_bf16_f32 v157, v242, v243
s_and_b32 s76, s32, 7
v_add_u32 v244, s76, v245
v_mfma_f32_32x32x16_bf16 v[96:111], a[144:147], v[80:83], v[96:111]
ds_read_b128 a[136:139], v25 offset:4160
v_exp_f32 v240, v204
v_exp_f32 v241, v205
v_mfma_f32_32x32x16_bf16 v[96:111], a[148:151], v[84:87], v[96:111]
s_waitcnt lgkmcnt(3)
ds_read_b128 a[140:143], v25 offset:4192
v_add_f32 v31, v31, v240
v_add_f32 v31, v31, v241
v_subrev_u32 v247, 7, v244
v_mfma_f32_32x32x16_bf16 v[96:111], a[152:155], v[88:91], v[96:111]
ds_read_b128 a[144:147], v25 offset:4224
v_cvt_pk_bf16_f32 v158, v240, v241
v_exp_f32 v242, v206
v_min_u32 v244, v244, v247
v_mfma_f32_32x32x16_bf16 v[96:111], a[156:159], v[92:95], v[96:111]
s_waitcnt lgkmcnt(3)
ds_read_b128 a[148:151], v25 offset:4256
v_exp_f32 v243, v207
v_add_f32_e64 v31, v31, v242
v_mfma_f32_32x32x16_bf16 v[112:127], a[128:131], v[32:35], v[208:223]
ds_read_b128 a[152:155], v25 offset:4288
v_add_f32_e64 v31, v31, v243
v_cvt_pk_bf16_f32 v159, v242, v243
v_cmp_nge_f32 vcc, 0x47800000, v31
v_mfma_f32_32x32x16_bf16 v[112:127], a[132:135], v[36:39], v[112:127]
s_cbranch_vccnz recurrent_scan__sliding_block_cached__moe_arch_mod__prompt_kernel_stub1
recurrent_scan__sliding_block_cached__moe_arch_mod__prompt_kernel_back1:
s_waitcnt lgkmcnt(3)
ds_read_b128 a[156:159], v25 offset:4320
v_add_f32 v30, v30, v31
v_exp_f32 v240, v96
v_mfma_f32_32x32x16_bf16 v[112:127], a[136:139], v[40:43], v[112:127]
ds_read_b128 a[128:131], v25 offset:4352
v_exp_f32 v241, v97
v_max_u32 v245, s33, v245
v_mad_u32_u24 v245, v244, 7, v245
v_mfma_f32_32x32x16_bf16 v[112:127], a[140:143], v[44:47], v[112:127]
s_waitcnt lgkmcnt(3)
ds_read_b128 a[132:135], v25 offset:4384
v_nop
v_add_f32_e64 v31, v240, v241
v_cvt_pk_bf16_f32 v128, v240, v241
v_mfma_f32_32x32x16_bf16 v[112:127], a[144:147], v[48:51], v[112:127]
ds_read_b128 a[136:139], v25 offset:4416
v_exp_f32 v242, v98
v_exp_f32 v243, v99
v_mfma_f32_32x32x16_bf16 v[112:127], a[148:151], v[52:55], v[112:127]
s_waitcnt lgkmcnt(3)
ds_read_b128 a[140:143], v25 offset:4448
v_add_f32 v31, v31, v242
v_add_f32_e64 v31, v31, v243
v_cvt_pk_bf16_f32 v129, v242, v243
v_mul_u32_u24 v245, 9216, v245
v_mfma_f32_32x32x16_bf16 v[112:127], a[152:155], v[56:59], v[112:127]
ds_read_b128 a[144:147], v25 offset:4480
v_exp_f32 v240, v100
v_and_b32 v247, 3, v0
v_mfma_f32_32x32x16_bf16 v[112:127], a[156:159], v[60:63], v[112:127]
s_waitcnt lgkmcnt(3)
ds_read_b128 a[148:151], v25 offset:4512
v_exp_f32 v241, v101
v_add_f32 v31, v31, v240
v_add_f32 v31, v31, v241
v_mfma_f32_32x32x16_bf16 v[112:127], a[128:131], v[64:67], v[112:127]
s_add_u32 m0, s72, 52224
ds_read_b128 a[152:155], v25 offset:4544
v_cvt_pk_bf16_f32 v130, v240, v241
v_exp_f32_e64 v242, v102
v_mul_u32_u24 v247, 57344, v247
v_mfma_f32_32x32x16_bf16 v[112:127], a[132:135], v[68:71], v[112:127]
s_waitcnt lgkmcnt(4)
ds_read_b128 a[156:159], v25 offset:4576
v_exp_f32 v243, v103
v_add_f32_e64 v31, v31, v242
v_mfma_f32_32x32x16_bf16 v[112:127], a[136:139], v[72:75], v[112:127]
s_waitcnt vmcnt(22) lgkmcnt(4)
s_barrier
ds_read_b64_tr_b16 a[128:129], v28 offset:21504
ds_read_b64_tr_b16 a[130:131], v28 offset:25856
v_mfma_f32_32x32x16_bf16 v[112:127], a[140:143], v[76:79], v[112:127]
s_waitcnt lgkmcnt(4)
ds_read_b64_tr_b16 a[132:133], v28 offset:21568
ds_read_b64_tr_b16 a[134:135], v28 offset:25920
v_add_f32 v31, v31, v243
v_cvt_pk_bf16_f32 v131, v242, v243
v_lshl_add_u32 v244, v244, 7, v247
v_mfma_f32_32x32x16_bf16 v[112:127], a[144:147], v[80:83], v[112:127]
s_xor_b32 s70, s0, 147456
ds_read_b64_tr_b16 a[136:137], v28 offset:21632
ds_read_b64_tr_b16 a[138:139], v28 offset:25984
buffer_load_dwordx4 v16, s[44:47], s70 offen offset:0 lds
v_mfma_f32_32x32x16_bf16 v[112:127], a[148:151], v[84:87], v[112:127]
s_waitcnt lgkmcnt(6)
s_nop 0
ds_read_b64_tr_b16 a[140:141], v28 offset:21696
ds_read_b64_tr_b16 a[142:143], v28 offset:26048
buffer_load_dwordx4 v17, s[44:47], s70 offen offset:1040 lds
v_mfma_f32_32x32x16_bf16 v[112:127], a[152:155], v[88:91], v[112:127]
ds_read_b64_tr_b16 a[144:145], v28 offset:21760
ds_read_b64_tr_b16 a[146:147], v28 offset:26112
v_exp_f32 v240, v104
v_mfma_f32_32x32x16_bf16 v[112:127], a[156:159], v[92:95], v[112:127]
s_waitcnt lgkmcnt(6)
ds_read_b64_tr_b16 a[148:149], v28 offset:21824
ds_read_b64_tr_b16 a[150:151], v28 offset:26176
buffer_load_dwordx4 v18, s[44:47], s70 offen offset:2080 lds
v_mfma_f32_32x32x16_bf16 a[0:15], a[128:131], v[144:147], a[0:15]
ds_read_b64_tr_b16 a[152:153], v28 offset:21888
ds_read_b64_tr_b16 a[154:155], v28 offset:26240
v_exp_f32 v241, v105
v_add_f32 v31, v31, v240
v_mfma_f32_32x32x16_bf16 a[16:31], a[132:135], v[144:147], a[16:31]
s_waitcnt lgkmcnt(6)
ds_read_b64_tr_b16 a[156:157], v28 offset:21952
ds_read_b64_tr_b16 a[158:159], v28 offset:26304
buffer_load_dwordx4 v19, s[44:47], s70 offen offset:3120 lds
s_lshl_b32 s3, s68, 8
v_mfma_f32_32x32x16_bf16 a[32:47], a[136:139], v[144:147], a[32:47]
s_xor_b32 s69, s0, 98304
ds_read_b64_tr_b16 a[128:129], v28 offset:30208
ds_read_b64_tr_b16 a[130:131], v28 offset:34560
s_add_u32 m0, s71, 69632
v_add_f32_e64 v31, v31, v241
v_mfma_f32_32x32x16_bf16 a[48:63], a[140:143], v[144:147], a[48:63]
s_waitcnt lgkmcnt(6)
ds_read_b64_tr_b16 a[132:133], v28 offset:30272
ds_read_b64_tr_b16 a[134:135], v28 offset:34624
buffer_load_dwordx4 v20, s[48:51], s69 offen offset:0 lds
s_lshl_b32 s34, s67, 5
v_mfma_f32_32x32x16_bf16 a[64:79], a[144:147], v[144:147], a[64:79]
ds_read_b64_tr_b16 a[136:137], v28 offset:30336
ds_read_b64_tr_b16 a[138:139], v28 offset:34688
v_cvt_pk_bf16_f32 v132, v240, v241
v_exp_f32 v242, v106
v_mfma_f32_32x32x16_bf16 a[80:95], a[148:151], v[144:147], a[80:95]
s_waitcnt lgkmcnt(6)
ds_read_b64_tr_b16 a[140:141], v28 offset:30400
ds_read_b64_tr_b16 a[142:143], v28 offset:34752
buffer_load_dwordx4 v21, s[48:51], s69 offen offset:1088 lds
v_mfma_f32_32x32x16_bf16 a[96:111], a[152:155], v[144:147], a[96:111]
ds_read_b64_tr_b16 a[144:145], v28 offset:30464
ds_read_b64_tr_b16 a[146:147], v28 offset:34816
v_exp_f32_e64 v243, v107
s_add_u32 s3, s3, s34
v_mfma_f32_32x32x16_bf16 a[112:127], a[156:159], v[144:147], a[112:127]
s_waitcnt lgkmcnt(6)
ds_read_b64_tr_b16 a[148:149], v28 offset:30528
ds_read_b64_tr_b16 a[150:151], v28 offset:34880
buffer_load_dwordx4 v22, s[48:51], s69 offen offset:2176 lds
v_mfma_f32_32x32x16_bf16 a[0:15], a[128:131], v[148:151], a[0:15]
ds_read_b64_tr_b16 a[152:153], v28 offset:30592
ds_read_b64_tr_b16 a[154:155], v28 offset:34944
v_add_f32_e64 v31, v31, v242
v_add_f32 v31, v31, v243
s_mul_i32 s3, s3, 896
v_mfma_f32_32x32x16_bf16 a[16:31], a[132:135], v[148:151], a[16:31]
s_waitcnt lgkmcnt(6)
ds_read_b64_tr_b16 a[156:157], v28 offset:30656
ds_read_b64_tr_b16 a[158:159], v28 offset:35008
buffer_load_dwordx4 v23, s[48:51], s69 offen offset:3264 lds
v_mfma_f32_32x32x16_bf16 a[32:47], a[136:139], v[148:151], a[32:47]
ds_read_b64_tr_b16 a[128:129], v28 offset:38912
ds_read_b64_tr_b16 a[130:131], v28 offset:43264
v_cvt_pk_bf16_f32 v133, v242, v243
v_exp_f32 v240, v108
v_mfma_f32_32x32x16_bf16 a[48:63], a[140:143], v[148:151], a[48:63]
s_waitcnt lgkmcnt(6)
ds_read_b64_tr_b16 a[132:133], v28 offset:38976
ds_read_b64_tr_b16 a[134:135], v28 offset:43328
buffer_load_dwordx4 v[160:163], v238, s[40:43], s77 offen
v_exp_f32_e64 v241, v109
v_mfma_f32_32x32x16_bf16 a[64:79], a[144:147], v[148:151], a[64:79]
ds_read_b64_tr_b16 a[136:137], v28 offset:39040
ds_read_b64_tr_b16 a[138:139], v28 offset:43392
v_add_f32 v31, v31, v240
v_lshrrev_b32 v5, 3, v0
v_mul_u32_u24 v1, 896, v5
v_mfma_f32_32x32x16_bf16 a[80:95], a[148:151], v[148:151], a[80:95]
s_waitcnt lgkmcnt(6)
ds_read_b64_tr_b16 a[140:141], v28 offset:39104
ds_read_b64_tr_b16 a[142:143], v28 offset:43456
v_add_f32 v31, v31, v241
v_cvt_pk_bf16_f32 v134, v240, v241
v_mfma_f32_32x32x16_bf16 a[96:111], a[152:155], v[148:151], a[96:111]
ds_read_b64_tr_b16 a[144:145], v28 offset:39168
ds_read_b64_tr_b16 a[146:147], v28 offset:43520
v_exp_f32 v242, v110
v_bfe_u32 v5, v0, 4, 1
v_mfma_f32_32x32x16_bf16 a[112:127], a[156:159], v[148:151], a[112:127]
s_waitcnt lgkmcnt(6)
ds_read_b64_tr_b16 a[148:149], v28 offset:39232
ds_read_b64_tr_b16 a[150:151], v28 offset:43584
v_exp_f32 v243, v111
v_add_f32 v31, v31, v242
v_mfma_f32_32x32x16_bf16 a[0:15], a[128:131], v[152:155], a[0:15]
ds_read_b64_tr_b16 a[152:153], v28 offset:39296
ds_read_b64_tr_b16 a[154:155], v28 offset:43648
v_add_f32 v31, v31, v243
v_cvt_pk_bf16_f32 v135, v242, v243
v_mfma_f32_32x32x16_bf16 a[16:31], a[132:135], v[152:155], a[16:31]
s_waitcnt lgkmcnt(6)
ds_read_b64_tr_b16 a[156:157], v28 offset:39360
ds_read_b64_tr_b16 a[158:159], v28 offset:43712
v_exp_f32 v240, v112
v_lshlrev_b32 v5, 2, v5
v_mfma_f32_32x32x16_bf16 a[32:47], a[136:139], v[152:155], a[32:47]
ds_read_b64_tr_b16 a[128:129], v28 offset:47616
ds_read_b64_tr_b16 a[130:131], v28 offset:51968
v_exp_f32 v241, v113
v_mfma_f32_32x32x16_bf16 a[48:63], a[140:143], v[152:155], a[48:63]
s_waitcnt lgkmcnt(6)
ds_read_b64_tr_b16 a[132:133], v28 offset:47680
ds_read_b64_tr_b16 a[134:135], v28 offset:52032
buffer_load_dwordx2 v[10:11], v8, s[8:11], 0 offen sc1
v_add_f32_e64 v31, v31, v240
v_mfma_f32_32x32x16_bf16 a[64:79], a[144:147], v[152:155], a[64:79]
ds_read_b64_tr_b16 a[136:137], v28 offset:47744
ds_read_b64_tr_b16 a[138:139], v28 offset:52096
v_add_f32_e64 v31, v31, v241
v_cvt_pk_bf16_f32 v136, v240, v241
v_xor_b32 v5, v5, v0
v_mfma_f32_32x32x16_bf16 a[80:95], a[148:151], v[152:155], a[80:95]
s_waitcnt lgkmcnt(6)
ds_read_b64_tr_b16 a[140:141], v28 offset:47808
ds_read_b64_tr_b16 a[142:143], v28 offset:52160
v_exp_f32_e64 v242, v114
v_mfma_f32_32x32x16_bf16 a[96:111], a[152:155], v[152:155], a[96:111]
ds_read_b64_tr_b16 a[144:145], v28 offset:47872
ds_read_b64_tr_b16 a[146:147], v28 offset:52224
v_exp_f32_e64 v243, v115
v_and_b32 v5, 7, v5
v_mfma_f32_32x32x16_bf16 a[112:127], a[156:159], v[152:155], a[112:127]
s_waitcnt lgkmcnt(6)
ds_read_b64_tr_b16 a[148:149], v28 offset:47936
ds_read_b64_tr_b16 a[150:151], v28 offset:52288
v_add_f32_e64 v31, v31, v242
v_lshl_add_u32 v1, v5, 4, v1
v_mfma_f32_32x32x16_bf16 a[0:15], a[128:131], v[156:159], a[0:15]
s_add_u32 m0, s71, 87040
ds_read_b64_tr_b16 a[152:153], v28 offset:48000
ds_read_b64_tr_b16 a[154:155], v28 offset:52352
v_add_f32_e64 v31, v31, v243
v_add_u32 v1, s3, v1
v_mfma_f32_32x32x16_bf16 a[16:31], a[132:135], v[156:159], a[16:31]
s_waitcnt lgkmcnt(8)
ds_read_b64_tr_b16 a[156:157], v28 offset:48064
ds_read_b64_tr_b16 a[158:159], v28 offset:52416
v_cvt_pk_bf16_f32 v137, v242, v243
v_exp_f32_e64 v240, v116
v_mfma_f32_32x32x16_bf16 a[32:47], a[136:139], v[156:159], a[32:47]
s_waitcnt vmcnt(23) lgkmcnt(8)
s_barrier
ds_read_b128 a[128:131], v25 offset:56320
v_mfma_f32_32x32x16_bf16 a[48:63], a[140:143], v[156:159], a[48:63]
s_waitcnt lgkmcnt(5)
ds_read_b128 a[132:135], v25 offset:56352
v_exp_f32 v241, v117
v_add_u32 v2, 6144, v1
v_add_u32 v3, 12288, v1
v_mfma_f32_32x32x16_bf16 a[64:79], a[144:147], v[156:159], a[64:79]
s_xor_b32 s70, s0, 114688
ds_read_b128 a[136:139], v25 offset:56384
buffer_load_dwordx4 v20, s[48:51], s70 offen offset:0 lds
v_add_u32 v4, 18432, v1
v_mfma_f32_32x32x16_bf16 a[80:95], a[148:151], v[156:159], a[80:95]
s_waitcnt lgkmcnt(3)
ds_read_b128 a[140:143], v25 offset:56416
buffer_load_dwordx4 v21, s[48:51], s70 offen offset:1088 lds
v_add_f32 v31, v31, v240
v_bfe_u32 v6, v0, 4, 1
v_mfma_f32_32x32x16_bf16 a[96:111], a[152:155], v[156:159], a[96:111]
ds_read_b128 a[144:147], v25 offset:56448
v_add_f32_e64 v31, v31, v241
v_cvt_pk_bf16_f32 v138, v240, v241
v_lshlrev_b32 v5, 5, v6
v_mfma_f32_32x32x16_bf16 a[112:127], a[156:159], v[156:159], a[112:127]
s_waitcnt lgkmcnt(3)
ds_read_b128 a[148:151], v25 offset:56480
buffer_load_dwordx4 v22, s[48:51], s70 offen offset:2176 lds
v_exp_f32_e64 v242, v118
v_mfma_f32_32x32x16_bf16 v[176:191], a[128:131], v[32:35], v[208:223]
ds_read_b128 a[152:155], v25 offset:56512
v_exp_f32 v243, v119
v_and_b32 v6, 1, v0
v_lshl_add_u32 v5, v6, 4, v5
v_mfma_f32_32x32x16_bf16 v[176:191], a[132:135], v[36:39], v[176:191]
s_waitcnt lgkmcnt(3)
ds_read_b128 a[156:159], v25 offset:56544
buffer_load_dwordx4 v23, s[48:51], s70 offen offset:3264 lds
v_add_f32 v31, v31, v242
v_mfma_f32_32x32x16_bf16 v[176:191], a[136:139], v[40:43], v[176:191]
s_xor_b32 s69, s0, 163840
ds_read_b128 a[128:131], v25 offset:56576
s_add_u32 m0, s72, 104448
v_add_f32 v31, v31, v243
v_cvt_pk_bf16_f32 v139, v242, v243
v_bfe_u32 v6, v0, 1, 1
v_mfma_f32_32x32x16_bf16 v[176:191], a[140:143], v[44:47], v[176:191]
s_waitcnt lgkmcnt(3)
ds_read_b128 a[132:135], v25 offset:56608
buffer_load_dwordx4 v16, s[44:47], s69 offen offset:0 lds
v_lshl_add_u32 v5, v6, 3, v5
v_mfma_f32_32x32x16_bf16 v[176:191], a[144:147], v[48:51], v[176:191]
ds_read_b128 a[136:139], v25 offset:56640
v_exp_f32_e64 v240, v120
v_bfe_u32 v6, v0, 2, 2
v_lshl_add_u32 v5, v6, 7, v5
v_mfma_f32_32x32x16_bf16 v[176:191], a[148:151], v[52:55], v[176:191]
s_waitcnt lgkmcnt(3)
ds_read_b128 a[140:143], v25 offset:56672
buffer_load_dwordx4 v17, s[44:47], s69 offen offset:1040 lds
v_exp_f32 v241, v121
v_mfma_f32_32x32x16_bf16 v[176:191], a[152:155], v[56:59], v[176:191]
ds_read_b128 a[144:147], v25 offset:56704
v_add_f32 v31, v31, v240
v_add_f32 v31, v31, v241
v_lshrrev_b32 v6, 5, v0
v_mfma_f32_32x32x16_bf16 v[176:191], a[156:159], v[60:63], v[176:191]
s_waitcnt lgkmcnt(3)
ds_read_b128 a[148:151], v25 offset:56736
buffer_load_dwordx4 v18, s[44:47], s69 offen offset:2080 lds
v_cvt_pk_bf16_f32 v140, v240, v241
v_lshl_add_u32 v5, v6, 9, v5
v_mfma_f32_32x32x16_bf16 v[176:191], a[128:131], v[64:67], v[176:191]
ds_read_b128 a[152:155], v25 offset:56768
v_exp_f32 v242, v122
v_bfe_u32 v6, v0, 3, 1
v_mfma_f32_32x32x16_bf16 v[176:191], a[132:135], v[68:71], v[176:191]
s_waitcnt lgkmcnt(3)
ds_read_b128 a[156:159], v25 offset:56800
buffer_load_dwordx4 v19, s[44:47], s69 offen offset:3120 lds
v_exp_f32_e64 v243, v123
v_mfma_f32_32x32x16_bf16 v[176:191], a[136:139], v[72:75], v[176:191]
ds_read_b128 a[128:131], v26 offset:8192
v_add_f32 v31, v31, v242
v_add_f32 v31, v31, v243
v_xor_b32 v6, s67, v6
v_lshl_add_u32 v5, v6, 6, v5
v_mfma_f32_32x32x16_bf16 v[176:191], a[140:143], v[76:79], v[176:191]
s_waitcnt lgkmcnt(3)
ds_read_b128 a[132:135], v26 offset:8224
buffer_load_dwordx4 v[164:167], v239, s[40:43], s77 offen
v_cvt_pk_bf16_f32 v141, v242, v243
v_exp_f32_e64 v240, v124
v_mfma_f32_32x32x16_bf16 v[176:191], a[144:147], v[80:83], v[176:191]
ds_read_b128 a[136:139], v26 offset:8256
v_exp_f32 v241, v125
v_add_u32 v5, s75, v5
v_mfma_f32_32x32x16_bf16 v[176:191], a[148:151], v[84:87], v[176:191]
s_waitcnt lgkmcnt(3)
ds_read_b128 a[140:143], v26 offset:8288
v_add_f32 v31, v31, v240
v_add_f32_e64 v31, v31, v241
v_cvt_pk_bf16_f32 v142, v240, v241
v_add_u32 v6, 0x10000, v5
v_mfma_f32_32x32x16_bf16 v[176:191], a[152:155], v[88:91], v[176:191]
ds_read_b128 a[144:147], v26 offset:8320
v_exp_f32_e64 v242, v126
v_add_u32 v7, 0x20000, v5
v_mfma_f32_32x32x16_bf16 v[176:191], a[156:159], v[92:95], v[176:191]
s_waitcnt lgkmcnt(3)
ds_read_b128 a[148:151], v26 offset:8352
v_exp_f32 v243, v127
v_add_f32_e64 v31, v31, v242
v_mfma_f32_32x32x16_bf16 v[192:207], a[128:131], v[32:35], v[208:223]
ds_read_b128 a[152:155], v26 offset:8384
v_add_f32_e64 v31, v31, v243
v_cvt_pk_bf16_f32 v143, v242, v243
v_cmp_nge_f32 vcc, 0x47800000, v31
v_mfma_f32_32x32x16_bf16 v[192:207], a[132:135], v[36:39], v[192:207]
s_cbranch_vccnz recurrent_scan__sliding_block_cached__moe_arch_mod__prompt_kernel_stub2
recurrent_scan__sliding_block_cached__moe_arch_mod__prompt_kernel_back2:
s_waitcnt vmcnt(9) lgkmcnt(3)
ds_read_b128 a[156:159], v26 offset:8416
v_add_f32 v30, v30, v31
v_exp_f32 v240, v176
v_and_b32_e64 v225, 1, v10
v_cmp_eq_u32 s[18:19], 0, v225
v_mfma_f32_32x32x16_bf16 v[192:207], a[136:139], v[40:43], v[192:207]
s_cmp_lg_u64 s[18:19], 0
s_cbranch_scc1 recurrent_scan__sliding_block_cached__moe_arch_mod__prompt_kernel_poll
recurrent_scan__sliding_block_cached__moe_arch_mod__prompt_kernel_pollback:
ds_read_b128 a[128:131], v26 offset:8448
v_exp_f32_e64 v241, v177
v_readlane_b32 s63, v10, 0
v_readlane_b32 s20, v10, 2
v_mfma_f32_32x32x16_bf16 v[192:207], a[140:143], v[44:47], v[192:207]
s_waitcnt lgkmcnt(3)
ds_read_b128 a[132:135], v26 offset:8480
v_nop
v_add_f32_e64 v31, v240, v241
v_cvt_pk_bf16_f32 v144, v240, v241
v_lshlrev_b32_e64 v11, v9, v11
v_mfma_f32_32x32x16_bf16 v[192:207], a[144:147], v[48:51], v[192:207]
ds_read_b128 a[136:139], v26 offset:8512
v_exp_f32 v242, v178
v_exp_f32 v243, v179
s_lshr_b32 s20, s20, 13
v_mfma_f32_32x32x16_bf16 v[192:207], a[148:151], v[52:55], v[192:207]
s_waitcnt lgkmcnt(3)
ds_read_b128 a[140:143], v26 offset:8544
v_add_f32_e64 v31, v31, v242
v_add_f32 v31, v31, v243
v_cvt_pk_bf16_f32 v145, v242, v243
s_add_u32 s63, s63, s20
v_mfma_f32_32x32x16_bf16 v[192:207], a[152:155], v[56:59], v[192:207]
ds_read_b128 a[144:147], v26 offset:8576
v_exp_f32_e64 v240, v180
v_bfe_u32 v10, v10, v14, 6
v_and_b32 v11, s74, v11
v_mfma_f32_32x32x16_bf16 v[192:207], a[156:159], v[60:63], v[192:207]
s_waitcnt lgkmcnt(3)
ds_read_b128 a[148:151], v26 offset:8608
v_exp_f32 v241, v181
v_add_f32 v31, v31, v240
v_add_f32_e64 v31, v31, v241
v_or3_b32 v10, v10, v11, v15
v_mfma_f32_32x32x16_bf16 v[192:207], a[128:131], v[64:67], v[192:207]
s_add_u32 m0, s72, 121856
ds_read_b128 a[152:155], v26 offset:8640
v_cvt_pk_bf16_f32 v146, v240, v241
v_exp_f32 v242, v182
v_mov_b32 v11, v10
v_mfma_f32_32x32x16_bf16 v[192:207], a[132:135], v[68:71], v[192:207]
s_waitcnt lgkmcnt(4)
ds_read_b128 a[156:159], v26 offset:8672
v_exp_f32 v243, v183
v_add_f32 v31, v31, v242
v_max_u32_dpp v11, v11, v11 row_shr:1 bound_ctrl:0
s_nop 1
v_max_u32_dpp v11, v11, v11 row_shr:2 bound_ctrl:0
v_mfma_f32_32x32x16_bf16 v[192:207], a[136:139], v[72:75], v[192:207]
s_waitcnt lgkmcnt(4)
s_barrier
ds_read_b64_tr_b16 a[128:129], v27 offset:0
ds_read_b64_tr_b16 a[130:131], v27 offset:4352
v_mfma_f32_32x32x16_bf16 v[192:207], a[140:143], v[76:79], v[192:207]
s_waitcnt lgkmcnt(4)
ds_read_b64_tr_b16 a[132:133], v27 offset:64
ds_read_b64_tr_b16 a[134:135], v27 offset:4416
v_add_f32 v31, v31, v243
v_cvt_pk_bf16_f32 v147, v242, v243
v_max_u32_dpp v11, v11, v11 row_shr:4 bound_ctrl:0
v_mfma_f32_32x32x16_bf16 v[192:207], a[144:147], v[80:83], v[192:207]
s_xor_b32 s70, s0, 180224
ds_read_b64_tr_b16 a[136:137], v27 offset:128
ds_read_b64_tr_b16 a[138:139], v27 offset:4480
buffer_load_dwordx4 v16, s[44:47], s70 offen offset:0 lds
v_max_u32_dpp v11, v11, v11 row_shr:8 bound_ctrl:0
s_nop 1
v_max_u32_dpp v11, v11, v11 row_bcast:15 row_mask:0xa
v_mfma_f32_32x32x16_bf16 v[192:207], a[148:151], v[84:87], v[192:207]
s_waitcnt lgkmcnt(6)
ds_read_b64_tr_b16 a[140:141], v27 offset:192
ds_read_b64_tr_b16 a[142:143], v27 offset:4544
buffer_load_dwordx4 v17, s[44:47], s70 offen offset:1040 lds
v_max_u32_dpp v11, v11, v11 row_bcast:31 row_mask:0xc
v_mfma_f32_32x32x16_bf16 v[192:207], a[152:155], v[88:91], v[192:207]
ds_read_b64_tr_b16 a[144:145], v27 offset:256
ds_read_b64_tr_b16 a[146:147], v27 offset:4608
v_exp_f32_e64 v240, v184
v_readlane_b32 s4, v11, 63
s_nop 1
v_cmp_ne_u32 s[18:19], s4, v10
v_mfma_f32_32x32x16_bf16 v[192:207], a[156:159], v[92:95], v[192:207]
s_waitcnt lgkmcnt(6)
ds_read_b64_tr_b16 a[148:149], v27 offset:320
ds_read_b64_tr_b16 a[150:151], v27 offset:4672
buffer_load_dwordx4 v18, s[44:47], s70 offen offset:2080 lds
v_cndmask_b32 v11, 0, v10, s[18:19]
v_mfma_f32_32x32x16_bf16 a[0:15], a[128:131], v[128:131], a[0:15]
ds_read_b64_tr_b16 a[152:153], v27 offset:384
ds_read_b64_tr_b16 a[154:155], v27 offset:4736
v_exp_f32_e64 v241, v185
v_add_f32 v31, v31, v240
v_max_u32_dpp v11, v11, v11 row_shr:1 bound_ctrl:0
v_mfma_f32_32x32x16_bf16 a[16:31], a[132:135], v[128:131], a[16:31]
s_waitcnt lgkmcnt(6)
ds_read_b64_tr_b16 a[156:157], v27 offset:448
ds_read_b64_tr_b16 a[158:159], v27 offset:4800
buffer_load_dwordx4 v19, s[44:47], s70 offen offset:3120 lds
v_max_u32_dpp v11, v11, v11 row_shr:2 bound_ctrl:0
v_mfma_f32_32x32x16_bf16 a[32:47], a[136:139], v[128:131], a[32:47]
s_xor_b32 s69, s0, 131072
ds_read_b64_tr_b16 a[128:129], v27 offset:8704
ds_read_b64_tr_b16 a[130:131], v27 offset:13056
s_add_u32 m0, s71, 139264
v_add_f32 v31, v31, v241
v_max_u32_dpp v11, v11, v11 row_shr:4 bound_ctrl:0
s_nop 1
v_max_u32_dpp v11, v11, v11 row_shr:8 bound_ctrl:0
v_mfma_f32_32x32x16_bf16 a[48:63], a[140:143], v[128:131], a[48:63]
s_waitcnt lgkmcnt(6)
ds_read_b64_tr_b16 a[132:133], v27 offset:8768
ds_read_b64_tr_b16 a[134:135], v27 offset:13120
buffer_load_dwordx4 v20, s[48:51], s69 offen offset:0 lds
v_max_u32_dpp v11, v11, v11 row_bcast:15 row_mask:0xa
s_nop 1
v_max_u32_dpp v11, v11, v11 row_bcast:31 row_mask:0xc
v_mfma_f32_32x32x16_bf16 a[64:79], a[144:147], v[128:131], a[64:79]
ds_read_b64_tr_b16 a[136:137], v27 offset:8832
ds_read_b64_tr_b16 a[138:139], v27 offset:13184
v_cvt_pk_bf16_f32 v148, v240, v241
v_exp_f32 v242, v186
v_mfma_f32_32x32x16_bf16 a[80:95], a[148:151], v[128:131], a[80:95]
s_waitcnt lgkmcnt(6)
ds_read_b64_tr_b16 a[140:141], v27 offset:8896
ds_read_b64_tr_b16 a[142:143], v27 offset:13248
buffer_load_dwordx4 v21, s[48:51], s69 offen offset:1088 lds
v_readlane_b32 s5, v11, 63
s_and_b32 s20, s4, 0x7ff
v_mfma_f32_32x32x16_bf16 a[96:111], a[152:155], v[128:131], a[96:111]
ds_read_b64_tr_b16 a[144:145], v27 offset:8960
ds_read_b64_tr_b16 a[146:147], v27 offset:13312
v_exp_f32 v243, v187
s_and_b32 s21, s5, 0x7ff
v_mfma_f32_32x32x16_bf16 a[112:127], a[156:159], v[128:131], a[112:127]
s_waitcnt lgkmcnt(6)
ds_read_b64_tr_b16 a[148:149], v27 offset:9024
ds_read_b64_tr_b16 a[150:151], v27 offset:13376
buffer_load_dwordx4 v22, s[48:51], s69 offen offset:2176 lds
s_sub_u32 s22, 2047, s20
s_sub_u32 s23, 2047, s21
v_mfma_f32_32x32x16_bf16 a[0:15], a[128:131], v[132:135], a[0:15]
ds_read_b64_tr_b16 a[152:153], v27 offset:9088
ds_read_b64_tr_b16 a[154:155], v27 offset:13440
v_add_f32 v31, v31, v242
v_add_f32 v31, v31, v243
s_mul_i32 s60, s22, 896
v_mfma_f32_32x32x16_bf16 a[16:31], a[132:135], v[132:135], a[16:31]
s_waitcnt lgkmcnt(6)
ds_read_b64_tr_b16 a[156:157], v27 offset:9152
ds_read_b64_tr_b16 a[158:159], v27 offset:13504
buffer_load_dwordx4 v23, s[48:51], s69 offen offset:3264 lds
s_mul_i32 s61, s23, 896
s_lshl_b32 s20, s22, 3
v_mfma_f32_32x32x16_bf16 a[32:47], a[136:139], v[132:135], a[32:47]
ds_read_b64_tr_b16 a[128:129], v27 offset:17408
ds_read_b64_tr_b16 a[130:131], v27 offset:21760
v_cvt_pk_bf16_f32 v149, v242, v243
v_exp_f32 v240, v188
v_mfma_f32_32x32x16_bf16 a[48:63], a[140:143], v[132:135], a[48:63]
s_waitcnt lgkmcnt(6)
ds_read_b64_tr_b16 a[132:133], v27 offset:17472
ds_read_b64_tr_b16 a[134:135], v27 offset:21824
buffer_load_dwordx4 v[168:171], v238, s[24:27], s77 offen
v_exp_f32_e64 v241, v189
v_mfma_f32_32x32x16_bf16 a[64:79], a[144:147], v[132:135], a[64:79]
ds_read_b64_tr_b16 a[136:137], v27 offset:17536
ds_read_b64_tr_b16 a[138:139], v27 offset:21888
v_add_f32_e64 v31, v31, v240
s_lshl_b32 s21, s23, 3
v_mov_b32 v9, 16777216
v_mfma_f32_32x32x16_bf16 a[80:95], a[148:151], v[132:135], a[80:95]
s_waitcnt lgkmcnt(6)
ds_read_b64_tr_b16 a[140:141], v27 offset:17600
ds_read_b64_tr_b16 a[142:143], v27 offset:21952
buffer_load_ushort v224, v12, s[36:39], s60 offen offset:48
v_add_f32_e64 v31, v31, v241
v_cvt_pk_bf16_f32 v150, v240, v241
v_mfma_f32_32x32x16_bf16 a[96:111], a[152:155], v[132:135], a[96:111]
ds_read_b64_tr_b16 a[144:145], v27 offset:17664
ds_read_b64_tr_b16 a[146:147], v27 offset:22016
buffer_load_ushort v225, v13, s[36:39], s60 offen offset:48
v_exp_f32 v242, v190
v_mfma_f32_32x32x16_bf16 a[112:127], a[156:159], v[132:135], a[112:127]
s_waitcnt lgkmcnt(6)
ds_read_b64_tr_b16 a[148:149], v27 offset:17728
ds_read_b64_tr_b16 a[150:151], v27 offset:22080
v_exp_f32 v243, v191
v_add_f32 v31, v31, v242
v_mfma_f32_32x32x16_bf16 a[0:15], a[128:131], v[136:139], a[0:15]
ds_read_b64_tr_b16 a[152:153], v27 offset:17792
ds_read_b64_tr_b16 a[154:155], v27 offset:22144
buffer_load_ushort v226, v12, s[36:39], s61 offen offset:48
v_add_f32 v31, v31, v243
v_cvt_pk_bf16_f32 v151, v242, v243
v_mfma_f32_32x32x16_bf16 a[16:31], a[132:135], v[136:139], a[16:31]
s_waitcnt lgkmcnt(6)
ds_read_b64_tr_b16 a[156:157], v27 offset:17856
ds_read_b64_tr_b16 a[158:159], v27 offset:22208
v_exp_f32_e64 v240, v192
v_mfma_f32_32x32x16_bf16 a[32:47], a[136:139], v[136:139], a[32:47]
ds_read_b64_tr_b16 a[128:129], v27 offset:26112
ds_read_b64_tr_b16 a[130:131], v27 offset:30464
buffer_load_ushort v227, v13, s[36:39], s61 offen offset:48
v_exp_f32 v241, v193
v_mfma_f32_32x32x16_bf16 a[48:63], a[140:143], v[136:139], a[48:63]
s_waitcnt lgkmcnt(6)
ds_read_b64_tr_b16 a[132:133], v27 offset:26176
ds_read_b64_tr_b16 a[134:135], v27 offset:30528
buffer_load_dwordx2 v[228:229], v9, s[56:59], s20 offen sc1
v_add_f32_e64 v31, v31, v240
v_mfma_f32_32x32x16_bf16 a[64:79], a[144:147], v[136:139], a[64:79]
ds_read_b64_tr_b16 a[136:137], v27 offset:26240
ds_read_b64_tr_b16 a[138:139], v27 offset:30592
buffer_load_dwordx2 v[230:231], v9, s[56:59], s21 offen sc1
v_add_f32 v31, v31, v241
v_cvt_pk_bf16_f32 v152, v240, v241
v_mfma_f32_32x32x16_bf16 a[80:95], a[148:151], v[136:139], a[80:95]
s_waitcnt lgkmcnt(6)
ds_read_b64_tr_b16 a[140:141], v27 offset:26304
ds_read_b64_tr_b16 a[142:143], v27 offset:30656
v_exp_f32_e64 v242, v194
v_mfma_f32_32x32x16_bf16 a[96:111], a[152:155], v[136:139], a[96:111]
ds_read_b64_tr_b16 a[144:145], v27 offset:26368
ds_read_b64_tr_b16 a[146:147], v27 offset:30720
v_exp_f32 v243, v195
v_mfma_f32_32x32x16_bf16 a[112:127], a[156:159], v[136:139], a[112:127]
s_waitcnt lgkmcnt(6)
ds_read_b64_tr_b16 a[148:149], v27 offset:26432
ds_read_b64_tr_b16 a[150:151], v27 offset:30784
v_add_f32 v31, v31, v242
v_mfma_f32_32x32x16_bf16 a[0:15], a[128:131], v[140:143], a[0:15]
s_add_u32 m0, s71, 0
ds_read_b64_tr_b16 a[152:153], v27 offset:26496
ds_read_b64_tr_b16 a[154:155], v27 offset:30848
v_add_f32 v31, v31, v243
v_mfma_f32_32x32x16_bf16 a[16:31], a[132:135], v[140:143], a[16:31]
s_waitcnt lgkmcnt(8)
ds_read_b64_tr_b16 a[156:157], v27 offset:26560
ds_read_b64_tr_b16 a[158:159], v27 offset:30912
v_cvt_pk_bf16_f32 v153, v242, v243
v_exp_f32_e64 v240, v196
v_mfma_f32_32x32x16_bf16 a[32:47], a[136:139], v[140:143], a[32:47]
s_waitcnt lgkmcnt(8)
s_barrier
ds_read_b128 a[128:131], v24 offset:34816
v_mfma_f32_32x32x16_bf16 a[48:63], a[140:143], v[140:143], a[48:63]
s_waitcnt lgkmcnt(5)
ds_read_b128 a[132:135], v24 offset:34848
v_exp_f32 v241, v197
v_mfma_f32_32x32x16_bf16 a[64:79], a[144:147], v[140:143], a[64:79]
s_xor_b32 s70, s0, 147456
ds_read_b128 a[136:139], v24 offset:34880
buffer_load_dwordx4 v20, s[48:51], s70 offen offset:0 lds
v_mfma_f32_32x32x16_bf16 a[80:95], a[148:151], v[140:143], a[80:95]
s_waitcnt lgkmcnt(3)
ds_read_b128 a[140:143], v24 offset:34912
buffer_load_dwordx4 v21, s[48:51], s70 offen offset:1088 lds
v_add_f32 v31, v31, v240
v_mfma_f32_32x32x16_bf16 a[96:111], a[152:155], v[140:143], a[96:111]
ds_read_b128 a[144:147], v24 offset:34944
v_add_f32 v31, v31, v241
v_cvt_pk_bf16_f32 v154, v240, v241
v_mfma_f32_32x32x16_bf16 a[112:127], a[156:159], v[140:143], a[112:127]
s_waitcnt lgkmcnt(3)
ds_read_b128 a[148:151], v24 offset:34976
buffer_load_dwordx4 v22, s[48:51], s70 offen offset:2176 lds
v_exp_f32_e64 v242, v198
v_mfma_f32_32x32x16_bf16 v[96:111], a[128:131], v[32:35], v[208:223]
ds_read_b128 a[152:155], v24 offset:35008
v_exp_f32 v243, v199
v_mfma_f32_32x32x16_bf16 v[96:111], a[132:135], v[36:39], v[96:111]
s_waitcnt lgkmcnt(3)
ds_read_b128 a[156:159], v24 offset:35040
buffer_load_dwordx4 v23, s[48:51], s70 offen offset:3264 lds
v_add_f32_e64 v31, v31, v242
v_mfma_f32_32x32x16_bf16 v[96:111], a[136:139], v[40:43], v[96:111]
s_xor_b32 s69, s0, 196608
ds_read_b128 a[128:131], v24 offset:35072
s_add_u32 m0, s72, 17408
v_add_f32 v31, v31, v243
v_cvt_pk_bf16_f32 v155, v242, v243
v_mfma_f32_32x32x16_bf16 v[96:111], a[140:143], v[44:47], v[96:111]
s_waitcnt lgkmcnt(3)
ds_read_b128 a[132:135], v24 offset:35104
buffer_load_dwordx4 v16, s[44:47], s69 offen offset:0 lds
v_mfma_f32_32x32x16_bf16 v[96:111], a[144:147], v[48:51], v[96:111]
ds_read_b128 a[136:139], v24 offset:35136
v_exp_f32 v240, v200
v_mfma_f32_32x32x16_bf16 v[96:111], a[148:151], v[52:55], v[96:111]
s_waitcnt lgkmcnt(3)
ds_read_b128 a[140:143], v24 offset:35168
buffer_load_dwordx4 v17, s[44:47], s69 offen offset:1040 lds
v_exp_f32_e64 v241, v201
v_mfma_f32_32x32x16_bf16 v[96:111], a[152:155], v[56:59], v[96:111]
ds_read_b128 a[144:147], v24 offset:35200
v_add_f32_e64 v31, v31, v240
v_add_f32 v31, v31, v241
v_mfma_f32_32x32x16_bf16 v[96:111], a[156:159], v[60:63], v[96:111]
s_waitcnt lgkmcnt(3)
ds_read_b128 a[148:151], v24 offset:35232
buffer_load_dwordx4 v18, s[44:47], s69 offen offset:2080 lds
v_cvt_pk_bf16_f32 v156, v240, v241
v_mfma_f32_32x32x16_bf16 v[96:111], a[128:131], v[64:67], v[96:111]
ds_read_b128 a[152:155], v24 offset:35264
v_exp_f32 v242, v202
v_mfma_f32_32x32x16_bf16 v[96:111], a[132:135], v[68:71], v[96:111]
s_waitcnt lgkmcnt(3)
ds_read_b128 a[156:159], v24 offset:35296
buffer_load_dwordx4 v19, s[44:47], s69 offen offset:3120 lds
v_exp_f32_e64 v243, v203
v_mfma_f32_32x32x16_bf16 v[96:111], a[136:139], v[72:75], v[96:111]
ds_read_b128 a[128:131], v24 offset:52224
v_add_f32_e64 v31, v31, v242
v_add_f32 v31, v31, v243
v_mfma_f32_32x32x16_bf16 v[96:111], a[140:143], v[76:79], v[96:111]
s_waitcnt lgkmcnt(3)
ds_read_b128 a[132:135], v24 offset:52256
buffer_load_dwordx4 v[172:175], v239, s[24:27], s77 offen
v_cvt_pk_bf16_f32 v157, v242, v243
v_exp_f32_e64 v240, v204
v_mfma_f32_32x32x16_bf16 v[96:111], a[144:147], v[80:83], v[96:111]
ds_read_b128 a[136:139], v24 offset:52288
v_exp_f32 v241, v205
v_mfma_f32_32x32x16_bf16 v[96:111], a[148:151], v[84:87], v[96:111]
s_waitcnt lgkmcnt(3)
ds_read_b128 a[140:143], v24 offset:52320
v_add_f32 v31, v31, v240
v_add_f32 v31, v31, v241
v_cvt_pk_bf16_f32 v158, v240, v241
v_mfma_f32_32x32x16_bf16 v[96:111], a[152:155], v[88:91], v[96:111]
ds_read_b128 a[144:147], v24 offset:52352
v_exp_f32 v242, v206
v_mfma_f32_32x32x16_bf16 v[96:111], a[156:159], v[92:95], v[96:111]
s_waitcnt lgkmcnt(3)
ds_read_b128 a[148:151], v24 offset:52384
v_exp_f32 v243, v207
v_add_f32 v31, v31, v242
v_mfma_f32_32x32x16_bf16 v[112:127], a[128:131], v[32:35], v[208:223]
ds_read_b128 a[152:155], v24 offset:52416
v_add_f32_e64 v31, v31, v243
v_cvt_pk_bf16_f32 v159, v242, v243
v_cmp_nge_f32 vcc, 0x47800000, v31
v_mfma_f32_32x32x16_bf16 v[112:127], a[132:135], v[36:39], v[112:127]
s_cbranch_vccnz recurrent_scan__sliding_block_cached__moe_arch_mod__prompt_kernel_stub3
recurrent_scan__sliding_block_cached__moe_arch_mod__prompt_kernel_back3:
s_waitcnt lgkmcnt(3)
ds_read_b128 a[156:159], v24 offset:52448
v_add_f32 v30, v30, v31
v_exp_f32 v240, v96
v_mfma_f32_32x32x16_bf16 v[112:127], a[136:139], v[40:43], v[112:127]
ds_read_b128 a[128:131], v24 offset:52480
v_exp_f32 v241, v97
v_mfma_f32_32x32x16_bf16 v[112:127], a[140:143], v[44:47], v[112:127]
s_waitcnt lgkmcnt(3)
ds_read_b128 a[132:135], v24 offset:52512
v_nop
v_add_f32 v31, v240, v241
v_cvt_pk_bf16_f32 v128, v240, v241
v_mfma_f32_32x32x16_bf16 v[112:127], a[144:147], v[48:51], v[112:127]
s_waitcnt vmcnt(0)
ds_read_b128 a[136:139], v24 offset:52544
v_exp_f32 v242, v98
v_exp_f32 v243, v99
v_rcp_f32 v229, v229
v_mfma_f32_32x32x16_bf16 v[112:127], a[148:151], v[52:55], v[112:127]
s_waitcnt lgkmcnt(3)
ds_read_b128 a[140:143], v24 offset:52576
v_add_f32 v31, v31, v242
v_add_f32_e64 v31, v31, v243
v_cvt_pk_bf16_f32 v129, v242, v243
v_lshlrev_b32_e64 v224, 16, v224
v_mfma_f32_32x32x16_bf16 v[112:127], a[152:155], v[56:59], v[112:127]
ds_read_b128 a[144:147], v24 offset:52608
v_exp_f32 v240, v100
v_lshlrev_b32 v225, 16, v225
v_sub_f32 v224, v224, v228
v_sub_f32 v225, v225, v228
v_cvt_pk_bf16_f32 v225, v224, v225
v_mfma_f32_32x32x16_bf16 v[112:127], a[156:159], v[60:63], v[112:127]
s_waitcnt lgkmcnt(3)
ds_read_b128 a[148:151], v24 offset:52640
v_exp_f32 v241, v101
v_add_f32 v31, v31, v240
v_add_f32 v31, v31, v241
v_lshlrev_b32_e64 v224, 16, v225
v_mfma_f32_32x32x16_bf16 v[112:127], a[128:131], v[64:67], v[112:127]
v_readlane_b32 s70, v244, 8
ds_read_b128 a[152:155], v24 offset:52672
v_cvt_pk_bf16_f32 v130, v240, v241
v_exp_f32 v242, v102
v_and_b32 v225, s74, v225
v_mul_f32 v224, v224, v229
v_mfma_f32_32x32x16_bf16 v[112:127], a[132:135], v[68:71], v[112:127]
s_waitcnt lgkmcnt(4)
ds_read_b128 a[156:159], v24 offset:52704
v_exp_f32 v243, v103
v_add_f32 v31, v31, v242
v_mul_f32_e64 v225, v225, v229
v_cvt_pk_bf16_f32 v225, v224, v225
v_mfma_f32_32x32x16_bf16 v[112:127], a[136:139], v[72:75], v[112:127]
s_waitcnt lgkmcnt(4)
s_barrier
ds_read_b64_tr_b16 a[128:129], v28 offset:4096
ds_read_b64_tr_b16 a[130:131], v28 offset:8448
v_lshlrev_b32 v224, 16, v225
v_mfma_f32_32x32x16_bf16 v[112:127], a[140:143], v[76:79], v[112:127]
s_waitcnt lgkmcnt(4)
ds_read_b64_tr_b16 a[132:133], v28 offset:4160
ds_read_b64_tr_b16 a[134:135], v28 offset:8512
v_add_f32_e64 v31, v31, v243
v_cvt_pk_bf16_f32 v131, v242, v243
v_and_b32_e64 v225, s74, v225
v_mfma_f32_32x32x16_bf16 v[112:127], a[144:147], v[80:83], v[112:127]
s_add_u32 m0, s73, 34816
ds_read_b64_tr_b16 a[136:137], v28 offset:4224
ds_read_b64_tr_b16 a[138:139], v28 offset:8576
buffer_load_dwordx4 v1, s[52:55], s70 offen offset:0 lds
v_rcp_f32_e64 v231, v231
v_lshlrev_b32 v226, 16, v226
v_mfma_f32_32x32x16_bf16 v[112:127], a[148:151], v[84:87], v[112:127]
s_waitcnt lgkmcnt(6)
ds_read_b64_tr_b16 a[140:141], v28 offset:4288
ds_read_b64_tr_b16 a[142:143], v28 offset:8640
buffer_load_dwordx4 v2, s[52:55], s70 offen offset:1024 lds
v_lshlrev_b32 v227, 16, v227
v_sub_f32 v226, v226, v230
v_mfma_f32_32x32x16_bf16 v[112:127], a[152:155], v[88:91], v[112:127]
ds_read_b64_tr_b16 a[144:145], v28 offset:4352
ds_read_b64_tr_b16 a[146:147], v28 offset:8704
v_exp_f32_e64 v240, v104
v_sub_f32 v227, v227, v230
v_cvt_pk_bf16_f32 v227, v226, v227
v_mfma_f32_32x32x16_bf16 v[112:127], a[156:159], v[92:95], v[112:127]
s_waitcnt lgkmcnt(6)
ds_read_b64_tr_b16 a[148:149], v28 offset:4416
ds_read_b64_tr_b16 a[150:151], v28 offset:8768
buffer_load_dwordx4 v3, s[52:55], s70 offen offset:2048 lds
v_lshlrev_b32 v226, 16, v227
v_and_b32 v227, s74, v227
v_mul_f32_e64 v226, v226, v231
v_mfma_f32_32x32x16_bf16 a[0:15], a[128:131], v[144:147], a[0:15]
ds_read_b64_tr_b16 a[152:153], v28 offset:4480
ds_read_b64_tr_b16 a[154:155], v28 offset:8832
v_exp_f32 v241, v105
v_add_f32 v31, v31, v240
v_mul_f32 v227, v227, v231
v_mfma_f32_32x32x16_bf16 a[16:31], a[132:135], v[144:147], a[16:31]
s_waitcnt lgkmcnt(6)
ds_read_b64_tr_b16 a[156:157], v28 offset:4544
ds_read_b64_tr_b16 a[158:159], v28 offset:8896
buffer_load_dwordx4 v4, s[52:55], s70 offen offset:3072 lds
v_cvt_pk_bf16_f32 v227, v226, v227
v_lshlrev_b32_e64 v226, 16, v227
v_mfma_f32_32x32x16_bf16 a[32:47], a[136:139], v[144:147], a[32:47]
s_xor_b32 s69, s0, 212992
ds_read_b64_tr_b16 a[128:129], v28 offset:12800
ds_read_b64_tr_b16 a[130:131], v28 offset:17152
s_add_u32 m0, s72, 52224
v_add_f32 v31, v31, v241
v_and_b32 v227, s74, v227
v_lshlrev_b32 v228, 16, v160
v_mfma_f32_32x32x16_bf16 a[48:63], a[140:143], v[144:147], a[48:63]
s_waitcnt lgkmcnt(6)
ds_read_b64_tr_b16 a[132:133], v28 offset:12864
ds_read_b64_tr_b16 a[134:135], v28 offset:17216
buffer_load_dwordx4 v16, s[44:47], s69 offen offset:0 lds
v_and_b32 v229, s74, v160
v_lshlrev_b32 v230, 16, v164
v_and_b32_e64 v231, s74, v164
v_mfma_f32_32x32x16_bf16 a[64:79], a[144:147], v[144:147], a[64:79]
ds_read_b64_tr_b16 a[136:137], v28 offset:12928
ds_read_b64_tr_b16 a[138:139], v28 offset:17280
v_cvt_pk_bf16_f32 v132, v240, v241
v_exp_f32 v242, v106
v_mul_f32 v232, v228, v224
v_min_u32 v252, 23, v0
v_mfma_f32_32x32x16_bf16 a[80:95], a[148:151], v[144:147], a[80:95]
s_waitcnt lgkmcnt(6)
ds_read_b64_tr_b16 a[140:141], v28 offset:12992
ds_read_b64_tr_b16 a[142:143], v28 offset:17344
buffer_load_dwordx4 v17, s[44:47], s69 offen offset:1040 lds
v_mul_f32 v233, v228, v226
v_mul_f32 v234, v229, v224
v_and_b32_e64 v251, 7, v252
v_mfma_f32_32x32x16_bf16 a[96:111], a[152:155], v[144:147], a[96:111]
ds_read_b64_tr_b16 a[144:145], v28 offset:13056
ds_read_b64_tr_b16 a[146:147], v28 offset:17408
v_exp_f32 v243, v107
v_mul_f32 v235, v229, v226
v_fmac_f32 v232, v230, v225
v_mul_u32_u24 v251, 896, v251
v_mfma_f32_32x32x16_bf16 a[112:127], a[156:159], v[144:147], a[112:127]
s_waitcnt lgkmcnt(6)
ds_read_b64_tr_b16 a[148:149], v28 offset:13120
ds_read_b64_tr_b16 a[150:151], v28 offset:17472
buffer_load_dwordx4 v18, s[44:47], s69 offen offset:2080 lds
v_fmac_f32 v233, v230, v227
v_fmac_f32 v234, v231, v225
v_mfma_f32_32x32x16_bf16 a[0:15], a[128:131], v[148:151], a[0:15]
ds_read_b64_tr_b16 a[152:153], v28 offset:13184
ds_read_b64_tr_b16 a[154:155], v28 offset:17536
v_add_f32 v31, v31, v242
v_add_f32 v31, v31, v243
v_fmac_f32 v235, v231, v227
v_nop
v_lshrrev_b32_e64 v252, 3, v252
v_mfma_f32_32x32x16_bf16 a[16:31], a[132:135], v[148:151], a[16:31]
s_waitcnt lgkmcnt(6)
ds_read_b64_tr_b16 a[156:157], v28 offset:13248
ds_read_b64_tr_b16 a[158:159], v28 offset:17600
buffer_load_dwordx4 v19, s[44:47], s69 offen offset:3120 lds
v_permlane32_swap_b32 v232, v233
v_lshl_add_u32 v252, v252, 7, v251
v_mfma_f32_32x32x16_bf16 a[32:47], a[136:139], v[148:151], a[32:47]
ds_read_b64_tr_b16 a[128:129], v28 offset:21504
ds_read_b64_tr_b16 a[130:131], v28 offset:25856
buffer_load_dword a255, v252, s[52:55], s1 offen offset:0
v_cvt_pk_bf16_f32 v133, v242, v243
v_exp_f32_e64 v240, v108
v_permlane32_swap_b32 v234, v235
v_mfma_f32_32x32x16_bf16 a[48:63], a[140:143], v[148:151], a[48:63]
s_waitcnt lgkmcnt(6)
ds_read_b64_tr_b16 a[132:133], v28 offset:21568
ds_read_b64_tr_b16 a[134:135], v28 offset:25920
v_exp_f32 v241, v109
v_add_f32 v160, v232, v233
v_add_f32_e64 v164, v234, v235
v_mfma_f32_32x32x16_bf16 a[64:79], a[144:147], v[148:151], a[64:79]
ds_read_b64_tr_b16 a[136:137], v28 offset:21632
ds_read_b64_tr_b16 a[138:139], v28 offset:25984
v_add_f32 v31, v31, v240
v_lshlrev_b32 v228, 16, v161
v_and_b32_e64 v229, s74, v161
v_lshlrev_b32 v230, 16, v165
v_mfma_f32_32x32x16_bf16 a[80:95], a[148:151], v[148:151], a[80:95]
s_waitcnt lgkmcnt(6)
ds_read_b64_tr_b16 a[140:141], v28 offset:21696
ds_read_b64_tr_b16 a[142:143], v28 offset:26048
v_add_f32_e64 v31, v31, v241
v_cvt_pk_bf16_f32 v134, v240, v241
v_and_b32 v231, s74, v165
v_mul_f32 v232, v228, v224
v_mul_f32_e64 v233, v228, v226
v_mfma_f32_32x32x16_bf16 a[96:111], a[152:155], v[148:151], a[96:111]
ds_read_b64_tr_b16 a[144:145], v28 offset:21760
ds_read_b64_tr_b16 a[146:147], v28 offset:26112
v_exp_f32 v242, v110
v_mul_f32 v234, v229, v224
v_mul_f32 v235, v229, v226
v_mfma_f32_32x32x16_bf16 a[112:127], a[156:159], v[148:151], a[112:127]
s_waitcnt lgkmcnt(6)
ds_read_b64_tr_b16 a[148:149], v28 offset:21824
ds_read_b64_tr_b16 a[150:151], v28 offset:26176
v_exp_f32 v243, v111
v_add_f32 v31, v31, v242
v_fmac_f32_e64 v232, v230, v225
v_mfma_f32_32x32x16_bf16 a[0:15], a[128:131], v[152:155], a[0:15]
ds_read_b64_tr_b16 a[152:153], v28 offset:21888
ds_read_b64_tr_b16 a[154:155], v28 offset:26240
v_add_f32_e64 v31, v31, v243
v_cvt_pk_bf16_f32 v135, v242, v243
v_fmac_f32_e64 v233, v230, v227
v_fmac_f32 v234, v231, v225
v_mfma_f32_32x32x16_bf16 a[16:31], a[132:135], v[152:155], a[16:31]
s_waitcnt lgkmcnt(6)
ds_read_b64_tr_b16 a[156:157], v28 offset:21952
ds_read_b64_tr_b16 a[158:159], v28 offset:26304
v_exp_f32_e64 v240, v112
v_fmac_f32 v235, v231, v227
v_nop
v_mfma_f32_32x32x16_bf16 a[32:47], a[136:139], v[152:155], a[32:47]
ds_read_b64_tr_b16 a[128:129], v28 offset:30208
ds_read_b64_tr_b16 a[130:131], v28 offset:34560
v_exp_f32_e64 v241, v113
v_permlane32_swap_b32 v232, v233
v_mfma_f32_32x32x16_bf16 a[48:63], a[140:143], v[152:155], a[48:63]
s_waitcnt lgkmcnt(6)
ds_read_b64_tr_b16 a[132:133], v28 offset:30272
ds_read_b64_tr_b16 a[134:135], v28 offset:34624
v_add_f32 v31, v31, v240
v_permlane32_swap_b32 v234, v235
v_add_f32 v161, v232, v233
v_add_f32 v165, v234, v235
v_mfma_f32_32x32x16_bf16 a[64:79], a[144:147], v[152:155], a[64:79]
ds_read_b64_tr_b16 a[136:137], v28 offset:30336
ds_read_b64_tr_b16 a[138:139], v28 offset:34688
v_add_f32_e64 v31, v31, v241
v_cvt_pk_bf16_f32 v136, v240, v241
v_lshlrev_b32_e64 v228, 16, v162
v_and_b32 v229, s74, v162
v_mfma_f32_32x32x16_bf16 a[80:95], a[148:151], v[152:155], a[80:95]
s_waitcnt lgkmcnt(6)
ds_read_b64_tr_b16 a[140:141], v28 offset:30400
ds_read_b64_tr_b16 a[142:143], v28 offset:34752
v_exp_f32 v242, v114
v_lshlrev_b32 v230, 16, v166
v_and_b32_e64 v231, s74, v166
v_mfma_f32_32x32x16_bf16 a[96:111], a[152:155], v[152:155], a[96:111]
ds_read_b64_tr_b16 a[144:145], v28 offset:30464
ds_read_b64_tr_b16 a[146:147], v28 offset:34816
v_exp_f32 v243, v115
v_mul_f32 v232, v228, v224
v_mul_f32_e64 v233, v228, v226
v_mul_f32 v234, v229, v224
v_mfma_f32_32x32x16_bf16 a[112:127], a[156:159], v[152:155], a[112:127]
s_waitcnt lgkmcnt(6)
ds_read_b64_tr_b16 a[148:149], v28 offset:30528
ds_read_b64_tr_b16 a[150:151], v28 offset:34880
v_add_f32 v31, v31, v242
v_mul_f32 v235, v229, v226
v_fmac_f32 v232, v230, v225
v_fmac_f32 v233, v230, v227
v_mfma_f32_32x32x16_bf16 a[0:15], a[128:131], v[156:159], a[0:15]
s_add_u32 m0, s71, 69632
ds_read_b64_tr_b16 a[152:153], v28 offset:30592
ds_read_b64_tr_b16 a[154:155], v28 offset:34944
v_add_f32 v31, v31, v243
v_fmac_f32 v234, v231, v225
v_fmac_f32_e64 v235, v231, v227
v_nop
v_mfma_f32_32x32x16_bf16 a[16:31], a[132:135], v[156:159], a[16:31]
s_waitcnt lgkmcnt(8)
ds_read_b64_tr_b16 a[156:157], v28 offset:30656
ds_read_b64_tr_b16 a[158:159], v28 offset:35008
v_cvt_pk_bf16_f32 v137, v242, v243
v_exp_f32 v240, v116
v_permlane32_swap_b32 v232, v233
v_mfma_f32_32x32x16_bf16 a[32:47], a[136:139], v[156:159], a[32:47]
s_waitcnt lgkmcnt(8)
s_barrier
ds_read_b128 a[128:131], v25 offset:38912
v_mfma_f32_32x32x16_bf16 a[48:63], a[140:143], v[156:159], a[48:63]
s_waitcnt lgkmcnt(5)
ds_read_b128 a[132:135], v25 offset:38944
v_exp_f32 v241, v117
v_permlane32_swap_b32 v234, v235
v_add_f32 v162, v232, v233
v_add_f32_e64 v166, v234, v235
v_mfma_f32_32x32x16_bf16 a[64:79], a[144:147], v[156:159], a[64:79]
s_xor_b32 s70, s0, 163840
ds_read_b128 a[136:139], v25 offset:38976
buffer_load_dwordx4 v20, s[48:51], s70 offen offset:0 lds
v_lshlrev_b32 v228, 16, v163
v_and_b32 v229, s74, v163
v_lshlrev_b32 v230, 16, v167
v_mfma_f32_32x32x16_bf16 a[80:95], a[148:151], v[156:159], a[80:95]
s_waitcnt lgkmcnt(3)
ds_read_b128 a[140:143], v25 offset:39008
buffer_load_dwordx4 v21, s[48:51], s70 offen offset:1088 lds
v_add_f32 v31, v31, v240
v_and_b32 v231, s74, v167
v_mul_f32_e64 v232, v228, v224
v_mfma_f32_32x32x16_bf16 a[96:111], a[152:155], v[156:159], a[96:111]
ds_read_b128 a[144:147], v25 offset:39040
v_add_f32_e64 v31, v31, v241
v_cvt_pk_bf16_f32 v138, v240, v241
v_mul_f32 v233, v228, v226
v_mul_f32 v234, v229, v224
v_mul_f32 v235, v229, v226
v_mfma_f32_32x32x16_bf16 a[112:127], a[156:159], v[156:159], a[112:127]
s_waitcnt lgkmcnt(3)
ds_read_b128 a[148:151], v25 offset:39072
buffer_load_dwordx4 v22, s[48:51], s70 offen offset:2176 lds
v_exp_f32 v242, v118
v_fmac_f32 v232, v230, v225
v_fmac_f32_e64 v233, v230, v227
v_mfma_f32_32x32x16_bf16 v[176:191], a[128:131], v[32:35], v[208:223]
ds_read_b128 a[152:155], v25 offset:39104
v_exp_f32 v243, v119
v_fmac_f32 v234, v231, v225
v_fmac_f32_e64 v235, v231, v227
v_nop
v_mfma_f32_32x32x16_bf16 v[176:191], a[132:135], v[36:39], v[176:191]
s_waitcnt lgkmcnt(3)
ds_read_b128 a[156:159], v25 offset:39136
buffer_load_dwordx4 v23, s[48:51], s70 offen offset:3264 lds
v_add_f32 v31, v31, v242
v_permlane32_swap_b32 v232, v233
v_mfma_f32_32x32x16_bf16 v[176:191], a[136:139], v[40:43], v[176:191]
s_xor_b32 s69, s0, 180224
ds_read_b128 a[128:131], v25 offset:39168
s_add_u32 m0, s71, 87040
v_add_f32_e64 v31, v31, v243
v_cvt_pk_bf16_f32 v139, v242, v243
v_permlane32_swap_b32 v234, v235
v_mfma_f32_32x32x16_bf16 v[176:191], a[140:143], v[44:47], v[176:191]
s_waitcnt lgkmcnt(3)
ds_read_b128 a[132:135], v25 offset:39200
buffer_load_dwordx4 v20, s[48:51], s69 offen offset:0 lds
v_add_f32 v163, v232, v233
v_add_f32 v167, v234, v235
v_lshlrev_b32 v228, 16, v168
v_and_b32 v229, s74, v168
v_mfma_f32_32x32x16_bf16 v[176:191], a[144:147], v[48:51], v[176:191]
ds_read_b128 a[136:139], v25 offset:39232
v_exp_f32 v240, v120
v_lshlrev_b32 v230, 16, v172
v_and_b32 v231, s74, v172
v_mul_f32 v232, v228, v224
v_min_u32 v252, 15, v0
v_mfma_f32_32x32x16_bf16 v[176:191], a[148:151], v[52:55], v[176:191]
s_waitcnt lgkmcnt(3)
ds_read_b128 a[140:143], v25 offset:39264
buffer_load_dwordx4 v21, s[48:51], s69 offen offset:1088 lds
v_exp_f32 v241, v121
v_mul_f32 v233, v228, v226
v_and_b32_e64 v251, 7, v252
v_mfma_f32_32x32x16_bf16 v[176:191], a[152:155], v[56:59], v[176:191]
ds_read_b128 a[144:147], v25 offset:39296
v_add_f32 v31, v31, v240
v_add_f32 v31, v31, v241
v_mul_f32 v234, v229, v224
v_mul_f32 v235, v229, v226
v_fmac_f32 v232, v230, v225
v_mul_u32_u24 v251, 896, v251
v_mfma_f32_32x32x16_bf16 v[176:191], a[156:159], v[60:63], v[176:191]
s_waitcnt lgkmcnt(3)
ds_read_b128 a[148:151], v25 offset:39328
buffer_load_dwordx4 v22, s[48:51], s69 offen offset:2176 lds
v_cvt_pk_bf16_f32 v140, v240, v241
v_fmac_f32 v233, v230, v227
v_fmac_f32 v234, v231, v225
v_lshrrev_b32_e64 v252, 3, v252
v_mfma_f32_32x32x16_bf16 v[176:191], a[128:131], v[64:67], v[176:191]
ds_read_b128 a[152:155], v25 offset:39360
v_exp_f32_e64 v242, v122
v_fmac_f32 v235, v231, v227
v_nop
v_permlane32_swap_b32 v232, v233
v_mfma_f32_32x32x16_bf16 v[176:191], a[132:135], v[68:71], v[176:191]
s_waitcnt lgkmcnt(3)
ds_read_b128 a[156:159], v25 offset:39392
buffer_load_dwordx4 v23, s[48:51], s69 offen offset:3264 lds
v_exp_f32_e64 v243, v123
v_lshl_add_u32 v252, v252, 7, v251
v_mfma_f32_32x32x16_bf16 v[176:191], a[136:139], v[72:75], v[176:191]
ds_read_b128 a[128:131], v25 offset:56320
buffer_load_dword a255, v252, s[52:55], s1 offen offset:384
v_add_f32 v31, v31, v242
v_add_f32 v31, v31, v243
v_permlane32_swap_b32 v234, v235
v_add_f32 v168, v232, v233
v_add_f32 v172, v234, v235
v_mfma_f32_32x32x16_bf16 v[176:191], a[140:143], v[76:79], v[176:191]
s_waitcnt lgkmcnt(3)
ds_read_b128 a[132:135], v25 offset:56352
v_cvt_pk_bf16_f32 v141, v242, v243
v_exp_f32 v240, v124
v_lshlrev_b32 v228, 16, v169
v_and_b32_e64 v229, s74, v169
v_mfma_f32_32x32x16_bf16 v[176:191], a[144:147], v[80:83], v[176:191]
ds_read_b128 a[136:139], v25 offset:56384
v_exp_f32 v241, v125
v_lshlrev_b32 v230, 16, v173
v_and_b32 v231, s74, v173
v_mul_f32 v232, v228, v224
v_mfma_f32_32x32x16_bf16 v[176:191], a[148:151], v[84:87], v[176:191]
s_waitcnt lgkmcnt(3)
ds_read_b128 a[140:143], v25 offset:56416
v_add_f32 v31, v31, v240
v_add_f32_e64 v31, v31, v241
v_cvt_pk_bf16_f32 v142, v240, v241
v_mul_f32 v233, v228, v226
v_mul_f32 v234, v229, v224
v_mul_f32_e64 v235, v229, v226
v_mfma_f32_32x32x16_bf16 v[176:191], a[152:155], v[88:91], v[176:191]
ds_read_b128 a[144:147], v25 offset:56448
v_exp_f32 v242, v126
v_fmac_f32 v232, v230, v225
v_fmac_f32 v233, v230, v227
v_fmac_f32 v234, v231, v225
v_mfma_f32_32x32x16_bf16 v[176:191], a[156:159], v[92:95], v[176:191]
s_waitcnt lgkmcnt(3)
ds_read_b128 a[148:151], v25 offset:56480
v_exp_f32 v243, v127
v_add_f32_e64 v31, v31, v242
v_fmac_f32 v235, v231, v227
v_nop
v_mfma_f32_32x32x16_bf16 v[192:207], a[128:131], v[32:35], v[208:223]
ds_read_b128 a[152:155], v25 offset:56512
v_add_f32 v31, v31, v243
v_cvt_pk_bf16_f32 v143, v242, v243
v_cmp_nge_f32 vcc, 0x47800000, v31
v_permlane32_swap_b32 v232, v233
v_mfma_f32_32x32x16_bf16 v[192:207], a[132:135], v[36:39], v[192:207]
s_cbranch_vccnz recurrent_scan__sliding_block_cached__moe_arch_mod__prompt_kernel_stub4
recurrent_scan__sliding_block_cached__moe_arch_mod__prompt_kernel_back4:
s_waitcnt lgkmcnt(3)
ds_read_b128 a[156:159], v25 offset:56544
v_add_f32_e64 v30, v30, v31
v_exp_f32 v240, v176
v_permlane32_swap_b32 v234, v235
v_mfma_f32_32x32x16_bf16 v[192:207], a[136:139], v[40:43], v[192:207]
ds_read_b128 a[128:131], v25 offset:56576
v_exp_f32 v241, v177
v_add_f32 v169, v232, v233
v_add_f32 v173, v234, v235
v_lshlrev_b32 v228, 16, v170
v_mfma_f32_32x32x16_bf16 v[192:207], a[140:143], v[44:47], v[192:207]
s_waitcnt lgkmcnt(3)
ds_read_b128 a[132:135], v25 offset:56608
v_nop
v_add_f32_e64 v31, v240, v241
v_cvt_pk_bf16_f32 v144, v240, v241
v_and_b32 v229, s74, v170
v_lshlrev_b32 v230, 16, v174
v_mfma_f32_32x32x16_bf16 v[192:207], a[144:147], v[48:51], v[192:207]
ds_read_b128 a[136:139], v25 offset:56640
v_exp_f32 v242, v178
v_exp_f32 v243, v179
v_and_b32 v231, s74, v174
v_mfma_f32_32x32x16_bf16 v[192:207], a[148:151], v[52:55], v[192:207]
s_waitcnt lgkmcnt(3)
ds_read_b128 a[140:143], v25 offset:56672
v_add_f32 v31, v31, v242
v_add_f32 v31, v31, v243
v_cvt_pk_bf16_f32 v145, v242, v243
v_mul_f32 v232, v228, v224
v_mul_f32 v233, v228, v226
v_mfma_f32_32x32x16_bf16 v[192:207], a[152:155], v[56:59], v[192:207]
ds_read_b128 a[144:147], v25 offset:56704
v_exp_f32 v240, v180
v_mul_f32 v234, v229, v224
v_mul_f32 v235, v229, v226
v_fmac_f32 v232, v230, v225
v_fmac_f32 v233, v230, v227
v_mfma_f32_32x32x16_bf16 v[192:207], a[156:159], v[60:63], v[192:207]
s_waitcnt lgkmcnt(3)
ds_read_b128 a[148:151], v25 offset:56736
v_exp_f32 v241, v181
v_add_f32 v31, v31, v240
v_add_f32 v31, v31, v241
v_fmac_f32 v234, v231, v225
v_mfma_f32_32x32x16_bf16 v[192:207], a[128:131], v[64:67], v[192:207]
s_add_u32 m0, s72, 104448
ds_read_b128 a[152:155], v25 offset:56768
v_cvt_pk_bf16_f32 v146, v240, v241
v_exp_f32 v242, v182
v_fmac_f32 v235, v231, v227
v_nop
v_mfma_f32_32x32x16_bf16 v[192:207], a[132:135], v[68:71], v[192:207]
s_waitcnt lgkmcnt(4)
ds_read_b128 a[156:159], v25 offset:56800
v_exp_f32_e64 v243, v183
v_add_f32 v31, v31, v242
v_permlane32_swap_b32 v232, v233
v_mfma_f32_32x32x16_bf16 v[192:207], a[136:139], v[72:75], v[192:207]
s_waitcnt lgkmcnt(4)
s_barrier
ds_read_b64_tr_b16 a[128:129], v29 offset:8192
ds_read_b64_tr_b16 a[130:131], v29 offset:12544
v_mfma_f32_32x32x16_bf16 v[192:207], a[140:143], v[76:79], v[192:207]
s_waitcnt lgkmcnt(4)
ds_read_b64_tr_b16 a[132:133], v29 offset:8256
ds_read_b64_tr_b16 a[134:135], v29 offset:12608
v_add_f32 v31, v31, v243
v_cvt_pk_bf16_f32 v147, v242, v243
v_permlane32_swap_b32 v234, v235
v_add_f32 v170, v232, v233
v_mfma_f32_32x32x16_bf16 v[192:207], a[144:147], v[80:83], v[192:207]
s_xor_b32 s70, s0, 229376
ds_read_b64_tr_b16 a[136:137], v29 offset:8320
ds_read_b64_tr_b16 a[138:139], v29 offset:12672
buffer_load_dwordx4 v16, s[44:47], s70 offen offset:0 lds
v_add_f32_e64 v174, v234, v235
v_lshlrev_b32 v228, 16, v171
v_mfma_f32_32x32x16_bf16 v[192:207], a[148:151], v[84:87], v[192:207]
s_waitcnt lgkmcnt(6)
ds_read_b64_tr_b16 a[140:141], v29 offset:8384
ds_read_b64_tr_b16 a[142:143], v29 offset:12736
buffer_load_dwordx4 v17, s[44:47], s70 offen offset:1040 lds
v_and_b32 v229, s74, v171
v_lshlrev_b32 v230, 16, v175
v_mfma_f32_32x32x16_bf16 v[192:207], a[152:155], v[88:91], v[192:207]
ds_read_b64_tr_b16 a[144:145], v29 offset:8448
ds_read_b64_tr_b16 a[146:147], v29 offset:12800
v_exp_f32 v240, v184
v_and_b32 v231, s74, v175
v_mul_f32 v232, v228, v224
v_mfma_f32_32x32x16_bf16 v[192:207], a[156:159], v[92:95], v[192:207]
s_waitcnt lgkmcnt(6)
ds_read_b64_tr_b16 a[148:149], v29 offset:8512
ds_read_b64_tr_b16 a[150:151], v29 offset:12864
buffer_load_dwordx4 v18, s[44:47], s70 offen offset:2080 lds
v_mul_f32 v233, v228, v226
v_mul_f32 v234, v229, v224
v_mul_f32_e64 v235, v229, v226
v_mfma_f32_32x32x16_bf16 a[0:15], a[128:131], v[128:131], a[0:15]
ds_read_b64_tr_b16 a[152:153], v29 offset:8576
ds_read_b64_tr_b16 a[154:155], v29 offset:12928
v_exp_f32 v241, v185
v_add_f32 v31, v31, v240
v_fmac_f32 v232, v230, v225
v_mfma_f32_32x32x16_bf16 a[16:31], a[132:135], v[128:131], a[16:31]
s_waitcnt lgkmcnt(6)
ds_read_b64_tr_b16 a[156:157], v29 offset:8640
ds_read_b64_tr_b16 a[158:159], v29 offset:12992
buffer_load_dwordx4 v19, s[44:47], s70 offen offset:3120 lds
v_fmac_f32 v233, v230, v227
v_fmac_f32 v234, v231, v225
v_mfma_f32_32x32x16_bf16 a[32:47], a[136:139], v[128:131], a[32:47]
s_xor_b32 s69, s0, 245760
ds_read_b64_tr_b16 a[128:129], v29 offset:16896
ds_read_b64_tr_b16 a[130:131], v29 offset:21248
s_add_u32 m0, s72, 121856
v_add_f32_e64 v31, v31, v241
v_fmac_f32 v235, v231, v227
v_nop
v_mfma_f32_32x32x16_bf16 a[48:63], a[140:143], v[128:131], a[48:63]
s_waitcnt lgkmcnt(6)
ds_read_b64_tr_b16 a[132:133], v29 offset:16960
ds_read_b64_tr_b16 a[134:135], v29 offset:21312
buffer_load_dwordx4 v16, s[44:47], s69 offen offset:0 lds
v_permlane32_swap_b32 v232, v233
v_mfma_f32_32x32x16_bf16 a[64:79], a[144:147], v[128:131], a[64:79]
ds_read_b64_tr_b16 a[136:137], v29 offset:17024
ds_read_b64_tr_b16 a[138:139], v29 offset:21376
v_cvt_pk_bf16_f32 v148, v240, v241
v_exp_f32_e64 v242, v186
v_permlane32_swap_b32 v234, v235
v_mfma_f32_32x32x16_bf16 a[80:95], a[148:151], v[128:131], a[80:95]
s_waitcnt lgkmcnt(6)
ds_read_b64_tr_b16 a[140:141], v29 offset:17088
ds_read_b64_tr_b16 a[142:143], v29 offset:21440
buffer_load_dwordx4 v17, s[44:47], s69 offen offset:1040 lds
v_add_f32 v171, v232, v233
v_add_f32 v175, v234, v235
v_min_u32_e64 v252, 15, v0
v_mfma_f32_32x32x16_bf16 a[96:111], a[152:155], v[128:131], a[96:111]
ds_read_b64_tr_b16 a[144:145], v29 offset:17152
ds_read_b64_tr_b16 a[146:147], v29 offset:21504
v_exp_f32 v243, v187
v_permlane16_swap_b32 v160, v168
v_and_b32_e64 v251, 7, v252
v_mfma_f32_32x32x16_bf16 a[112:127], a[156:159], v[128:131], a[112:127]
s_waitcnt lgkmcnt(6)
ds_read_b64_tr_b16 a[148:149], v29 offset:17216
ds_read_b64_tr_b16 a[150:151], v29 offset:21568
buffer_load_dwordx4 v18, s[44:47], s69 offen offset:2080 lds
v_permlane16_swap_b32 v164, v172
v_mul_u32_u24 v251, 896, v251
v_mfma_f32_32x32x16_bf16 a[0:15], a[128:131], v[132:135], a[0:15]
ds_read_b64_tr_b16 a[152:153], v29 offset:17280
ds_read_b64_tr_b16 a[154:155], v29 offset:21632
v_add_f32 v31, v31, v242
v_add_f32 v31, v31, v243
v_permlane16_swap_b32 v161, v169
v_lshrrev_b32 v252, 3, v252
v_mfma_f32_32x32x16_bf16 a[16:31], a[132:135], v[132:135], a[16:31]
s_waitcnt lgkmcnt(6)
ds_read_b64_tr_b16 a[156:157], v29 offset:17344
ds_read_b64_tr_b16 a[158:159], v29 offset:21696
buffer_load_dwordx4 v19, s[44:47], s69 offen offset:3120 lds
v_permlane16_swap_b32 v165, v173
v_lshl_add_u32 v252, v252, 7, v251
v_mfma_f32_32x32x16_bf16 a[32:47], a[136:139], v[132:135], a[32:47]
ds_read_b64_tr_b16 a[128:129], v27 offset:0
ds_read_b64_tr_b16 a[130:131], v27 offset:4352
buffer_load_dword a255, v252, s[52:55], s1 offen offset:640
v_cvt_pk_bf16_f32 v149, v242, v243
v_exp_f32_e64 v240, v188
v_permlane16_swap_b32 v162, v170
v_mfma_f32_32x32x16_bf16 a[48:63], a[140:143], v[132:135], a[48:63]
s_waitcnt lgkmcnt(6)
ds_read_b64_tr_b16 a[132:133], v27 offset:64
ds_read_b64_tr_b16 a[134:135], v27 offset:4416
v_exp_f32 v241, v189
v_permlane16_swap_b32 v166, v174
v_xor_b32 v16, 0x2000, v5
v_mfma_f32_32x32x16_bf16 a[64:79], a[144:147], v[132:135], a[64:79]
ds_read_b64_tr_b16 a[136:137], v27 offset:128
ds_read_b64_tr_b16 a[138:139], v27 offset:4480
v_add_f32 v31, v31, v240
v_permlane16_swap_b32 v163, v171
v_permlane16_swap_b32 v167, v175
v_mfma_f32_32x32x16_bf16 a[80:95], a[148:151], v[132:135], a[80:95]
s_waitcnt lgkmcnt(6)
ds_read_b64_tr_b16 a[140:141], v27 offset:192
ds_read_b64_tr_b16 a[142:143], v27 offset:4544
v_add_f32_e64 v31, v31, v241
v_cvt_pk_bf16_f32 v150, v240, v241
v_add_f32 v160, v160, v168
v_add_f32 v164, v164, v172
v_add_u32 v17, 0x10000, v16
v_mfma_f32_32x32x16_bf16 a[96:111], a[152:155], v[132:135], a[96:111]
ds_read_b64_tr_b16 a[144:145], v27 offset:256
ds_read_b64_tr_b16 a[146:147], v27 offset:4608
v_exp_f32 v242, v190
v_add_f32 v161, v161, v169
v_add_f32 v165, v165, v173
v_mfma_f32_32x32x16_bf16 a[112:127], a[156:159], v[132:135], a[112:127]
s_waitcnt lgkmcnt(6)
ds_read_b64_tr_b16 a[148:149], v27 offset:320
ds_read_b64_tr_b16 a[150:151], v27 offset:4672
v_exp_f32 v243, v191
v_add_f32 v31, v31, v242
v_add_f32_e64 v162, v162, v170
v_add_u32 v18, 0x20000, v16
v_mfma_f32_32x32x16_bf16 a[0:15], a[128:131], v[136:139], a[0:15]
ds_read_b64_tr_b16 a[152:153], v27 offset:384
ds_read_b64_tr_b16 a[154:155], v27 offset:4736
v_add_f32_e64 v31, v31, v243
v_cvt_pk_bf16_f32 v151, v242, v243
v_add_f32_e64 v166, v166, v174
v_add_f32 v163, v163, v171
v_mfma_f32_32x32x16_bf16 a[16:31], a[132:135], v[136:139], a[16:31]
s_waitcnt lgkmcnt(6)
ds_read_b64_tr_b16 a[156:157], v27 offset:448
ds_read_b64_tr_b16 a[158:159], v27 offset:4800
v_exp_f32 v240, v192
v_add_f32 v167, v167, v175
v_add_f32_dpp v228, v160, v160 row_ror:8
v_add_f32_dpp v229, v164, v164 row_ror:8
v_mfma_f32_32x32x16_bf16 a[32:47], a[136:139], v[136:139], a[32:47]
ds_read_b64_tr_b16 a[128:129], v27 offset:8704
ds_read_b64_tr_b16 a[130:131], v27 offset:13056
v_exp_f32_e64 v241, v193
v_add_f32_dpp v230, v161, v161 row_ror:8
v_add_f32_dpp v231, v165, v165 row_ror:8
v_mfma_f32_32x32x16_bf16 a[48:63], a[140:143], v[136:139], a[48:63]
s_waitcnt lgkmcnt(6)
ds_read_b64_tr_b16 a[132:133], v27 offset:8768
ds_read_b64_tr_b16 a[134:135], v27 offset:13120
v_add_f32 v31, v31, v240
v_add_f32_e64 v31, v31, v241
v_add_f32_dpp v228, v162, v162 row_ror:8 bank_mask:0xc
v_add_f32_dpp v229, v166, v166 row_ror:8 bank_mask:0xc
v_mfma_f32_32x32x16_bf16 a[64:79], a[144:147], v[136:139], a[64:79]
ds_read_b64_tr_b16 a[136:137], v27 offset:8832
ds_read_b64_tr_b16 a[138:139], v27 offset:13184
v_cvt_pk_bf16_f32 v152, v240, v241
v_exp_f32 v242, v194
v_add_f32_dpp v230, v163, v163 row_ror:8 bank_mask:0xc
v_mfma_f32_32x32x16_bf16 a[80:95], a[148:151], v[136:139], a[80:95]
s_waitcnt lgkmcnt(6)
ds_read_b64_tr_b16 a[140:141], v27 offset:8896
ds_read_b64_tr_b16 a[142:143], v27 offset:13248
v_exp_f32_e64 v243, v195
v_add_f32_dpp v231, v167, v167 row_ror:8 bank_mask:0xc
v_lshrrev_b32_e64 v9, 2, v0
v_mfma_f32_32x32x16_bf16 a[96:111], a[152:155], v[136:139], a[96:111]
ds_read_b64_tr_b16 a[144:145], v27 offset:8960
ds_read_b64_tr_b16 a[146:147], v27 offset:13312
v_add_f32 v31, v31, v242
v_lshlrev_b32 v9, 3, v9
v_add_f32_dpp v232, v228, v228 row_half_mirror
v_add_f32_dpp v233, v229, v229 row_half_mirror
s_nop 0
v_add_f32_dpp v232, v230, v230 row_half_mirror bank_mask:0xa
v_mfma_f32_32x32x16_bf16 a[112:127], a[156:159], v[136:139], a[112:127]
s_waitcnt lgkmcnt(6)
ds_read_b64_tr_b16 a[148:149], v27 offset:9024
ds_read_b64_tr_b16 a[150:151], v27 offset:13376
v_add_f32_e64 v31, v31, v243
v_cvt_pk_bf16_f32 v153, v242, v243
v_add_f32_dpp v233, v231, v231 row_half_mirror bank_mask:0xa
v_add_u32 v9, 157696, v9
v_mfma_f32_32x32x16_bf16 a[0:15], a[128:131], v[140:143], a[0:15]
v_readlane_b32 s70, v244, 1
ds_read_b64_tr_b16 a[152:153], v27 offset:9088
ds_read_b64_tr_b16 a[154:155], v27 offset:13440
v_exp_f32 v240, v196
s_lshl_b32 s20, s66, 7
v_add_f32_dpp v232, v232, v232 quad_perm:[1,0,3,2]
v_mfma_f32_32x32x16_bf16 a[16:31], a[132:135], v[140:143], a[16:31]
s_waitcnt lgkmcnt(8)
ds_read_b64_tr_b16 a[156:157], v27 offset:9152
ds_read_b64_tr_b16 a[158:159], v27 offset:13504
v_exp_f32 v241, v197
v_add_f32_dpp v233, v233, v233 quad_perm:[1,0,3,2]
v_add_u32_e64 v10, s20, v9
v_mfma_f32_32x32x16_bf16 a[32:47], a[136:139], v[140:143], a[32:47]
s_waitcnt vmcnt(19) lgkmcnt(8)
s_barrier
ds_read_b128 a[128:131], v24 offset:17408
v_nop
v_add_f32_dpp v232, v232, v232 quad_perm:[2,3,0,1]
v_mfma_f32_32x32x16_bf16 a[48:63], a[140:143], v[140:143], a[48:63]
s_waitcnt lgkmcnt(5)
ds_read_b128 a[132:135], v24 offset:17440
v_add_f32 v31, v31, v240
v_add_f32 v31, v31, v241
v_cvt_pk_bf16_f32 v154, v240, v241
v_add_f32_dpp v233, v233, v233 quad_perm:[2,3,0,1]
v_mfma_f32_32x32x16_bf16 a[64:79], a[144:147], v[140:143], a[64:79]
s_add_u32 m0, s73, 139264
ds_read_b128 a[136:139], v24 offset:17472
buffer_load_dwordx4 v1, s[52:55], s70 offen offset:0 lds
ds_write_b64 v10, v[232:233]
v_exp_f32 v242, v198
v_mfma_f32_32x32x16_bf16 a[80:95], a[148:151], v[140:143], a[80:95]
s_waitcnt lgkmcnt(4)
ds_read_b128 a[140:143], v24 offset:17504
buffer_load_dwordx4 v2, s[52:55], s70 offen offset:1024 lds
v_mfma_f32_32x32x16_bf16 a[96:111], a[152:155], v[140:143], a[96:111]
ds_read_b128 a[144:147], v24 offset:17536
v_exp_f32_e64 v243, v199
v_add_f32 v31, v31, v242
v_mfma_f32_32x32x16_bf16 a[112:127], a[156:159], v[140:143], a[112:127]
s_waitcnt lgkmcnt(4)
ds_read_b128 a[148:151], v24 offset:17568
buffer_load_dwordx4 v3, s[52:55], s70 offen offset:2048 lds
v_add_f32_e64 v31, v31, v243
v_mfma_f32_32x32x16_bf16 v[96:111], a[128:131], v[32:35], v[208:223]
ds_read_b128 a[152:155], v24 offset:17600
v_cvt_pk_bf16_f32 v155, v242, v243
v_exp_f32 v240, v200
v_mfma_f32_32x32x16_bf16 v[96:111], a[132:135], v[36:39], v[96:111]
s_waitcnt lgkmcnt(3)
ds_read_b128 a[156:159], v24 offset:17632
buffer_load_dwordx4 v4, s[52:55], s70 offen offset:3072 lds
v_exp_f32_e64 v241, v201
v_mfma_f32_32x32x16_bf16 v[96:111], a[136:139], v[40:43], v[96:111]
v_readlane_b32 s69, v244, 0
ds_read_b128 a[128:131], v24 offset:17664
s_add_u32 m0, s73, 0
v_add_f32 v31, v31, v240
s_mul_i32 s31, s77, 448
s_mul_i32 s30, s66, 224
v_mfma_f32_32x32x16_bf16 v[96:111], a[140:143], v[44:47], v[96:111]
s_waitcnt lgkmcnt(3)
ds_read_b128 a[132:135], v24 offset:17696
buffer_load_dwordx4 v1, s[52:55], s69 offen offset:0 lds
v_add_f32 v31, v31, v241
v_mfma_f32_32x32x16_bf16 v[96:111], a[144:147], v[48:51], v[96:111]
ds_read_b128 a[136:139], v24 offset:17728
v_cvt_pk_bf16_f32 v156, v240, v241
v_exp_f32_e64 v242, v202
s_add_u32 s31, s31, s30
v_mfma_f32_32x32x16_bf16 v[96:111], a[148:151], v[52:55], v[96:111]
s_waitcnt lgkmcnt(3)
ds_read_b128 a[140:143], v24 offset:17760
buffer_load_dwordx4 v2, s[52:55], s69 offen offset:1024 lds
v_exp_f32_e64 v243, v203
v_mfma_f32_32x32x16_bf16 v[96:111], a[152:155], v[56:59], v[96:111]
ds_read_b128 a[144:147], v24 offset:17792
v_add_f32 v31, v31, v242
v_add_f32 v31, v31, v243
v_min_u32 v254, 55, v0
v_mfma_f32_32x32x16_bf16 v[96:111], a[156:159], v[60:63], v[96:111]
s_waitcnt lgkmcnt(3)
ds_read_b128 a[148:151], v24 offset:17824
buffer_load_dwordx4 v3, s[52:55], s69 offen offset:2048 lds
v_cvt_pk_bf16_f32 v157, v242, v243
v_lshlrev_b32_e64 v254, 2, v254
v_mfma_f32_32x32x16_bf16 v[96:111], a[128:131], v[64:67], v[96:111]
ds_read_b128 a[152:155], v24 offset:17856
ds_read_b64_tr_b16 a[176:177], v16 offset:34816
ds_read_b64_tr_b16 a[178:179], v16 offset:35840
v_exp_f32 v240, v204
v_mfma_f32_32x32x16_bf16 v[96:111], a[132:135], v[68:71], v[96:111]
s_waitcnt lgkmcnt(5)
ds_read_b128 a[156:159], v24 offset:17888
buffer_load_dwordx4 v4, s[52:55], s69 offen offset:3072 lds
s_add_u32 s30, s31, 3584
v_mfma_f32_32x32x16_bf16 v[96:111], a[136:139], v[72:75], v[96:111]
ds_read_b128 a[128:131], v24 offset:52224
ds_read_b64_tr_b16 a[180:181], v16 offset:36864
ds_read_b64_tr_b16 a[182:183], v16 offset:37888
buffer_load_dword a232, v254, s[12:15], s31 offen offset:0
buffer_load_dword a233, v254, s[12:15], s31 offen offset:896
v_exp_f32 v241, v205
v_mfma_f32_32x32x16_bf16 v[96:111], a[140:143], v[76:79], v[96:111]
s_waitcnt lgkmcnt(7)
ds_read_b128 a[132:135], v24 offset:52256
buffer_load_dword a234, v254, s[12:15], s31 offen offset:1792
buffer_load_dword a235, v254, s[12:15], s31 offen offset:2688
v_add_f32 v31, v31, v240
v_add_f32 v31, v31, v241
v_mfma_f32_32x32x16_bf16 v[96:111], a[144:147], v[80:83], v[96:111]
ds_read_b128 a[136:139], v24 offset:52288
ds_read_b64_tr_b16 a[184:185], v16 offset:38912
ds_read_b64_tr_b16 a[186:187], v16 offset:39936
buffer_load_dword a236, v254, s[12:15], s30 offen offset:0
buffer_load_dword a237, v254, s[12:15], s30 offen offset:896
v_cvt_pk_bf16_f32 v158, v240, v241
v_mfma_f32_32x32x16_bf16 v[96:111], a[148:151], v[84:87], v[96:111]
s_waitcnt lgkmcnt(7)
ds_read_b128 a[140:143], v24 offset:52320
buffer_load_dword a238, v254, s[12:15], s30 offen offset:1792
buffer_load_dword a239, v254, s[12:15], s30 offen offset:2688
v_exp_f32 v242, v206
v_exp_f32_e64 v243, v207
v_mfma_f32_32x32x16_bf16 v[96:111], a[152:155], v[88:91], v[96:111]
ds_read_b128 a[144:147], v24 offset:52352
ds_read_b64_tr_b16 a[188:189], v16 offset:40960
ds_read_b64_tr_b16 a[190:191], v16 offset:41984
v_mfma_f32_32x32x16_bf16 v[96:111], a[156:159], v[92:95], v[96:111]
s_waitcnt lgkmcnt(7)
ds_read_b128 a[148:151], v24 offset:52384
v_add_f32 v31, v31, v242
v_add_f32_e64 v31, v31, v243
v_cvt_pk_bf16_f32 v159, v242, v243
v_mfma_f32_32x32x16_bf16 v[112:127], a[128:131], v[32:35], v[208:223]
ds_read_b128 a[152:155], v24 offset:52416
ds_read_b64_tr_b16 a[192:193], v5 offset:34816
ds_read_b64_tr_b16 a[194:195], v5 offset:35840
v_cmp_nge_f32 vcc, 0x47800000, v31
v_mfma_f32_32x32x16_bf16 v[112:127], a[132:135], v[36:39], v[112:127]
s_cbranch_vccnz recurrent_scan__sliding_block_cached__moe_arch_mod__prompt_kernel_stub5
recurrent_scan__sliding_block_cached__moe_arch_mod__prompt_kernel_back5:
s_waitcnt lgkmcnt(7)
ds_read_b128 a[156:159], v24 offset:52448
v_add_f32 v30, v30, v31
v_exp_f32 v240, v96
v_mfma_f32_32x32x16_bf16 v[112:127], a[136:139], v[40:43], v[112:127]
ds_read_b128 a[128:131], v24 offset:52480
ds_read_b64_tr_b16 a[196:197], v5 offset:36864
ds_read_b64_tr_b16 a[198:199], v5 offset:37888
v_exp_f32 v241, v97
v_mfma_f32_32x32x16_bf16 v[112:127], a[140:143], v[44:47], v[112:127]
s_waitcnt lgkmcnt(7)
ds_read_b128 a[132:135], v24 offset:52512
v_nop
v_add_f32 v31, v240, v241
v_cvt_pk_bf16_f32 v128, v240, v241
v_mfma_f32_32x32x16_bf16 v[112:127], a[144:147], v[48:51], v[112:127]
ds_read_b128 a[136:139], v24 offset:52544
ds_read_b64_tr_b16 a[200:201], v5 offset:38912
ds_read_b64_tr_b16 a[202:203], v5 offset:39936
v_exp_f32 v242, v98
v_mfma_f32_32x32x16_bf16 v[112:127], a[148:151], v[52:55], v[112:127]
s_waitcnt lgkmcnt(7)
ds_read_b128 a[140:143], v24 offset:52576
v_exp_f32 v243, v99
v_add_f32 v31, v31, v242
v_mfma_f32_32x32x16_bf16 v[112:127], a[152:155], v[56:59], v[112:127]
ds_read_b128 a[144:147], v24 offset:52608
ds_read_b64_tr_b16 a[204:205], v5 offset:40960
ds_read_b64_tr_b16 a[206:207], v5 offset:41984
v_add_f32_e64 v31, v31, v243
v_cvt_pk_bf16_f32 v129, v242, v243
v_mfma_f32_32x32x16_bf16 v[112:127], a[156:159], v[60:63], v[112:127]
s_waitcnt lgkmcnt(7)
ds_read_b128 a[148:151], v24 offset:52640
v_exp_f32 v240, v100
v_exp_f32_e64 v241, v101
v_mfma_f32_32x32x16_bf16 v[112:127], a[128:131], v[64:67], v[112:127]
s_add_u32 m0, s71, 17408
ds_read_b128 a[152:155], v24 offset:52672
v_add_f32 v31, v31, v240
v_add_f32 v31, v31, v241
v_cvt_pk_bf16_f32 v130, v240, v241
v_mfma_f32_32x32x16_bf16 v[112:127], a[132:135], v[68:71], v[112:127]
s_waitcnt lgkmcnt(8)
ds_read_b128 a[156:159], v24 offset:52704
v_exp_f32 v242, v102
v_exp_f32 v243, v103
v_mfma_f32_32x32x16_bf16 v[112:127], a[136:139], v[72:75], v[112:127]
s_waitcnt vmcnt(30) lgkmcnt(6)
s_barrier
ds_read_b64_tr_b16 a[128:129], v28 offset:4096
ds_read_b64_tr_b16 a[130:131], v28 offset:8448
v_mfma_f32_32x32x16_bf16 v[112:127], a[140:143], v[76:79], v[112:127]
s_waitcnt lgkmcnt(4)
ds_read_b64_tr_b16 a[132:133], v28 offset:4160
ds_read_b64_tr_b16 a[134:135], v28 offset:8512
ds_read_b64 v[160:161], v9 offset:0
ds_read_b64 v[162:163], v9 offset:128
ds_read_b64 v[164:165], v9 offset:256
v_add_f32 v31, v31, v242
v_add_f32 v31, v31, v243
v_mfma_f32_32x32x16_bf16 v[112:127], a[144:147], v[80:83], v[112:127]
s_xor_b32 s70, s0, 196608
ds_read_b64_tr_b16 a[136:137], v28 offset:4224
ds_read_b64_tr_b16 a[138:139], v28 offset:8576
buffer_load_dwordx4 v20, s[48:51], s70 offen offset:0 lds
ds_read_b64 v[166:167], v9 offset:384
v_cvt_pk_bf16_f32 v131, v242, v243
v_mfma_f32_32x32x16_bf16 v[112:127], a[148:151], v[84:87], v[112:127]
s_waitcnt lgkmcnt(10)
s_nop 0
ds_read_b64_tr_b16 a[140:141], v28 offset:4288
ds_read_b64_tr_b16 a[142:143], v28 offset:8640
buffer_load_dwordx4 v21, s[48:51], s70 offen offset:1088 lds
v_bfe_u32 v10, v0, 2, 2
v_bfe_u32 v11, v0, 4, 1
v_lshl_add_u32 v10, v10, 1, v11
v_mfma_f32_32x32x16_bf16 v[112:127], a[152:155], v[88:91], v[112:127]
ds_read_b64_tr_b16 a[144:145], v28 offset:4352
ds_read_b64_tr_b16 a[146:147], v28 offset:8704
v_exp_f32_e64 v240, v104
v_lshrrev_b32 v11, 5, v0
v_lshl_add_u32 v10, v11, 3, v10
v_mfma_f32_32x32x16_bf16 v[112:127], a[156:159], v[92:95], v[112:127]
s_waitcnt lgkmcnt(10)
ds_read_b64_tr_b16 a[148:149], v28 offset:4416
ds_read_b64_tr_b16 a[150:151], v28 offset:8768
buffer_load_dwordx4 v22, s[48:51], s70 offen offset:2176 lds
v_exp_f32 v241, v105
v_lshlrev_b32 v10, 2, v10
v_mfma_f32_32x32x16_bf16 a[0:15], a[128:131], v[144:147], a[0:15]
ds_read_b64_tr_b16 a[152:153], v28 offset:4480
ds_read_b64_tr_b16 a[154:155], v28 offset:8832
v_add_f32_e64 v31, v31, v240
v_add_f32 v31, v31, v241
v_add_u32 v10, 158208, v10
v_mov_b32 v11, 158208
v_mfma_f32_32x32x16_bf16 a[16:31], a[132:135], v[144:147], a[16:31]
s_waitcnt lgkmcnt(6)
ds_read_b64_tr_b16 a[156:157], v28 offset:4544
ds_read_b64_tr_b16 a[158:159], v28 offset:8896
buffer_load_dwordx4 v23, s[48:51], s70 offen offset:3264 lds
v_cvt_pk_bf16_f32 v132, v240, v241
v_add_f32 v160, v160, v162
v_add_f32 v161, v161, v163
v_mfma_f32_32x32x16_bf16 a[32:47], a[136:139], v[144:147], a[32:47]
v_readlane_b32 s69, v244, 4
ds_read_b64_tr_b16 a[128:129], v28 offset:12800
ds_read_b64_tr_b16 a[130:131], v28 offset:17152
s_add_u32 m0, s73, 34816
v_exp_f32_e64 v242, v106
v_add_f32 v164, v164, v166
v_mfma_f32_32x32x16_bf16 a[48:63], a[140:143], v[144:147], a[48:63]
s_waitcnt lgkmcnt(6)
ds_read_b64_tr_b16 a[132:133], v28 offset:12864
ds_read_b64_tr_b16 a[134:135], v28 offset:17216
buffer_load_dwordx4 v1, s[52:55], s69 offen offset:0 lds
v_add_f32 v165, v165, v167
v_add_f32 v160, v160, v164
v_add_f32_e64 v161, v161, v165
v_mfma_f32_32x32x16_bf16 a[64:79], a[144:147], v[144:147], a[64:79]
ds_read_b64_tr_b16 a[136:137], v28 offset:12928
ds_read_b64_tr_b16 a[138:139], v28 offset:17280
v_exp_f32_e64 v243, v107
v_lshlrev_b32 v12, 2, v0
v_cmp_gt_u32 s[18:19], s62, v0
v_mfma_f32_32x32x16_bf16 a[80:95], a[148:151], v[144:147], a[80:95]
s_waitcnt lgkmcnt(6)
ds_read_b64_tr_b16 a[140:141], v28 offset:12992
ds_read_b64_tr_b16 a[142:143], v28 offset:17344
buffer_load_dwordx4 v2, s[52:55], s69 offen offset:1024 lds
v_add_f32 v31, v31, v242
v_permlane16_swap_b32 v160, v161
v_mfma_f32_32x32x16_bf16 a[96:111], a[152:155], v[144:147], a[96:111]
ds_read_b64_tr_b16 a[144:145], v28 offset:13056
ds_read_b64_tr_b16 a[146:147], v28 offset:17408
v_add_f32_e64 v31, v31, v243
v_cvt_pk_bf16_f32 v133, v242, v243
v_cvt_pk_bf16_f32 v161, v160, v161
v_lshlrev_b32 v160, 16, v161
v_mfma_f32_32x32x16_bf16 a[112:127], a[156:159], v[144:147], a[112:127]
s_waitcnt lgkmcnt(6)
ds_read_b64_tr_b16 a[148:149], v28 offset:13120
ds_read_b64_tr_b16 a[150:151], v28 offset:17472
buffer_load_dwordx4 v3, s[52:55], s69 offen offset:2048 lds
v_exp_f32 v240, v108
v_and_b32 v161, s74, v161
v_mfma_f32_32x32x16_bf16 a[0:15], a[128:131], v[148:151], a[0:15]
v_readlane_b32 s70, v244, 5
ds_read_b64_tr_b16 a[152:153], v28 offset:13184
ds_read_b64_tr_b16 a[154:155], v28 offset:17536
v_exp_f32_e64 v241, v109
v_mul_f32 v162, 0xbfb8aa3b, v160
v_exp_f32 v162, v162
v_mfma_f32_32x32x16_bf16 a[16:31], a[132:135], v[148:151], a[16:31]
s_waitcnt lgkmcnt(8)
ds_read_b64_tr_b16 a[156:157], v28 offset:13248
ds_read_b64_tr_b16 a[158:159], v28 offset:17600
buffer_load_dwordx4 v4, s[52:55], s69 offen offset:3072 lds
v_mov_b32 v13, 2130706432
v_add_f32_e64 v162, 1.0, v162
v_mfma_f32_32x32x16_bf16 a[32:47], a[136:139], v[148:151], a[32:47]
s_waitcnt vmcnt(34) lgkmcnt(8)
s_barrier
ds_read_b64_tr_b16 a[128:129], v28 offset:21504
ds_read_b64_tr_b16 a[130:131], v28 offset:25856
s_add_u32 m0, s73, 52224
v_mfma_f32_32x32x16_bf16 a[48:63], a[140:143], v[148:151], a[48:63]
s_waitcnt lgkmcnt(6)
ds_read_b64_tr_b16 a[132:133], v28 offset:21568
ds_read_b64_tr_b16 a[134:135], v28 offset:25920
buffer_load_dwordx4 v1, s[52:55], s70 offen offset:0 lds
v_add_f32 v31, v31, v240
v_rcp_f32_e64 v162, v162
v_mfma_f32_32x32x16_bf16 a[64:79], a[144:147], v[148:151], a[64:79]
ds_read_b64_tr_b16 a[136:137], v28 offset:21632
ds_read_b64_tr_b16 a[138:139], v28 offset:25984
v_add_f32_e64 v31, v31, v241
v_cvt_pk_bf16_f32 v134, v240, v241
v_cndmask_b32 v12, v13, v12, s[18:19]
v_mul_f32 v160, v160, v162
v_mfma_f32_32x32x16_bf16 a[80:95], a[148:151], v[148:151], a[80:95]
s_waitcnt lgkmcnt(6)
ds_read_b64_tr_b16 a[140:141], v28 offset:21696
ds_read_b64_tr_b16 a[142:143], v28 offset:26048
buffer_load_dwordx4 v2, s[52:55], s70 offen offset:1024 lds
v_exp_f32_e64 v242, v110
v_cvt_pk_bf16_f32 v160, v160, v160
v_mfma_f32_32x32x16_bf16 a[96:111], a[152:155], v[148:151], a[96:111]
ds_read_b64_tr_b16 a[144:145], v28 offset:21760
ds_read_b64_tr_b16 a[146:147], v28 offset:26112
v_exp_f32 v243, v111
v_and_b32 v160, s74, v160
v_mul_f32 v160, v160, v161
v_mfma_f32_32x32x16_bf16 a[112:127], a[156:159], v[148:151], a[112:127]
s_waitcnt lgkmcnt(6)
ds_read_b64_tr_b16 a[148:149], v28 offset:21824
ds_read_b64_tr_b16 a[150:151], v28 offset:26176
buffer_load_dwordx4 v3, s[52:55], s70 offen offset:2048 lds
v_cvt_pk_bf16_f32 v160, v160, v160
v_and_b32_e64 v160, s74, v160
v_mfma_f32_32x32x16_bf16 a[0:15], a[128:131], v[152:155], a[0:15]
ds_read_b64_tr_b16 a[152:153], v28 offset:21888
ds_read_b64_tr_b16 a[154:155], v28 offset:26240
ds_write_b32 v10, v160
v_add_f32_e64 v31, v31, v242
v_add_f32 v31, v31, v243
v_cvt_pk_bf16_f32 v135, v242, v243
v_mfma_f32_32x32x16_bf16 a[16:31], a[132:135], v[152:155], a[16:31]
s_waitcnt lgkmcnt(7)
ds_read_b64_tr_b16 a[156:157], v28 offset:21952
ds_read_b64_tr_b16 a[158:159], v28 offset:26304
buffer_load_dwordx4 v4, s[52:55], s70 offen offset:3072 lds
ds_read_b128 v[160:163], v11 offset:0
ds_read_b128 v[164:167], v11 offset:16
ds_read_b128 v[168:171], v11 offset:32
v_mfma_f32_32x32x16_bf16 a[32:47], a[136:139], v[152:155], a[32:47]
s_xor_b32 s69, s0, 212992
ds_read_b64_tr_b16 a[128:129], v28 offset:30208
ds_read_b64_tr_b16 a[130:131], v28 offset:34560
ds_read_b128 v[172:175], v11 offset:48
s_add_u32 m0, s71, 69632
v_exp_f32 v240, v112
v_mfma_f32_32x32x16_bf16 a[48:63], a[140:143], v[152:155], a[48:63]
s_waitcnt lgkmcnt(11)
ds_read_b64_tr_b16 a[132:133], v28 offset:30272
ds_read_b64_tr_b16 a[134:135], v28 offset:34624
buffer_load_dwordx4 v20, s[48:51], s69 offen offset:0 lds
s_lshl_b32 s20, s64, 12
s_mul_i32 s21, s66, 224
s_add_u32 s20, s20, s21
v_mfma_f32_32x32x16_bf16 a[64:79], a[144:147], v[152:155], a[64:79]
ds_read_b64_tr_b16 a[136:137], v28 offset:30336
ds_read_b64_tr_b16 a[138:139], v28 offset:34688
v_exp_f32 v241, v113
s_add_u32 s20, s20, 16908288
v_mfma_f32_32x32x16_bf16 a[80:95], a[148:151], v[152:155], a[80:95]
s_waitcnt vmcnt(13) lgkmcnt(4)
ds_read_b64_tr_b16 a[140:141], v28 offset:30400
ds_read_b64_tr_b16 a[142:143], v28 offset:34752
buffer_load_dwordx4 v21, s[48:51], s69 offen offset:1088 lds
v_accvgpr_read_b32 v229, a232
v_lshlrev_b32 v228, 16, v229
v_and_b32 v229, s74, v229
v_mul_f32_e64 v224, v228, v160
v_mfma_f32_32x32x16_bf16 a[96:111], a[152:155], v[152:155], a[96:111]
ds_read_b64_tr_b16 a[144:145], v28 offset:30464
ds_read_b64_tr_b16 a[146:147], v28 offset:34816
v_add_f32 v31, v31, v240
v_mul_f32 v225, v229, v160
v_mul_f32_e64 v226, v228, v168
v_mul_f32 v227, v229, v168
v_mfma_f32_32x32x16_bf16 a[112:127], a[156:159], v[152:155], a[112:127]
s_waitcnt lgkmcnt(6)
ds_read_b64_tr_b16 a[148:149], v28 offset:30528
ds_read_b64_tr_b16 a[150:151], v28 offset:34880
buffer_load_dwordx4 v22, s[48:51], s69 offen offset:2176 lds
v_accvgpr_read_b32 v231, a233
v_lshlrev_b32 v230, 16, v231
v_and_b32 v231, s74, v231
v_mfma_f32_32x32x16_bf16 a[0:15], a[128:131], v[156:159], a[0:15]
ds_read_b64_tr_b16 a[152:153], v28 offset:30592
ds_read_b64_tr_b16 a[154:155], v28 offset:34944
v_add_f32_e64 v31, v31, v241
v_cvt_pk_bf16_f32 v136, v240, v241
v_fmac_f32_e64 v224, v230, v161
v_fmac_f32 v225, v231, v161
v_mfma_f32_32x32x16_bf16 a[16:31], a[132:135], v[156:159], a[16:31]
s_waitcnt lgkmcnt(8)
ds_read_b64_tr_b16 a[156:157], v28 offset:30656
ds_read_b64_tr_b16 a[158:159], v28 offset:35008
buffer_load_dwordx4 v23, s[48:51], s69 offen offset:3264 lds
v_fmac_f32 v226, v230, v169
v_fmac_f32 v227, v231, v169
v_accvgpr_read_b32 v229, a234
v_mfma_f32_32x32x16_bf16 a[32:47], a[136:139], v[156:159], a[32:47]
s_waitcnt lgkmcnt(8)
s_barrier
ds_read_b128 a[128:131], v25 offset:38912
s_add_u32 m0, s71, 87040
v_mfma_f32_32x32x16_bf16 a[48:63], a[140:143], v[156:159], a[48:63]
s_waitcnt lgkmcnt(5)
ds_read_b128 a[132:135], v25 offset:38944
v_exp_f32 v242, v114
v_exp_f32 v243, v115
v_lshlrev_b32 v228, 16, v229
v_and_b32_e64 v229, s74, v229
v_mfma_f32_32x32x16_bf16 a[64:79], a[144:147], v[156:159], a[64:79]
s_xor_b32 s70, s0, 229376
ds_read_b128 a[136:139], v25 offset:38976
buffer_load_dwordx4 v20, s[48:51], s70 offen offset:0 lds
v_fmac_f32 v224, v228, v162
v_fmac_f32 v225, v229, v162
v_fmac_f32 v226, v228, v170
v_mfma_f32_32x32x16_bf16 a[80:95], a[148:151], v[156:159], a[80:95]
s_waitcnt lgkmcnt(3)
ds_read_b128 a[140:143], v25 offset:39008
buffer_load_dwordx4 v21, s[48:51], s70 offen offset:1088 lds
v_add_f32 v31, v31, v242
v_fmac_f32 v227, v229, v170
v_accvgpr_read_b32 v231, a235
v_mfma_f32_32x32x16_bf16 a[96:111], a[152:155], v[156:159], a[96:111]
ds_read_b128 a[144:147], v25 offset:39040
v_add_f32_e64 v31, v31, v243
v_cvt_pk_bf16_f32 v137, v242, v243
v_exp_f32 v240, v116
v_lshlrev_b32 v230, 16, v231
v_and_b32 v231, s74, v231
v_mfma_f32_32x32x16_bf16 a[112:127], a[156:159], v[156:159], a[112:127]
s_waitcnt lgkmcnt(3)
ds_read_b128 a[148:151], v25 offset:39072
buffer_load_dwordx4 v22, s[48:51], s70 offen offset:2176 lds
v_fmac_f32 v224, v230, v163
v_fmac_f32 v225, v231, v163
v_fmac_f32_e64 v226, v230, v171
v_mfma_f32_32x32x16_bf16 v[176:191], a[128:131], v[32:35], v[208:223]
ds_read_b128 a[152:155], v25 offset:39104
v_exp_f32 v241, v117
v_add_f32 v31, v31, v240
v_add_f32_e64 v31, v31, v241
v_fmac_f32 v227, v231, v171
v_mfma_f32_32x32x16_bf16 v[176:191], a[132:135], v[36:39], v[176:191]
s_waitcnt lgkmcnt(3)
ds_read_b128 a[156:159], v25 offset:39136
buffer_load_dwordx4 v23, s[48:51], s70 offen offset:3264 lds
v_cvt_pk_bf16_f32 v138, v240, v241
v_accvgpr_read_b32 v229, a236
v_lshlrev_b32 v228, 16, v229
v_and_b32 v229, s74, v229
v_mfma_f32_32x32x16_bf16 v[176:191], a[136:139], v[40:43], v[176:191]
ds_read_b128 a[128:131], v25 offset:39168
v_exp_f32 v242, v118
v_fmac_f32 v224, v228, v164
v_fmac_f32 v225, v229, v164
v_fmac_f32 v226, v228, v172
v_mfma_f32_32x32x16_bf16 v[176:191], a[140:143], v[44:47], v[176:191]
s_waitcnt lgkmcnt(3)
ds_read_b128 a[132:135], v25 offset:39200
v_exp_f32 v243, v119
v_add_f32 v31, v31, v242
v_add_f32 v31, v31, v243
v_fmac_f32_e64 v227, v229, v172
v_mfma_f32_32x32x16_bf16 v[176:191], a[144:147], v[48:51], v[176:191]
ds_read_b128 a[136:139], v25 offset:39232
v_cvt_pk_bf16_f32 v139, v242, v243
v_exp_f32_e64 v240, v120
v_accvgpr_read_b32 v231, a237
v_lshlrev_b32 v230, 16, v231
v_and_b32 v231, s74, v231
v_mfma_f32_32x32x16_bf16 v[176:191], a[148:151], v[52:55], v[176:191]
s_waitcnt lgkmcnt(3)
ds_read_b128 a[140:143], v25 offset:39264
v_exp_f32 v241, v121
v_add_f32 v31, v31, v240
v_fmac_f32 v224, v230, v165
v_fmac_f32 v225, v231, v165
v_fmac_f32 v226, v230, v173
v_mfma_f32_32x32x16_bf16 v[176:191], a[152:155], v[56:59], v[176:191]
ds_read_b128 a[144:147], v25 offset:39296
v_add_f32_e64 v31, v31, v241
v_cvt_pk_bf16_f32 v140, v240, v241
v_fmac_f32_e64 v227, v231, v173
v_accvgpr_read_b32 v229, a238
v_lshlrev_b32 v228, 16, v229
v_mfma_f32_32x32x16_bf16 v[176:191], a[156:159], v[60:63], v[176:191]
s_waitcnt lgkmcnt(3)
ds_read_b128 a[148:151], v25 offset:39328
v_exp_f32 v242, v122
v_exp_f32 v243, v123
v_and_b32_e64 v229, s74, v229
v_mfma_f32_32x32x16_bf16 v[176:191], a[128:131], v[64:67], v[176:191]
s_add_u32 m0, s71, 104448
ds_read_b128 a[152:155], v25 offset:39360
v_add_f32 v31, v31, v242
v_add_f32 v31, v31, v243
v_cvt_pk_bf16_f32 v141, v242, v243
v_fmac_f32 v224, v228, v166
v_fmac_f32 v225, v229, v166
v_fmac_f32 v226, v228, v174
v_mfma_f32_32x32x16_bf16 v[176:191], a[132:135], v[68:71], v[176:191]
s_waitcnt lgkmcnt(4)
ds_read_b128 a[156:159], v25 offset:39392
v_exp_f32 v240, v124
v_fmac_f32 v227, v229, v174
v_accvgpr_read_b32 v231, a239
v_lshlrev_b32_e64 v230, 16, v231
v_mfma_f32_32x32x16_bf16 v[176:191], a[136:139], v[72:75], v[176:191]
s_waitcnt lgkmcnt(4)
s_barrier
ds_read_b128 a[128:131], v25 offset:56320
v_and_b32 v231, s74, v231
v_mfma_f32_32x32x16_bf16 v[176:191], a[140:143], v[76:79], v[176:191]
s_waitcnt lgkmcnt(3)
ds_read_b128 a[132:135], v25 offset:56352
v_exp_f32 v241, v125
v_add_f32 v31, v31, v240
v_add_f32 v31, v31, v241
v_fmac_f32 v224, v230, v167
v_fmac_f32_e64 v225, v231, v167
v_mfma_f32_32x32x16_bf16 v[176:191], a[144:147], v[80:83], v[176:191]
s_xor_b32 s69, s0, 245760
ds_read_b128 a[136:139], v25 offset:56384
buffer_load_dwordx4 v20, s[48:51], s69 offen offset:0 lds
v_cvt_pk_bf16_f32 v142, v240, v241
v_fmac_f32_e64 v226, v230, v175
v_fmac_f32 v227, v231, v175
v_mfma_f32_32x32x16_bf16 v[176:191], a[148:151], v[84:87], v[176:191]
s_waitcnt lgkmcnt(3)
ds_read_b128 a[140:143], v25 offset:56416
buffer_load_dwordx4 v21, s[48:51], s69 offen offset:1088 lds
buffer_atomic_add_f32 v224, v12, s[56:59], s20 offen offset:0 sc1
v_mfma_f32_32x32x16_bf16 v[176:191], a[152:155], v[88:91], v[176:191]
ds_read_b128 a[144:147], v25 offset:56448
buffer_atomic_add_f32 v225, v12, s[56:59], s20 offen offset:1024 sc1
v_exp_f32_e64 v242, v126
v_exp_f32 v243, v127
v_mfma_f32_32x32x16_bf16 v[176:191], a[156:159], v[92:95], v[176:191]
s_waitcnt lgkmcnt(3)
ds_read_b128 a[148:151], v25 offset:56480
buffer_load_dwordx4 v22, s[48:51], s69 offen offset:2176 lds
v_add_f32_e64 v31, v31, v242
v_mfma_f32_32x32x16_bf16 v[192:207], a[128:131], v[32:35], v[208:223]
ds_read_b128 a[152:155], v25 offset:56512
buffer_atomic_add_f32 v226, v12, s[56:59], s20 offen offset:2048 sc1
v_add_f32_e64 v31, v31, v243
v_cvt_pk_bf16_f32 v143, v242, v243
v_cmp_nge_f32 vcc, 0x47800000, v31
v_mfma_f32_32x32x16_bf16 v[192:207], a[132:135], v[36:39], v[192:207]
s_cbranch_vccnz recurrent_scan__sliding_block_cached__moe_arch_mod__prompt_kernel_stub6
recurrent_scan__sliding_block_cached__moe_arch_mod__prompt_kernel_back6:
s_waitcnt lgkmcnt(3)
ds_read_b128 a[156:159], v25 offset:56544
ds_read_b64_tr_b16 a[208:209], v18 offset:8192
ds_read_b64_tr_b16 a[210:211], v18 offset:9216
buffer_load_dwordx4 v23, s[48:51], s69 offen offset:3264 lds
v_add_f32_e64 v30, v30, v31
v_mfma_f32_32x32x16_bf16 v[192:207], a[136:139], v[40:43], v[192:207]
ds_read_b128 a[128:131], v25 offset:56576
ds_read_b64_tr_b16 a[212:213], v18 offset:10240
ds_read_b64_tr_b16 a[214:215], v18 offset:11264
v_exp_f32_e64 v240, v176
v_exp_f32 v241, v177
v_mfma_f32_32x32x16_bf16 v[192:207], a[140:143], v[44:47], v[192:207]
s_waitcnt lgkmcnt(7)
ds_read_b128 a[132:135], v25 offset:56608
ds_read_b64_tr_b16 a[216:217], v18 offset:12288
ds_read_b64_tr_b16 a[218:219], v18 offset:13312
v_nop
v_add_f32 v31, v240, v241
v_cvt_pk_bf16_f32 v144, v240, v241
v_mfma_f32_32x32x16_bf16 v[192:207], a[144:147], v[48:51], v[192:207]
ds_read_b128 a[136:139], v25 offset:56640
ds_read_b64_tr_b16 a[220:221], v18 offset:14336
ds_read_b64_tr_b16 a[222:223], v18 offset:15360
v_exp_f32_e64 v242, v178
v_exp_f32 v243, v179
v_mfma_f32_32x32x16_bf16 v[192:207], a[148:151], v[52:55], v[192:207]
s_waitcnt lgkmcnt(11)
ds_read_b128 a[140:143], v25 offset:56672
ds_read_b64_tr_b16 v[96:97], v7 offset:8192
ds_read_b64_tr_b16 v[98:99], v7 offset:9216
buffer_atomic_add_f32 v227, v12, s[56:59], s20 offen offset:3072 sc1
v_add_f32 v31, v31, v242
v_add_f32 v31, v31, v243
v_cvt_pk_bf16_f32 v145, v242, v243
v_mfma_f32_32x32x16_bf16 v[192:207], a[152:155], v[56:59], v[192:207]
ds_read_b128 a[144:147], v25 offset:56704
ds_read_b64_tr_b16 v[100:101], v7 offset:10240
ds_read_b64_tr_b16 v[102:103], v7 offset:11264
v_exp_f32_e64 v240, v180
v_exp_f32 v241, v181
v_mfma_f32_32x32x16_bf16 v[192:207], a[156:159], v[60:63], v[192:207]
s_waitcnt lgkmcnt(11)
ds_read_b128 a[148:151], v25 offset:56736
ds_read_b64_tr_b16 v[104:105], v7 offset:12288
ds_read_b64_tr_b16 v[106:107], v7 offset:13312
v_add_f32 v31, v31, v240
v_add_f32 v31, v31, v241
v_cvt_pk_bf16_f32 v146, v240, v241
v_exp_f32_e64 v242, v182
v_mfma_f32_32x32x16_bf16 v[192:207], a[128:131], v[64:67], v[192:207]
v_readlane_b32 s70, v244, 9
ds_read_b128 a[152:155], v25 offset:56768
ds_read_b64_tr_b16 v[108:109], v7 offset:14336
ds_read_b64_tr_b16 v[110:111], v7 offset:15360
v_exp_f32_e64 v243, v183
v_add_f32 v31, v31, v242
v_mfma_f32_32x32x16_bf16 v[192:207], a[132:135], v[68:71], v[192:207]
s_waitcnt lgkmcnt(14)
ds_read_b128 a[156:159], v25 offset:56800
ds_read_b64_tr_b16 v[112:113], v16 offset:0
ds_read_b64_tr_b16 v[114:115], v16 offset:1024
v_add_f32_e64 v31, v31, v243
v_cvt_pk_bf16_f32 v147, v242, v243
v_exp_f32_e64 v240, v184
v_mfma_f32_32x32x16_bf16 v[192:207], a[136:139], v[72:75], v[192:207]
s_waitcnt vmcnt(16) lgkmcnt(14)
s_barrier
ds_read_b64_tr_b16 a[128:129], v27 offset:17408
ds_read_b64_tr_b16 a[130:131], v27 offset:21760
ds_read_b64_tr_b16 v[116:117], v16 offset:2048
ds_read_b64_tr_b16 v[118:119], v16 offset:3072
v_mfma_f32_32x32x16_bf16 v[192:207], a[140:143], v[76:79], v[192:207]
s_waitcnt lgkmcnt(12)
s_nop 0
ds_read_b64_tr_b16 a[132:133], v27 offset:17472
ds_read_b64_tr_b16 a[134:135], v27 offset:21824
ds_read_b64_tr_b16 v[120:121], v16 offset:4096
ds_read_b64_tr_b16 v[122:123], v16 offset:5120
v_exp_f32 v241, v185
v_lshlrev_b32 v20, 4, v0
v_mfma_f32_32x32x16_bf16 v[192:207], a[144:147], v[80:83], v[192:207]
s_add_u32 m0, s73, 139264
ds_read_b64_tr_b16 a[136:137], v27 offset:17536
ds_read_b64_tr_b16 a[138:139], v27 offset:21888
ds_read_b64_tr_b16 v[64:65], v16 offset:6144
ds_read_b64_tr_b16 v[66:67], v16 offset:7168
buffer_load_dwordx4 v1, s[52:55], s70 offen offset:0 lds
v_add_f32 v31, v31, v240
v_mfma_f32_32x32x16_bf16 v[192:207], a[148:151], v[84:87], v[192:207]
s_waitcnt lgkmcnt(14)
ds_read_b64_tr_b16 a[140:141], v27 offset:17600
ds_read_b64_tr_b16 a[142:143], v27 offset:21952
ds_read_b64_tr_b16 v[160:161], v5 offset:0
ds_read_b64_tr_b16 v[162:163], v5 offset:1024
buffer_load_dwordx4 v2, s[52:55], s70 offen offset:1024 lds
v_mfma_f32_32x32x16_bf16 v[192:207], a[152:155], v[88:91], v[192:207]
ds_read_b64_tr_b16 a[144:145], v27 offset:17664
ds_read_b64_tr_b16 a[146:147], v27 offset:22016
ds_read_b64_tr_b16 v[164:165], v5 offset:2048
ds_read_b64_tr_b16 v[166:167], v5 offset:3072
v_add_f32_e64 v31, v31, v241
v_cvt_pk_bf16_f32 v148, v240, v241
v_exp_f32 v242, v186
v_mfma_f32_32x32x16_bf16 v[192:207], a[156:159], v[92:95], v[192:207]
s_waitcnt lgkmcnt(14)
ds_read_b64_tr_b16 a[148:149], v27 offset:17728
ds_read_b64_tr_b16 a[150:151], v27 offset:22080
ds_read_b64_tr_b16 v[168:169], v5 offset:4096
ds_read_b64_tr_b16 v[170:171], v5 offset:5120
buffer_load_dwordx4 v3, s[52:55], s70 offen offset:2048 lds
v_mfma_f32_32x32x16_bf16 a[0:15], a[128:131], v[128:131], a[0:15]
ds_read_b64_tr_b16 a[152:153], v27 offset:17792
ds_read_b64_tr_b16 a[154:155], v27 offset:22144
ds_read_b64_tr_b16 v[172:173], v5 offset:6144
ds_read_b64_tr_b16 v[174:175], v5 offset:7168
v_exp_f32 v243, v187
v_mfma_f32_32x32x16_bf16 a[16:31], a[132:135], v[128:131], a[16:31]
s_waitcnt lgkmcnt(14)
ds_read_b64_tr_b16 a[156:157], v27 offset:17856
ds_read_b64_tr_b16 a[158:159], v27 offset:22208
ds_read_b64_tr_b16 v[68:69], v16 offset:34816
ds_read_b64_tr_b16 v[70:71], v16 offset:35840
buffer_load_dwordx4 v4, s[52:55], s70 offen offset:3072 lds
v_add_f32_e64 v31, v31, v242
v_mfma_f32_32x32x16_bf16 a[32:47], a[136:139], v[128:131], a[32:47]
ds_read_b64_tr_b16 a[128:129], v27 offset:26112
ds_read_b64_tr_b16 a[130:131], v27 offset:30464
ds_read_b64_tr_b16 v[72:73], v16 offset:36864
ds_read_b64_tr_b16 v[74:75], v16 offset:37888
v_add_f32_e64 v31, v31, v243
v_cvt_pk_bf16_f32 v149, v242, v243
v_add_u32 v19, s78, v20
v_mfma_f32_32x32x16_bf16 a[48:63], a[140:143], v[128:131], a[48:63]
s_waitcnt lgkmcnt(14)
ds_read_b64_tr_b16 a[132:133], v27 offset:26176
ds_read_b64_tr_b16 a[134:135], v27 offset:30528
ds_read_b64_tr_b16 v[76:77], v16 offset:38912
ds_read_b64_tr_b16 v[78:79], v16 offset:39936
v_exp_f32 v240, v188
v_exp_f32 v241, v189
v_mfma_f32_32x32x16_bf16 a[64:79], a[144:147], v[128:131], a[64:79]
ds_read_b64_tr_b16 a[136:137], v27 offset:26240
ds_read_b64_tr_b16 a[138:139], v27 offset:30592
ds_read_b64_tr_b16 v[80:81], v16 offset:40960
ds_read_b64_tr_b16 v[82:83], v16 offset:41984
v_add_f32_e64 v31, v31, v240
v_add_f32 v31, v31, v241
v_mfma_f32_32x32x16_bf16 a[80:95], a[148:151], v[128:131], a[80:95]
s_waitcnt lgkmcnt(14)
ds_read_b64_tr_b16 a[140:141], v27 offset:26304
ds_read_b64_tr_b16 a[142:143], v27 offset:30656
ds_read_b64_tr_b16 v[84:85], v5 offset:34816
ds_read_b64_tr_b16 v[86:87], v5 offset:35840
v_cvt_pk_bf16_f32 v150, v240, v241
v_exp_f32_e64 v242, v190
v_mfma_f32_32x32x16_bf16 a[96:111], a[152:155], v[128:131], a[96:111]
ds_read_b64_tr_b16 a[144:145], v27 offset:26368
ds_read_b64_tr_b16 a[146:147], v27 offset:30720
ds_read_b64_tr_b16 v[88:89], v5 offset:36864
ds_read_b64_tr_b16 v[90:91], v5 offset:37888
v_exp_f32 v243, v191
v_mfma_f32_32x32x16_bf16 a[112:127], a[156:159], v[128:131], a[112:127]
s_waitcnt lgkmcnt(14)
ds_read_b64_tr_b16 a[148:149], v27 offset:26432
ds_read_b64_tr_b16 a[150:151], v27 offset:30784
ds_read_b64_tr_b16 v[92:93], v5 offset:38912
ds_read_b64_tr_b16 v[94:95], v5 offset:39936
v_add_f32 v31, v31, v242
v_add_f32 v31, v31, v243
v_cvt_pk_bf16_f32 v151, v242, v243
v_mfma_f32_32x32x16_bf16 a[0:15], a[128:131], v[132:135], a[0:15]
v_readlane_b32 s69, v244, 2
ds_read_b64_tr_b16 a[152:153], v27 offset:26496
ds_read_b64_tr_b16 a[154:155], v27 offset:30848
ds_read_b64_tr_b16 v[124:125], v5 offset:40960
ds_read_b64_tr_b16 v[126:127], v5 offset:41984
v_exp_f32 v240, v192
v_mfma_f32_32x32x16_bf16 a[16:31], a[132:135], v[132:135], a[16:31]
s_waitcnt lgkmcnt(15)
ds_read_b64_tr_b16 a[156:157], v27 offset:26560
ds_read_b64_tr_b16 a[158:159], v27 offset:30912
ds_read_b64_tr_b16 v[208:209], v16 offset:52224
ds_read_b64_tr_b16 v[210:211], v16 offset:53248
v_exp_f32 v241, v193
v_add_f32 v31, v31, v240
v_mfma_f32_32x32x16_bf16 a[32:47], a[136:139], v[132:135], a[32:47]
s_waitcnt vmcnt(16) lgkmcnt(15)
s_barrier
ds_read_b64_tr_b16 a[128:129], v28 offset:4096
ds_read_b64_tr_b16 a[130:131], v28 offset:8448
ds_read_b64_tr_b16 v[212:213], v16 offset:54272
ds_read_b64_tr_b16 v[214:215], v16 offset:55296
v_mfma_f32_32x32x16_bf16 a[48:63], a[140:143], v[132:135], a[48:63]
s_waitcnt lgkmcnt(14)
ds_read_b64_tr_b16 a[132:133], v28 offset:4160
ds_read_b64_tr_b16 a[134:135], v28 offset:8512
v_add_f32 v31, v31, v241
v_cvt_pk_bf16_f32 v152, v240, v241
v_exp_f32_e64 v242, v194
v_add_u32 v20, s79, v20
v_mfma_f32_32x32x16_bf16 a[64:79], a[144:147], v[132:135], a[64:79]
s_add_u32 m0, s73, 0
ds_read_b64_tr_b16 a[136:137], v28 offset:4224
ds_read_b64_tr_b16 a[138:139], v28 offset:8576
ds_read_b64_tr_b16 v[216:217], v16 offset:56320
ds_read_b64_tr_b16 v[218:219], v16 offset:57344
buffer_load_dwordx4 v1, s[52:55], s69 offen offset:0 lds
v_mfma_f32_32x32x16_bf16 a[80:95], a[148:151], v[132:135], a[80:95]
s_waitcnt lgkmcnt(12)
ds_read_b64_tr_b16 a[140:141], v28 offset:4288
ds_read_b64_tr_b16 a[142:143], v28 offset:8640
buffer_load_dwordx4 v2, s[52:55], s69 offen offset:1024 lds
v_exp_f32 v243, v195
v_add_f32_e64 v31, v31, v242
v_mfma_f32_32x32x16_bf16 a[96:111], a[152:155], v[132:135], a[96:111]
ds_read_b64_tr_b16 a[144:145], v28 offset:4352
ds_read_b64_tr_b16 a[146:147], v28 offset:8704
ds_read_b64_tr_b16 v[220:221], v16 offset:58368
ds_read_b64_tr_b16 v[222:223], v16 offset:59392
v_add_f32 v31, v31, v243
v_cvt_pk_bf16_f32 v153, v242, v243
v_mfma_f32_32x32x16_bf16 a[112:127], a[156:159], v[132:135], a[112:127]
s_waitcnt lgkmcnt(10)
ds_read_b64_tr_b16 a[148:149], v28 offset:4416
ds_read_b64_tr_b16 a[150:151], v28 offset:8768
buffer_load_dwordx4 v3, s[52:55], s69 offen offset:2048 lds
v_exp_f32 v240, v196
v_exp_f32 v241, v197
v_mfma_f32_32x32x16_bf16 a[0:15], a[128:131], v[136:139], a[0:15]
ds_read_b64_tr_b16 a[152:153], v28 offset:4480
ds_read_b64_tr_b16 a[154:155], v28 offset:8832
ds_read_b64_tr_b16 v[224:225], v5 offset:52224
ds_read_b64_tr_b16 v[226:227], v5 offset:53248
v_add_f32_e64 v31, v31, v240
v_add_f32 v31, v31, v241
v_mfma_f32_32x32x16_bf16 a[16:31], a[132:135], v[136:139], a[16:31]
s_waitcnt lgkmcnt(10)
ds_read_b64_tr_b16 a[156:157], v28 offset:4544
ds_read_b64_tr_b16 a[158:159], v28 offset:8896
buffer_load_dwordx4 v4, s[52:55], s69 offen offset:3072 lds
v_cvt_pk_bf16_f32 v154, v240, v241
v_exp_f32_e64 v242, v198
v_mfma_f32_32x32x16_bf16 a[32:47], a[136:139], v[136:139], a[32:47]
v_readlane_b32 s70, v244, 6
ds_read_b64_tr_b16 a[128:129], v28 offset:12800
ds_read_b64_tr_b16 a[130:131], v28 offset:17152
ds_read_b64_tr_b16 v[228:229], v5 offset:54272
ds_read_b64_tr_b16 v[230:231], v5 offset:55296
s_add_u32 m0, s73, 34816
v_mfma_f32_32x32x16_bf16 a[48:63], a[140:143], v[136:139], a[48:63]
s_waitcnt lgkmcnt(10)
ds_read_b64_tr_b16 a[132:133], v28 offset:12864
ds_read_b64_tr_b16 a[134:135], v28 offset:17216
buffer_load_dwordx4 v1, s[52:55], s70 offen offset:0 lds
v_exp_f32 v243, v199
v_add_f32_e64 v31, v31, v242
v_mfma_f32_32x32x16_bf16 a[64:79], a[144:147], v[136:139], a[64:79]
ds_read_b64_tr_b16 a[136:137], v28 offset:12928
ds_read_b64_tr_b16 a[138:139], v28 offset:17280
ds_read_b64_tr_b16 v[232:233], v5 offset:56320
ds_read_b64_tr_b16 v[234:235], v5 offset:57344
v_add_f32 v31, v31, v243
v_cvt_pk_bf16_f32 v155, v242, v243
v_mfma_f32_32x32x16_bf16 a[80:95], a[148:151], v[136:139], a[80:95]
s_waitcnt lgkmcnt(10)
ds_read_b64_tr_b16 a[140:141], v28 offset:12992
ds_read_b64_tr_b16 a[142:143], v28 offset:17344
buffer_load_dwordx4 v2, s[52:55], s70 offen offset:1024 lds
v_exp_f32 v240, v200
v_exp_f32 v241, v201
v_mfma_f32_32x32x16_bf16 a[96:111], a[152:155], v[136:139], a[96:111]
ds_read_b64_tr_b16 a[144:145], v28 offset:13056
ds_read_b64_tr_b16 a[146:147], v28 offset:17408
ds_read_b64_tr_b16 v[236:237], v5 offset:58368
ds_read_b64_tr_b16 v[238:239], v5 offset:59392
v_add_f32_e64 v31, v31, v240
v_add_f32 v31, v31, v241
v_mfma_f32_32x32x16_bf16 a[112:127], a[156:159], v[136:139], a[112:127]
s_waitcnt lgkmcnt(10)
ds_read_b64_tr_b16 a[148:149], v28 offset:13120
ds_read_b64_tr_b16 a[150:151], v28 offset:17472
buffer_load_dwordx4 v3, s[52:55], s70 offen offset:2048 lds
v_cvt_pk_bf16_f32 v156, v240, v241
v_exp_f32_e64 v242, v202
v_mfma_f32_32x32x16_bf16 a[0:15], a[128:131], v[140:143], a[0:15]
v_readlane_b32 s69, v244, 10
ds_read_b64_tr_b16 a[152:153], v28 offset:13184
ds_read_b64_tr_b16 a[154:155], v28 offset:17536
v_exp_f32 v243, v203
v_add_f32 v31, v31, v242
v_add_f32 v31, v31, v243
v_mfma_f32_32x32x16_bf16 a[16:31], a[132:135], v[140:143], a[16:31]
s_waitcnt lgkmcnt(12)
ds_read_b64_tr_b16 a[156:157], v28 offset:13248
ds_read_b64_tr_b16 a[158:159], v28 offset:17600
buffer_load_dwordx4 v4, s[52:55], s70 offen offset:3072 lds
v_cvt_pk_bf16_f32 v157, v242, v243
v_exp_f32_e64 v240, v204
v_mfma_f32_32x32x16_bf16 a[32:47], a[136:139], v[140:143], a[32:47]
s_waitcnt vmcnt(8) lgkmcnt(10)
s_barrier
ds_read_b64_tr_b16 a[128:129], v28 offset:21504
ds_read_b64_tr_b16 a[130:131], v28 offset:25856
s_add_u32 m0, s73, 17408
v_mfma_f32_32x32x16_bf16 a[48:63], a[140:143], v[140:143], a[48:63]
s_waitcnt lgkmcnt(6)
ds_read_b64_tr_b16 a[132:133], v28 offset:30208
ds_read_b64_tr_b16 a[134:135], v28 offset:34560
buffer_load_dwordx4 v1, s[52:55], s69 offen offset:0 lds
v_exp_f32 v241, v205
v_mfma_f32_32x32x16_bf16 a[64:79], a[144:147], v[140:143], a[64:79]
ds_read_b64_tr_b16 a[136:137], v28 offset:38912
ds_read_b64_tr_b16 a[138:139], v28 offset:43264
v_add_f32 v31, v31, v240
v_add_f32 v31, v31, v241
v_cvt_pk_bf16_f32 v158, v240, v241
v_exp_f32 v242, v206
v_mfma_f32_32x32x16_bf16 a[80:95], a[148:151], v[140:143], a[80:95]
s_waitcnt lgkmcnt(6)
ds_read_b64_tr_b16 a[140:141], v28 offset:47616
ds_read_b64_tr_b16 a[142:143], v28 offset:51968
buffer_load_dwordx4 v2, s[52:55], s69 offen offset:1024 lds
v_exp_f32_e64 v243, v207
v_mfma_f32_32x32x16_bf16 a[96:111], a[152:155], v[140:143], a[96:111]
ds_read_b64_tr_b16 a[144:145], v28 offset:21568
ds_read_b64_tr_b16 a[146:147], v28 offset:25920
v_add_f32 v31, v31, v242
v_add_f32 v31, v31, v243
v_cvt_pk_bf16_f32 v159, v242, v243
v_cmp_nge_f32 vcc, 0x47800000, v31
v_mfma_f32_32x32x16_bf16 a[112:127], a[156:159], v[140:143], a[112:127]
s_cbranch_vccnz recurrent_scan__sliding_block_cached__moe_arch_mod__prompt_kernel_stub7
recurrent_scan__sliding_block_cached__moe_arch_mod__prompt_kernel_back7:
s_waitcnt lgkmcnt(6)
ds_read_b64_tr_b16 a[148:149], v28 offset:30272
ds_read_b64_tr_b16 a[150:151], v28 offset:34624
buffer_load_dwordx4 v3, s[52:55], s69 offen offset:2048 lds
v_add_f32_e64 v30, v30, v31
v_mfma_f32_32x32x16_bf16 a[0:15], a[128:131], v[144:147], a[0:15]
ds_read_b64_tr_b16 a[152:153], v28 offset:38976
ds_read_b64_tr_b16 a[154:155], v28 offset:43328
ds_read_b64_tr_b16 v[176:177], v18 offset:8192
ds_read_b64_tr_b16 v[178:179], v18 offset:9216
v_mov_b32 v21, v30
v_nop
v_mfma_f32_32x32x16_bf16 a[0:15], a[132:135], v[148:151], a[0:15]
s_waitcnt lgkmcnt(8)
ds_read_b64_tr_b16 a[156:157], v28 offset:47680
ds_read_b64_tr_b16 a[158:159], v28 offset:52032
ds_read_b64_tr_b16 v[180:181], v18 offset:10240
ds_read_b64_tr_b16 v[182:183], v18 offset:11264
buffer_load_dwordx4 v4, s[52:55], s69 offen offset:3072 lds
v_permlane32_swap_b32 v30, v21
v_mfma_f32_32x32x16_bf16 a[0:15], a[136:139], v[152:155], a[0:15]
v_readlane_b32 s70, v244, 3
ds_read_b64_tr_b16 a[128:129], v28 offset:21632
ds_read_b64_tr_b16 a[130:131], v28 offset:25984
s_add_u32 m0, s73, 52224
v_add_f32_e64 v21, v30, v21
v_rcp_f32 v21, v21
v_mfma_f32_32x32x16_bf16 a[0:15], a[140:143], v[156:159], a[0:15]
s_waitcnt lgkmcnt(10)
ds_read_b64_tr_b16 a[132:133], v28 offset:30336
ds_read_b64_tr_b16 a[134:135], v28 offset:34688
ds_read_b64_tr_b16 v[184:185], v18 offset:12288
ds_read_b64_tr_b16 v[186:187], v18 offset:13312
buffer_load_dwordx4 v1, s[52:55], s70 offen offset:0 lds
v_mfma_f32_32x32x16_bf16 a[16:31], a[144:147], v[144:147], a[16:31]
ds_read_b64_tr_b16 a[136:137], v28 offset:39040
ds_read_b64_tr_b16 a[138:139], v28 offset:43392
ds_read_b64_tr_b16 v[188:189], v18 offset:14336
ds_read_b64_tr_b16 v[190:191], v18 offset:15360
v_mfma_f32_32x32x16_bf16 a[16:31], a[148:151], v[148:151], a[16:31]
s_waitcnt lgkmcnt(12)
s_nop 0
ds_read_b64_tr_b16 a[140:141], v28 offset:47744
ds_read_b64_tr_b16 a[142:143], v28 offset:52096
ds_read_b64_tr_b16 v[192:193], v7 offset:8192
ds_read_b64_tr_b16 v[194:195], v7 offset:9216
buffer_load_dwordx4 v2, s[52:55], s70 offen offset:1024 lds
v_accvgpr_read_b32 v240, a0
v_accvgpr_read_b32 v241, a1
v_mul_f32_e64 v240, v240, v21
v_mfma_f32_32x32x16_bf16 a[16:31], a[152:155], v[152:155], a[16:31]
ds_read_b64_tr_b16 a[144:145], v28 offset:21696
ds_read_b64_tr_b16 a[146:147], v28 offset:26048
ds_read_b64_tr_b16 v[196:197], v7 offset:10240
ds_read_b64_tr_b16 v[198:199], v7 offset:11264
v_mul_f32_e64 v241, v241, v21
v_cvt_pk_bf16_f32 v32, v240, v241
v_accvgpr_read_b32 v242, a2
v_accvgpr_read_b32 v243, a3
v_mul_f32 v242, v242, v21
v_mfma_f32_32x32x16_bf16 a[16:31], a[156:159], v[156:159], a[16:31]
s_waitcnt lgkmcnt(14)
ds_read_b64_tr_b16 a[148:149], v28 offset:30400
ds_read_b64_tr_b16 a[150:151], v28 offset:34752
buffer_load_dwordx4 v3, s[52:55], s70 offen offset:2048 lds
v_mul_f32_e64 v243, v243, v21
v_cvt_pk_bf16_f32 v33, v242, v243
v_accvgpr_read_b32 v240, a4
v_accvgpr_read_b32 v241, a5
v_mul_f32_e64 v240, v240, v21
v_mfma_f32_32x32x16_bf16 a[32:47], a[128:131], v[144:147], a[32:47]
v_readlane_b32 s69, v244, 7
ds_read_b64_tr_b16 a[152:153], v28 offset:39104
ds_read_b64_tr_b16 a[154:155], v28 offset:43456
ds_read_b64_tr_b16 v[200:201], v7 offset:12288
ds_read_b64_tr_b16 v[202:203], v7 offset:13312
v_mul_f32_e64 v241, v241, v21
v_cvt_pk_bf16_f32 v34, v240, v241
v_accvgpr_read_b32 v242, a6
v_accvgpr_read_b32 v243, a7
v_mul_f32 v242, v242, v21
v_mfma_f32_32x32x16_bf16 a[32:47], a[132:135], v[148:151], a[32:47]
s_waitcnt lgkmcnt(15)
ds_read_b64_tr_b16 a[156:157], v28 offset:47808
ds_read_b64_tr_b16 a[158:159], v28 offset:52160
ds_read_b64_tr_b16 v[204:205], v7 offset:14336
ds_read_b64_tr_b16 v[206:207], v7 offset:15360
buffer_load_dwordx4 v4, s[52:55], s70 offen offset:3072 lds
v_mul_f32_e64 v243, v243, v21
v_cvt_pk_bf16_f32 v35, v242, v243
v_accvgpr_read_b32 v240, a8
v_mfma_f32_32x32x16_bf16 a[32:47], a[136:139], v[152:155], a[32:47]
s_waitcnt vmcnt(12) lgkmcnt(15)
s_barrier
ds_read_b64_tr_b16 a[128:129], v28 offset:21760
ds_read_b64_tr_b16 a[130:131], v28 offset:26112
s_add_u32 m0, s73, 69632
v_accvgpr_read_b32 v241, a9
v_mul_f32 v240, v240, v21
v_mfma_f32_32x32x16_bf16 a[32:47], a[140:143], v[156:159], a[32:47]
s_waitcnt lgkmcnt(10)
ds_read_b64_tr_b16 a[132:133], v28 offset:30464
ds_read_b64_tr_b16 a[134:135], v28 offset:34816
buffer_load_dwordx4 v1, s[52:55], s69 offen offset:0 lds
v_mul_f32_e64 v241, v241, v21
v_cvt_pk_bf16_f32 v36, v240, v241
v_accvgpr_read_b32 v242, a10
v_accvgpr_read_b32 v243, a11
v_mul_f32_e64 v242, v242, v21
v_mfma_f32_32x32x16_bf16 a[48:63], a[144:147], v[144:147], a[48:63]
ds_read_b64_tr_b16 a[136:137], v28 offset:39168
ds_read_b64_tr_b16 a[138:139], v28 offset:43520
v_mul_f32_e64 v243, v243, v21
v_cvt_pk_bf16_f32 v37, v242, v243
v_accvgpr_read_b32 v240, a12
v_accvgpr_read_b32 v241, a13
v_mul_f32_e64 v240, v240, v21
v_mul_f32 v241, v241, v21
v_cvt_pk_bf16_f32 v38, v240, v241
v_mfma_f32_32x32x16_bf16 a[48:63], a[148:151], v[148:151], a[48:63]
s_waitcnt lgkmcnt(8)
ds_read_b64_tr_b16 a[140:141], v28 offset:47872
ds_read_b64_tr_b16 a[142:143], v28 offset:52224
buffer_load_dwordx4 v2, s[52:55], s69 offen offset:1024 lds
v_accvgpr_read_b32 v242, a14
v_accvgpr_read_b32 v243, a15
v_mul_f32 v242, v242, v21
v_mul_f32 v243, v243, v21
v_cvt_pk_bf16_f32 v39, v242, v243
v_mfma_f32_32x32x16_bf16 a[48:63], a[152:155], v[152:155], a[48:63]
ds_read_b64_tr_b16 a[144:145], v28 offset:21824
ds_read_b64_tr_b16 a[146:147], v28 offset:26176
v_accvgpr_read_b32 v240, a16
v_accvgpr_read_b32 v241, a17
v_mul_f32_e64 v240, v240, v21
v_mul_f32 v241, v241, v21
v_cvt_pk_bf16_f32 v40, v240, v241
v_accvgpr_read_b32 v242, a18
v_mfma_f32_32x32x16_bf16 a[48:63], a[156:159], v[156:159], a[48:63]
s_waitcnt lgkmcnt(6)
ds_read_b64_tr_b16 a[148:149], v28 offset:30528
ds_read_b64_tr_b16 a[150:151], v28 offset:34880
buffer_load_dwordx4 v3, s[52:55], s69 offen offset:2048 lds
v_accvgpr_read_b32 v243, a19
v_mul_f32 v242, v242, v21
v_mul_f32 v243, v243, v21
v_cvt_pk_bf16_f32 v41, v242, v243
v_mfma_f32_32x32x16_bf16 a[64:79], a[128:131], v[144:147], a[64:79]
ds_read_b64_tr_b16 a[152:153], v28 offset:39232
ds_read_b64_tr_b16 a[154:155], v28 offset:43584
ds_read_b64_tr_b16 a[0:1], v16 offset:0
ds_read_b64_tr_b16 a[2:3], v16 offset:1024
v_accvgpr_read_b32 v240, a20
v_accvgpr_read_b32 v241, a21
v_mul_f32_e64 v240, v240, v21
v_mul_f32 v241, v241, v21
v_mfma_f32_32x32x16_bf16 a[64:79], a[132:135], v[148:151], a[64:79]
s_waitcnt lgkmcnt(8)
ds_read_b64_tr_b16 a[156:157], v28 offset:47936
ds_read_b64_tr_b16 a[158:159], v28 offset:52288
buffer_load_dwordx4 v4, s[52:55], s69 offen offset:3072 lds
v_cvt_pk_bf16_f32 v42, v240, v241
v_accvgpr_read_b32 v242, a22
v_accvgpr_read_b32 v243, a23
v_mul_f32_e64 v242, v242, v21
v_mfma_f32_32x32x16_bf16 a[64:79], a[136:139], v[152:155], a[64:79]
v_readlane_b32 s70, v244, 11
ds_read_b64_tr_b16 a[128:129], v28 offset:21888
ds_read_b64_tr_b16 a[130:131], v28 offset:26240
ds_read_b64_tr_b16 a[4:5], v16 offset:2048
ds_read_b64_tr_b16 a[6:7], v16 offset:3072
s_add_u32 m0, s73, 139264
v_mul_f32_e64 v243, v243, v21
v_cvt_pk_bf16_f32 v43, v242, v243
v_accvgpr_read_b32 v240, a24
v_accvgpr_read_b32 v241, a25
v_mfma_f32_32x32x16_bf16 a[64:79], a[140:143], v[156:159], a[64:79]
s_waitcnt lgkmcnt(10)
ds_read_b64_tr_b16 a[132:133], v28 offset:30592
ds_read_b64_tr_b16 a[134:135], v28 offset:34944
buffer_load_dwordx4 v1, s[52:55], s70 offen offset:0 lds
v_mul_f32 v240, v240, v21
v_mul_f32_e64 v241, v241, v21
v_cvt_pk_bf16_f32 v44, v240, v241
v_accvgpr_read_b32 v242, a26
v_mfma_f32_32x32x16_bf16 a[80:95], a[144:147], v[144:147], a[80:95]
ds_read_b64_tr_b16 a[136:137], v28 offset:39296
ds_read_b64_tr_b16 a[138:139], v28 offset:43648
v_accvgpr_read_b32 v243, a27
v_mul_f32 v242, v242, v21
v_mul_f32 v243, v243, v21
v_cvt_pk_bf16_f32 v45, v242, v243
v_accvgpr_read_b32 v240, a28
v_accvgpr_read_b32 v241, a29
v_mfma_f32_32x32x16_bf16 a[80:95], a[148:151], v[148:151], a[80:95]
s_waitcnt lgkmcnt(8)
s_nop 0
ds_read_b64_tr_b16 a[140:141], v28 offset:48000
ds_read_b64_tr_b16 a[142:143], v28 offset:52352
ds_read_b64_tr_b16 a[8:9], v16 offset:4096
ds_read_b64_tr_b16 a[10:11], v16 offset:5120
buffer_load_dwordx4 v2, s[52:55], s70 offen offset:1024 lds
v_mul_f32 v240, v240, v21
v_mul_f32 v241, v241, v21
v_mfma_f32_32x32x16_bf16 a[80:95], a[152:155], v[152:155], a[80:95]
ds_read_b64_tr_b16 a[144:145], v28 offset:21952
ds_read_b64_tr_b16 a[146:147], v28 offset:26304
v_cvt_pk_bf16_f32 v46, v240, v241
v_accvgpr_read_b32 v242, a30
v_accvgpr_read_b32 v243, a31
v_mul_f32_e64 v242, v242, v21
v_mul_f32 v243, v243, v21
v_cvt_pk_bf16_f32 v47, v242, v243
v_mfma_f32_32x32x16_bf16 a[80:95], a[156:159], v[156:159], a[80:95]
s_waitcnt lgkmcnt(8)
ds_read_b64_tr_b16 a[148:149], v28 offset:30656
ds_read_b64_tr_b16 a[150:151], v28 offset:35008
ds_read_b64_tr_b16 a[12:13], v16 offset:6144
ds_read_b64_tr_b16 a[14:15], v16 offset:7168
ds_write_b128 v19, v[32:35] offset:0
ds_write_b128 v19, v[36:39] offset:4096
v_mfma_f32_32x32x16_bf16 a[96:111], a[128:131], v[144:147], a[96:111]
ds_read_b64_tr_b16 a[152:153], v28 offset:39360
ds_read_b64_tr_b16 a[154:155], v28 offset:43712
ds_write_b128 v19, v[40:43] offset:8192
ds_write_b128 v19, v[44:47] offset:12288
v_accvgpr_read_b32 v240, a32
v_mfma_f32_32x32x16_bf16 a[96:111], a[132:135], v[148:151], a[96:111]
s_waitcnt lgkmcnt(15)
s_nop 0
ds_read_b64_tr_b16 a[156:157], v28 offset:48064
ds_read_b64_tr_b16 a[158:159], v28 offset:52416
buffer_load_dwordx4 v3, s[52:55], s70 offen offset:2048 lds
v_accvgpr_read_b32 v241, a33
v_mul_f32 v240, v240, v21
v_mul_f32 v241, v241, v21
v_mfma_f32_32x32x16_bf16 a[96:111], a[136:139], v[152:155], a[96:111]
s_waitcnt vmcnt(15) lgkmcnt(2)
s_barrier
ds_read_b64_tr_b16 a[16:17], v5 offset:0
ds_read_b64_tr_b16 a[18:19], v5 offset:1024
v_cvt_pk_bf16_f32 v48, v240, v241
v_mfma_f32_32x32x16_bf16 a[96:111], a[140:143], v[156:159], a[96:111]
ds_read_b64_tr_b16 a[20:21], v5 offset:2048
ds_read_b64_tr_b16 a[22:23], v5 offset:3072
buffer_load_dwordx4 v4, s[52:55], s70 offen offset:3072 lds
ds_read_b128 a[160:163], v20 offset:0
v_accvgpr_read_b32 v242, a34
v_accvgpr_read_b32 v243, a35
v_mfma_f32_32x32x16_bf16 a[112:127], a[144:147], v[144:147], a[112:127]
v_readlane_b32 s69, v244, 12
ds_read_b64_tr_b16 a[24:25], v5 offset:4096
ds_read_b64_tr_b16 a[26:27], v5 offset:5120
ds_read_b128 a[164:167], v20 offset:4096
s_add_u32 m0, s73, 87040
v_mul_f32_e64 v242, v242, v21
v_mul_f32 v243, v243, v21
v_cvt_pk_bf16_f32 v49, v242, v243
v_mfma_f32_32x32x16_bf16 a[112:127], a[148:151], v[148:151], a[112:127]
s_waitcnt lgkmcnt(8)
ds_read_b64_tr_b16 a[28:29], v5 offset:6144
ds_read_b64_tr_b16 a[30:31], v5 offset:7168
buffer_load_dwordx4 v1, s[52:55], s69 offen offset:0 lds
ds_read_b128 a[168:171], v20 offset:8192
v_accvgpr_read_b32 v240, a36
v_accvgpr_read_b32 v241, a37
v_mfma_f32_32x32x16_bf16 a[112:127], a[152:155], v[152:155], a[112:127]
buffer_load_dwordx4 v2, s[52:55], s69 offen offset:1024 lds
ds_read_b128 a[172:175], v20 offset:12288
v_mul_f32 v240, v240, v21
v_mul_f32 v241, v241, v21
v_cvt_pk_bf16_f32 v50, v240, v241
v_mfma_f32_32x32x16_bf16 a[112:127], a[156:159], v[156:159], a[112:127]
v_accvgpr_read_b32 v242, a38
v_accvgpr_read_b32 v243, a39
v_mul_f32 v242, v242, v21
v_mul_f32 v243, v243, v21
v_cvt_pk_bf16_f32 v51, v242, v243
v_accvgpr_read_b32 v240, a40
v_accvgpr_read_b32 v241, a41
v_mfma_f32_32x32x16_bf16 v[128:143], v[112:115], v[32:35], 0
ds_read_b64_tr_b16 v[112:113], v16 offset:34816
ds_read_b64_tr_b16 v[114:115], v16 offset:35840
buffer_load_dwordx4 v3, s[52:55], s69 offen offset:2048 lds
v_mul_f32 v240, v240, v21
v_mul_f32 v241, v241, v21
v_cvt_pk_bf16_f32 v52, v240, v241
v_mfma_f32_32x32x16_bf16 v[128:143], v[116:119], v[36:39], v[128:143]
ds_read_b64_tr_b16 v[116:117], v16 offset:36864
ds_read_b64_tr_b16 v[118:119], v16 offset:37888
v_accvgpr_read_b32 v242, a42
v_accvgpr_read_b32 v243, a43
v_mul_f32 v242, v242, v21
v_mul_f32 v243, v243, v21
v_cvt_pk_bf16_f32 v53, v242, v243
v_mfma_f32_32x32x16_bf16 v[128:143], v[120:123], v[40:43], v[128:143]
v_readlane_b32 s70, v244, 13
ds_read_b64_tr_b16 v[120:121], v16 offset:38912
ds_read_b64_tr_b16 v[122:123], v16 offset:39936
buffer_load_dwordx4 v4, s[52:55], s69 offen offset:3072 lds
v_accvgpr_read_b32 v240, a44
v_accvgpr_read_b32 v241, a45
v_mul_f32_e64 v240, v240, v21
v_mfma_f32_32x32x16_bf16 v[128:143], v[64:67], v[44:47], v[128:143]
s_waitcnt lgkmcnt(13)
v_mul_f32 v241, v241, v21
v_cvt_pk_bf16_f32 v54, v240, v241
v_accvgpr_read_b32 v242, a46
v_accvgpr_read_b32 v243, a47
v_mul_f32 v242, v242, v21
v_mul_f32 v243, v243, v21
v_cvt_pk_bf16_f32 v55, v242, v243
v_mfma_f32_32x32x16_bf16 v[128:143], v[160:163], a[160:163], v[128:143]
s_waitcnt lgkmcnt(10)
s_add_u32 m0, s73, 104448
s_nop 0
buffer_load_dwordx4 v1, s[52:55], s70 offen offset:0 lds
v_accvgpr_read_b32 v240, a48
v_accvgpr_read_b32 v241, a49
v_mul_f32 v240, v240, v21
v_mfma_f32_32x32x16_bf16 v[128:143], v[164:167], a[164:167], v[128:143]
s_waitcnt lgkmcnt(7)
ds_read_b64_tr_b16 a[32:33], v16 offset:40960
ds_read_b64_tr_b16 a[34:35], v16 offset:41984
v_mul_f32_e64 v241, v241, v21
v_cvt_pk_bf16_f32 v56, v240, v241
v_accvgpr_read_b32 v242, a50
v_accvgpr_read_b32 v243, a51
v_mfma_f32_32x32x16_bf16 v[128:143], v[168:171], a[168:171], v[128:143]
s_waitcnt lgkmcnt(8)
ds_read_b64_tr_b16 a[36:37], v5 offset:34816
ds_read_b64_tr_b16 a[38:39], v5 offset:35840
buffer_load_dwordx4 v2, s[52:55], s70 offen offset:1024 lds
v_mul_f32 v242, v242, v21
v_mul_f32_e64 v243, v243, v21
v_accvgpr_read_b32 v250, a229
v_mfma_f32_32x32x16_bf16 v[128:143], v[172:175], a[172:175], v[128:143]
ds_read_b64_tr_b16 a[40:41], v5 offset:36864
ds_read_b64_tr_b16 a[42:43], v5 offset:37888
v_cvt_pk_bf16_f32 v57, v242, v243
v_accvgpr_read_b32 v240, a52
v_accvgpr_read_b32 v241, a53
v_mul_f32 v240, v240, v21
v_mov_b32 v251, 1
v_mfma_f32_32x32x16_bf16 v[144:159], v[68:71], v[32:35], 0
ds_read_b64_tr_b16 a[44:45], v5 offset:38912
ds_read_b64_tr_b16 a[46:47], v5 offset:39936
buffer_load_dwordx4 v3, s[52:55], s70 offen offset:2048 lds
v_mul_f32_e64 v241, v241, v21
v_cvt_pk_bf16_f32 v58, v240, v241
v_mfma_f32_32x32x16_bf16 v[144:159], v[72:75], v[36:39], v[144:159]
v_accvgpr_read_b32 v242, a54
v_accvgpr_read_b32 v243, a55
v_mul_f32 v242, v242, v21
v_mul_f32 v243, v243, v21
v_cvt_pk_bf16_f32 v59, v242, v243
v_accvgpr_read_b32 v240, a56
s_mov_b32 s17, 16941056
v_mfma_f32_32x32x16_bf16 v[144:159], v[76:79], v[40:43], v[144:159]
s_waitcnt vmcnt(19)
s_barrier
v_accvgpr_read_b32 v241, a57
v_mul_f32_e64 v240, v240, v21
v_mfma_f32_32x32x16_bf16 v[144:159], v[80:83], v[44:47], v[144:159]
buffer_load_dwordx4 v4, s[52:55], s70 offen offset:3072 lds
buffer_store_dword v251, v250, s[56:59], s17 offen sc1
v_mul_f32_e64 v241, v241, v21
v_cvt_pk_bf16_f32 v60, v240, v241
v_accvgpr_read_b32 v242, a58
v_accvgpr_read_b32 v243, a59
v_mfma_f32_32x32x16_bf16 v[144:159], v[84:87], a[160:163], v[144:159]
v_readlane_b32 s69, v244, 14
s_add_u32 m0, s73, 0
v_mul_f32 v242, v242, v21
v_mul_f32_e64 v243, v243, v21
v_cvt_pk_bf16_f32 v61, v242, v243
v_accvgpr_read_b32 v240, a60
v_accvgpr_read_b32 v241, a61
v_mfma_f32_32x32x16_bf16 v[144:159], v[88:91], a[164:167], v[144:159]
buffer_load_dwordx4 v1, s[52:55], s69 offen offset:0 lds
v_mul_f32 v240, v240, v21
v_mul_f32 v241, v241, v21
v_cvt_pk_bf16_f32 v62, v240, v241
v_accvgpr_read_b32 v242, a62
v_mfma_f32_32x32x16_bf16 v[144:159], v[92:95], a[168:171], v[144:159]
buffer_load_dwordx4 v2, s[52:55], s69 offen offset:1024 lds
v_accvgpr_read_b32 v243, a63
v_mul_f32 v242, v242, v21
v_mul_f32 v243, v243, v21
v_cvt_pk_bf16_f32 v63, v242, v243
v_mfma_f32_32x32x16_bf16 v[144:159], v[124:127], a[172:175], v[144:159]
ds_read_b64_tr_b16 v[124:125], v5 offset:40960
ds_read_b64_tr_b16 v[126:127], v5 offset:41984
ds_write_b128 v19, v[48:51] offset:0
ds_write_b128 v19, v[52:55] offset:4096
v_mfma_f32_32x32x16_bf16 v[160:175], a[176:179], v[32:35], 0
ds_write_b128 v19, v[56:59] offset:8192
ds_write_b128 v19, v[60:63] offset:12288
v_accvgpr_read_b32 v240, a64
v_accvgpr_read_b32 v241, a65
v_mfma_f32_32x32x16_bf16 v[160:175], a[180:183], v[36:39], v[160:175]
ds_read_b64_tr_b16 a[48:49], v16 offset:17408
ds_read_b64_tr_b16 a[50:51], v16 offset:18432
buffer_load_dwordx4 v3, s[52:55], s69 offen offset:2048 lds
v_mul_f32 v240, v240, v21
v_mul_f32 v241, v241, v21
v_mfma_f32_32x32x16_bf16 v[160:175], a[184:187], v[40:43], v[160:175]
s_waitcnt vmcnt(20) lgkmcnt(2)
s_barrier
ds_read_b64_tr_b16 a[52:53], v16 offset:19456
ds_read_b64_tr_b16 a[54:55], v16 offset:20480
v_mfma_f32_32x32x16_bf16 v[160:175], a[188:191], v[44:47], v[160:175]
ds_read_b64_tr_b16 a[56:57], v16 offset:21504
ds_read_b64_tr_b16 a[58:59], v16 offset:22528
buffer_load_dwordx4 v4, s[52:55], s69 offen offset:3072 lds
ds_read_b128 a[176:179], v20 offset:0
v_cvt_pk_bf16_f32 v64, v240, v241
v_mfma_f32_32x32x16_bf16 v[160:175], a[192:195], a[160:163], v[160:175]
v_readlane_b32 s70, v244, 15
ds_read_b64_tr_b16 a[60:61], v16 offset:23552
ds_read_b64_tr_b16 a[62:63], v16 offset:24576
ds_read_b128 a[180:183], v20 offset:4096
s_add_u32 m0, s73, 34816
v_accvgpr_read_b32 v242, a66
v_accvgpr_read_b32 v243, a67
v_mfma_f32_32x32x16_bf16 v[160:175], a[196:199], a[164:167], v[160:175]
buffer_load_dwordx4 v1, s[52:55], s70 offen offset:0 lds
ds_read_b128 a[184:187], v20 offset:8192
v_mul_f32 v242, v242, v21
v_mul_f32 v243, v243, v21
v_cvt_pk_bf16_f32 v65, v242, v243
v_accvgpr_read_b32 v240, a68
v_mfma_f32_32x32x16_bf16 v[160:175], a[200:203], a[168:171], v[160:175]
buffer_load_dwordx4 v2, s[52:55], s70 offen offset:1024 lds
ds_read_b128 a[188:191], v20 offset:12288
v_accvgpr_read_b32 v241, a69
v_mul_f32 v240, v240, v21
v_mul_f32 v241, v241, v21
v_mfma_f32_32x32x16_bf16 v[160:175], a[204:207], a[172:175], v[160:175]
v_cvt_pk_bf16_f32 v66, v240, v241
v_accvgpr_read_b32 v242, a70
v_accvgpr_read_b32 v243, a71
v_mul_f32 v242, v242, v21
v_mul_f32 v243, v243, v21
v_cvt_pk_bf16_f32 v67, v242, v243
v_mfma_f32_32x32x16_bf16 v[128:143], a[208:211], v[48:51], v[128:143]
buffer_load_dwordx4 v3, s[52:55], s70 offen offset:2048 lds
v_accvgpr_read_b32 v240, a72
v_accvgpr_read_b32 v241, a73
v_mul_f32 v240, v240, v21
v_mul_f32 v241, v241, v21
v_mfma_f32_32x32x16_bf16 v[128:143], a[212:215], v[52:55], v[128:143]
v_cvt_pk_bf16_f32 v68, v240, v241
v_accvgpr_read_b32 v242, a74
v_accvgpr_read_b32 v243, a75
v_mul_f32 v242, v242, v21
v_mul_f32 v243, v243, v21
v_cvt_pk_bf16_f32 v69, v242, v243
v_mfma_f32_32x32x16_bf16 v[128:143], a[216:219], v[56:59], v[128:143]
buffer_load_dwordx4 v4, s[52:55], s70 offen offset:3072 lds
v_accvgpr_read_b32 v240, a76
v_accvgpr_read_b32 v241, a77
v_mul_f32_e64 v240, v240, v21
v_mul_f32 v241, v241, v21
v_mfma_f32_32x32x16_bf16 v[128:143], a[220:223], v[60:63], v[128:143]
s_waitcnt lgkmcnt(5)
v_cvt_pk_bf16_f32 v70, v240, v241
v_accvgpr_read_b32 v242, a78
v_accvgpr_read_b32 v243, a79
v_mul_f32_e64 v242, v242, v21
v_mul_f32 v243, v243, v21
v_cvt_pk_bf16_f32 v71, v242, v243
v_mfma_f32_32x32x16_bf16 v[128:143], v[96:99], a[176:179], v[128:143]
s_waitcnt lgkmcnt(2)
ds_read_b64_tr_b16 v[96:97], v5 offset:17408
ds_read_b64_tr_b16 v[98:99], v5 offset:18432
v_accvgpr_read_b32 v240, a80
v_accvgpr_read_b32 v241, a81
v_mul_f32_e64 v240, v240, v21
v_mul_f32 v241, v241, v21
v_mfma_f32_32x32x16_bf16 v[128:143], v[100:103], a[180:183], v[128:143]
s_waitcnt lgkmcnt(3)
ds_read_b64_tr_b16 v[100:101], v5 offset:19456
ds_read_b64_tr_b16 v[102:103], v5 offset:20480
v_cvt_pk_bf16_f32 v72, v240, v241
v_accvgpr_read_b32 v242, a82
v_accvgpr_read_b32 v243, a83
v_mul_f32_e64 v242, v242, v21
v_mul_f32 v243, v243, v21
v_mfma_f32_32x32x16_bf16 v[128:143], v[104:107], a[184:187], v[128:143]
s_waitcnt lgkmcnt(4)
ds_read_b64_tr_b16 v[104:105], v5 offset:21504
ds_read_b64_tr_b16 v[106:107], v5 offset:22528
v_cvt_pk_bf16_f32 v73, v242, v243
v_accvgpr_read_b32 v240, a84
v_accvgpr_read_b32 v241, a85
v_mul_f32_e64 v240, v240, v21
v_mfma_f32_32x32x16_bf16 v[128:143], v[108:111], a[188:191], v[128:143]
ds_read_b64_tr_b16 v[108:109], v5 offset:23552
ds_read_b64_tr_b16 v[110:111], v5 offset:24576
v_mul_f32_e64 v241, v241, v21
v_cvt_pk_bf16_f32 v74, v240, v241
v_accvgpr_read_b32 v242, a86
v_accvgpr_read_b32 v243, a87
v_mfma_f32_32x32x16_bf16 v[144:159], v[208:211], v[48:51], v[144:159]
v_readlane_b32 s69, v244, 16
ds_read_b64_tr_b16 v[208:209], v16 offset:52224
ds_read_b64_tr_b16 v[210:211], v16 offset:53248
v_mul_f32 v242, v242, v21
v_mul_f32 v243, v243, v21
v_cvt_pk_bf16_f32 v75, v242, v243
v_accvgpr_read_b32 v240, a88
v_accvgpr_read_b32 v241, a89
v_mfma_f32_32x32x16_bf16 v[144:159], v[212:215], v[52:55], v[144:159]
ds_read_b64_tr_b16 v[212:213], v16 offset:54272
ds_read_b64_tr_b16 v[214:215], v16 offset:55296
v_mul_f32 v240, v240, v21
v_mul_f32 v241, v241, v21
v_cvt_pk_bf16_f32 v76, v240, v241
v_accvgpr_read_b32 v242, a90
v_mfma_f32_32x32x16_bf16 v[144:159], v[216:219], v[56:59], v[144:159]
s_waitcnt vmcnt(21)
s_barrier
ds_read_b64_tr_b16 v[216:217], v16 offset:56320
ds_read_b64_tr_b16 v[218:219], v16 offset:57344
v_mfma_f32_32x32x16_bf16 v[144:159], v[220:223], v[60:63], v[144:159]
ds_read_b64_tr_b16 v[220:221], v16 offset:58368
ds_read_b64_tr_b16 v[222:223], v16 offset:59392
v_accvgpr_read_b32 v243, a91
v_mul_f32 v242, v242, v21
v_mul_f32 v243, v243, v21
v_cvt_pk_bf16_f32 v77, v242, v243
v_accvgpr_read_b32 v240, a92
v_mfma_f32_32x32x16_bf16 v[144:159], v[224:227], a[176:179], v[144:159]
s_add_u32 m0, s73, 17408
ds_read_b64_tr_b16 v[224:225], v5 offset:52224
ds_read_b64_tr_b16 v[226:227], v5 offset:53248
buffer_load_dwordx4 v1, s[52:55], s69 offen offset:0 lds
v_accvgpr_read_b32 v241, a93
v_mul_f32_e64 v240, v240, v21
v_mfma_f32_32x32x16_bf16 v[144:159], v[228:231], a[180:183], v[144:159]
ds_read_b64_tr_b16 v[228:229], v5 offset:54272
ds_read_b64_tr_b16 v[230:231], v5 offset:55296
buffer_load_dwordx4 v2, s[52:55], s69 offen offset:1024 lds
v_mul_f32_e64 v241, v241, v21
v_cvt_pk_bf16_f32 v78, v240, v241
v_mfma_f32_32x32x16_bf16 v[144:159], v[232:235], a[184:187], v[144:159]
ds_read_b64_tr_b16 v[232:233], v5 offset:56320
ds_read_b64_tr_b16 v[234:235], v5 offset:57344
v_accvgpr_read_b32 v242, a94
v_accvgpr_read_b32 v243, a95
v_mul_f32 v242, v242, v21
v_mul_f32 v243, v243, v21
v_cvt_pk_bf16_f32 v79, v242, v243
v_mfma_f32_32x32x16_bf16 v[144:159], v[236:239], a[188:191], v[144:159]
ds_read_b64_tr_b16 v[236:237], v5 offset:58368
ds_read_b64_tr_b16 v[238:239], v5 offset:59392
ds_write_b128 v19, v[64:67] offset:0
ds_write_b128 v19, v[68:71] offset:4096
v_mfma_f32_32x32x16_bf16 v[160:175], v[176:179], v[48:51], v[160:175]
ds_read_b64_tr_b16 v[176:177], v17 offset:4096
ds_read_b64_tr_b16 v[178:179], v17 offset:5120
ds_write_b128 v19, v[72:75] offset:8192
ds_write_b128 v19, v[76:79] offset:12288
v_accvgpr_read_b32 v240, a96
v_mfma_f32_32x32x16_bf16 v[160:175], v[180:183], v[52:55], v[160:175]
ds_read_b64_tr_b16 v[180:181], v17 offset:6144
ds_read_b64_tr_b16 v[182:183], v17 offset:7168
buffer_load_dwordx4 v3, s[52:55], s69 offen offset:2048 lds
v_accvgpr_read_b32 v241, a97
v_mul_f32 v240, v240, v21
v_mul_f32 v241, v241, v21
v_cvt_pk_bf16_f32 v80, v240, v241
v_mfma_f32_32x32x16_bf16 v[160:175], v[184:187], v[56:59], v[160:175]
s_waitcnt vmcnt(16) lgkmcnt(2)
s_barrier
ds_read_b64_tr_b16 v[184:185], v17 offset:8192
ds_read_b64_tr_b16 v[186:187], v17 offset:9216
v_accvgpr_read_b32 v242, a98
v_mfma_f32_32x32x16_bf16 v[160:175], v[188:191], v[60:63], v[160:175]
ds_read_b64_tr_b16 v[188:189], v17 offset:10240
ds_read_b64_tr_b16 v[190:191], v17 offset:11264
buffer_load_dwordx4 v4, s[52:55], s69 offen offset:3072 lds
ds_read_b128 a[192:195], v20 offset:0
v_accvgpr_read_b32 v243, a99
v_mul_f32 v242, v242, v21
v_mul_f32 v243, v243, v21
v_mfma_f32_32x32x16_bf16 v[160:175], v[192:195], a[176:179], v[160:175]
v_readlane_b32 s70, v244, 17
ds_read_b64_tr_b16 v[192:193], v6 offset:4096
ds_read_b64_tr_b16 v[194:195], v6 offset:5120
ds_read_b128 a[196:199], v20 offset:4096
s_add_u32 m0, s73, 52224
v_cvt_pk_bf16_f32 v81, v242, v243
v_accvgpr_read_b32 v240, a100
v_accvgpr_read_b32 v241, a101
v_mfma_f32_32x32x16_bf16 v[160:175], v[196:199], a[180:183], v[160:175]
ds_read_b64_tr_b16 v[196:197], v6 offset:6144
ds_read_b64_tr_b16 v[198:199], v6 offset:7168
buffer_load_dwordx4 v1, s[52:55], s70 offen offset:0 lds
ds_read_b128 a[200:203], v20 offset:8192
v_mul_f32 v240, v240, v21
v_mul_f32 v241, v241, v21
v_cvt_pk_bf16_f32 v82, v240, v241
v_mfma_f32_32x32x16_bf16 v[160:175], v[200:203], a[184:187], v[160:175]
ds_read_b64_tr_b16 v[200:201], v6 offset:8192
ds_read_b64_tr_b16 v[202:203], v6 offset:9216
buffer_load_dwordx4 v2, s[52:55], s70 offen offset:1024 lds
ds_read_b128 a[204:207], v20 offset:12288
v_accvgpr_read_b32 v242, a102
v_accvgpr_read_b32 v243, a103
v_mfma_f32_32x32x16_bf16 v[160:175], v[204:207], a[188:191], v[160:175]
ds_read_b64_tr_b16 v[204:205], v6 offset:10240
ds_read_b64_tr_b16 v[206:207], v6 offset:11264
v_mul_f32 v242, v242, v21
v_mul_f32 v243, v243, v21
v_cvt_pk_bf16_f32 v83, v242, v243
v_accvgpr_read_b32 v240, a104
v_accvgpr_read_b32 v241, a105
v_mfma_f32_32x32x16_bf16 v[128:143], a[0:3], v[64:67], v[128:143]
ds_read_b64_tr_b16 a[0:1], v18 offset:8192
ds_read_b64_tr_b16 a[2:3], v18 offset:9216
buffer_load_dwordx4 v3, s[52:55], s70 offen offset:2048 lds
v_mul_f32 v240, v240, v21
v_mul_f32 v241, v241, v21
v_cvt_pk_bf16_f32 v84, v240, v241
v_accvgpr_read_b32 v242, a106
v_mfma_f32_32x32x16_bf16 v[128:143], a[4:7], v[68:71], v[128:143]
ds_read_b64_tr_b16 a[4:5], v18 offset:10240
ds_read_b64_tr_b16 a[6:7], v18 offset:11264
v_accvgpr_read_b32 v243, a107
v_mul_f32 v242, v242, v21
v_mul_f32 v243, v243, v21
v_cvt_pk_bf16_f32 v85, v242, v243
v_accvgpr_read_b32 v240, a108
v_mfma_f32_32x32x16_bf16 v[128:143], a[8:11], v[72:75], v[128:143]
ds_read_b64_tr_b16 a[8:9], v18 offset:12288
ds_read_b64_tr_b16 a[10:11], v18 offset:13312
buffer_load_dwordx4 v4, s[52:55], s70 offen offset:3072 lds
v_accvgpr_read_b32 v241, a109
v_mul_f32_e64 v240, v240, v21
v_mul_f32 v241, v241, v21
v_cvt_pk_bf16_f32 v86, v240, v241
v_mfma_f32_32x32x16_bf16 v[128:143], a[12:15], v[76:79], v[128:143]
s_waitcnt lgkmcnt(15)
ds_read_b64_tr_b16 a[12:13], v18 offset:14336
ds_read_b64_tr_b16 a[14:15], v18 offset:15360
v_accvgpr_read_b32 v242, a110
v_accvgpr_read_b32 v243, a111
v_mul_f32_e64 v242, v242, v21
v_mul_f32 v243, v243, v21
v_cvt_pk_bf16_f32 v87, v242, v243
v_mfma_f32_32x32x16_bf16 v[128:143], a[16:19], a[192:195], v[128:143]
s_waitcnt lgkmcnt(15)
ds_read_b64_tr_b16 a[16:17], v7 offset:8192
ds_read_b64_tr_b16 a[18:19], v7 offset:9216
v_accvgpr_read_b32 v240, a112
v_accvgpr_read_b32 v241, a113
v_mul_f32_e64 v240, v240, v21
v_mul_f32 v241, v241, v21
v_mfma_f32_32x32x16_bf16 v[128:143], a[20:23], a[196:199], v[128:143]
s_waitcnt lgkmcnt(15)
ds_read_b64_tr_b16 a[20:21], v7 offset:10240
ds_read_b64_tr_b16 a[22:23], v7 offset:11264
v_cvt_pk_bf16_f32 v88, v240, v241
v_accvgpr_read_b32 v242, a114
v_accvgpr_read_b32 v243, a115
v_mul_f32_e64 v242, v242, v21
v_mul_f32 v243, v243, v21
v_mfma_f32_32x32x16_bf16 v[128:143], a[24:27], a[200:203], v[128:143]
s_waitcnt lgkmcnt(14)
ds_read_b64_tr_b16 a[24:25], v7 offset:12288
ds_read_b64_tr_b16 a[26:27], v7 offset:13312
v_cvt_pk_bf16_f32 v89, v242, v243
v_accvgpr_read_b32 v240, a116
v_accvgpr_read_b32 v241, a117
v_mul_f32_e64 v240, v240, v21
v_mfma_f32_32x32x16_bf16 v[128:143], a[28:31], a[204:207], v[128:143]
ds_read_b64_tr_b16 a[28:29], v7 offset:14336
ds_read_b64_tr_b16 a[30:31], v7 offset:15360
v_mul_f32_e64 v241, v241, v21
v_cvt_pk_bf16_f32 v90, v240, v241
v_accvgpr_read_b32 v242, a118
v_accvgpr_read_b32 v243, a119
v_mfma_f32_32x32x16_bf16 v[144:159], v[112:115], v[64:67], v[144:159]
v_readlane_b32 s69, v244, 18
ds_read_b64_tr_b16 a[64:65], v17 offset:21504
ds_read_b64_tr_b16 a[66:67], v17 offset:22528
v_mul_f32 v242, v242, v21
v_mul_f32 v243, v243, v21
v_cvt_pk_bf16_f32 v91, v242, v243
v_accvgpr_read_b32 v240, a120
v_accvgpr_read_b32 v241, a121
v_mfma_f32_32x32x16_bf16 v[144:159], v[116:119], v[68:71], v[144:159]
ds_read_b64_tr_b16 a[68:69], v17 offset:23552
ds_read_b64_tr_b16 a[70:71], v17 offset:24576
v_mul_f32 v240, v240, v21
v_mul_f32 v241, v241, v21
v_cvt_pk_bf16_f32 v92, v240, v241
v_accvgpr_read_b32 v242, a122
v_mfma_f32_32x32x16_bf16 v[144:159], v[120:123], v[72:75], v[144:159]
s_waitcnt vmcnt(17)
s_barrier
ds_read_b64_tr_b16 a[72:73], v17 offset:25600
ds_read_b64_tr_b16 a[74:75], v17 offset:26624
v_mfma_f32_32x32x16_bf16 v[144:159], a[32:35], v[76:79], v[144:159]
ds_read_b64_tr_b16 a[32:33], v17 offset:27648
ds_read_b64_tr_b16 a[34:35], v17 offset:28672
v_accvgpr_read_b32 v243, a123
v_mul_f32 v242, v242, v21
v_mul_f32 v243, v243, v21
v_cvt_pk_bf16_f32 v93, v242, v243
v_accvgpr_read_b32 v240, a124
v_mfma_f32_32x32x16_bf16 v[144:159], a[36:39], a[192:195], v[144:159]
s_add_u32 m0, s73, 69632
ds_read_b64_tr_b16 a[36:37], v6 offset:21504
ds_read_b64_tr_b16 a[38:39], v6 offset:22528
buffer_load_dwordx4 v1, s[52:55], s69 offen offset:0 lds
v_accvgpr_read_b32 v241, a125
v_mul_f32_e64 v240, v240, v21
v_mfma_f32_32x32x16_bf16 v[144:159], a[40:43], a[196:199], v[144:159]
ds_read_b64_tr_b16 a[40:41], v6 offset:23552
ds_read_b64_tr_b16 a[42:43], v6 offset:24576
buffer_load_dwordx4 v2, s[52:55], s69 offen offset:1024 lds
v_mul_f32_e64 v241, v241, v21
v_cvt_pk_bf16_f32 v94, v240, v241
v_mfma_f32_32x32x16_bf16 v[144:159], a[44:47], a[200:203], v[144:159]
ds_read_b64_tr_b16 a[44:45], v6 offset:25600
ds_read_b64_tr_b16 a[46:47], v6 offset:26624
v_accvgpr_read_b32 v242, a126
v_accvgpr_read_b32 v243, a127
v_mul_f32 v242, v242, v21
v_mul_f32 v243, v243, v21
v_cvt_pk_bf16_f32 v95, v242, v243
v_mfma_f32_32x32x16_bf16 v[144:159], v[124:127], a[204:207], v[144:159]
ds_read_b64_tr_b16 a[76:77], v6 offset:27648
ds_read_b64_tr_b16 a[78:79], v6 offset:28672
ds_write_b128 v19, v[80:83] offset:0
ds_write_b128 v19, v[84:87] offset:4096
v_mfma_f32_32x32x16_bf16 v[160:175], a[48:51], v[64:67], v[160:175]
ds_read_b64_tr_b16 a[48:49], v17 offset:38912
ds_read_b64_tr_b16 a[50:51], v17 offset:39936
ds_write_b128 v19, v[88:91] offset:8192
ds_write_b128 v19, v[92:95] offset:12288
v_mfma_f32_32x32x16_bf16 v[160:175], a[52:55], v[68:71], v[160:175]
ds_read_b64_tr_b16 a[52:53], v17 offset:40960
ds_read_b64_tr_b16 a[54:55], v17 offset:41984
buffer_load_dwordx4 v3, s[52:55], s69 offen offset:2048 lds
v_mfma_f32_32x32x16_bf16 v[160:175], a[56:59], v[72:75], v[160:175]
s_waitcnt vmcnt(11) lgkmcnt(2)
s_barrier
ds_read_b64_tr_b16 a[56:57], v17 offset:43008
ds_read_b64_tr_b16 a[58:59], v17 offset:44032
v_mfma_f32_32x32x16_bf16 v[160:175], a[60:63], v[76:79], v[160:175]
ds_read_b64_tr_b16 a[60:61], v17 offset:45056
ds_read_b64_tr_b16 a[62:63], v17 offset:46080
buffer_load_dwordx4 v4, s[52:55], s69 offen offset:3072 lds
ds_read_b128 a[208:211], v20 offset:0
v_mfma_f32_32x32x16_bf16 v[160:175], v[96:99], a[192:195], v[160:175]
v_readlane_b32 s70, v244, 19
ds_read_b64_tr_b16 a[80:81], v6 offset:38912
ds_read_b64_tr_b16 a[82:83], v6 offset:39936
ds_read_b128 a[212:215], v20 offset:4096
s_add_u32 m0, s73, 139264
v_mfma_f32_32x32x16_bf16 v[160:175], v[100:103], a[196:199], v[160:175]
ds_read_b64_tr_b16 a[84:85], v6 offset:40960
ds_read_b64_tr_b16 a[86:87], v6 offset:41984
buffer_load_dwordx4 v1, s[52:55], s70 offen offset:0 lds
ds_read_b128 a[216:219], v20 offset:8192
v_mfma_f32_32x32x16_bf16 v[160:175], v[104:107], a[200:203], v[160:175]
ds_read_b64_tr_b16 a[88:89], v6 offset:43008
ds_read_b64_tr_b16 a[90:91], v6 offset:44032
buffer_load_dwordx4 v2, s[52:55], s70 offen offset:1024 lds
ds_read_b128 a[220:223], v20 offset:12288
v_mfma_f32_32x32x16_bf16 v[160:175], v[108:111], a[204:207], v[160:175]
ds_read_b64_tr_b16 a[92:93], v6 offset:45056
ds_read_b64_tr_b16 a[94:95], v6 offset:46080
s_movk_i32 s62, 896
s_lshl1_add_u32 s34, s65, s68
s_sub_u32 s20, s32, 1
v_mfma_f32_32x32x16_bf16 v[128:143], v[208:211], v[80:83], v[128:143]
ds_read_b64_tr_b16 v[208:209], v16 offset:0
ds_read_b64_tr_b16 v[210:211], v16 offset:1024
buffer_load_dwordx4 v3, s[52:55], s70 offen offset:2048 lds
s_mul_i32 s24, s20, 64512
v_mfma_f32_32x32x16_bf16 v[128:143], v[212:215], v[84:87], v[128:143]
ds_read_b64_tr_b16 v[212:213], v16 offset:2048
ds_read_b64_tr_b16 v[214:215], v16 offset:3072
s_lshl_b32 s12, s20, 7
s_lshl_b32 s21, s67, 6
s_add_u32 s12, s12, s21
v_mfma_f32_32x32x16_bf16 v[128:143], v[216:219], v[88:91], v[128:143]
v_readlane_b32 s69, v244, 20
ds_read_b64_tr_b16 v[216:217], v16 offset:4096
ds_read_b64_tr_b16 v[218:219], v16 offset:5120
buffer_load_dwordx4 v4, s[52:55], s70 offen offset:3072 lds
v_accvgpr_read_b32 v30, a227
v_mfma_f32_32x32x16_bf16 v[128:143], v[220:223], v[92:95], v[128:143]
s_waitcnt lgkmcnt(15)
ds_read_b64_tr_b16 v[220:221], v16 offset:6144
ds_read_b64_tr_b16 v[222:223], v16 offset:7168
v_lshrrev_b32 v31, 5, v0
v_lshlrev_b32 v31, 4, v31
v_mad_u32_u24 v247, v30, s62, v31
v_mfma_f32_32x32x16_bf16 v[128:143], v[224:227], a[208:211], v[128:143]
s_waitcnt lgkmcnt(15)
s_add_u32 m0, s73, 87040
ds_read_b64_tr_b16 v[224:225], v5 offset:0
ds_read_b64_tr_b16 v[226:227], v5 offset:1024
buffer_load_dwordx4 v1, s[52:55], s69 offen offset:0 lds
v_mfma_f32_32x32x16_bf16 v[128:143], v[228:231], a[212:215], v[128:143]
s_waitcnt lgkmcnt(15)
ds_read_b64_tr_b16 v[228:229], v5 offset:2048
ds_read_b64_tr_b16 v[230:231], v5 offset:3072
v_and_b32 v123, 7, v0
v_lshl_add_u32 v123, v123, 12, v31
s_add_u32 s25, s24, 9216
v_mfma_f32_32x32x16_bf16 v[128:143], v[232:235], a[216:219], v[128:143]
s_waitcnt lgkmcnt(14)
s_nop 0
ds_read_b64_tr_b16 v[232:233], v5 offset:4096
ds_read_b64_tr_b16 v[234:235], v5 offset:5120
s_add_u32 s26, s24, 18432
s_add_u32 s27, s24, 27648
s_add_u32 s30, s24, 36864
v_mfma_f32_32x32x16_bf16 v[128:143], v[236:239], a[220:223], v[128:143]
ds_read_b64_tr_b16 v[236:237], v5 offset:6144
ds_read_b64_tr_b16 v[238:239], v5 offset:7168
buffer_load_dwordx4 v2, s[52:55], s69 offen offset:1024 lds
s_add_u32 s31, s24, 46080
v_mfma_f32_32x32x16_bf16 v[144:159], v[176:179], v[80:83], v[144:159]
ds_read_b64_tr_b16 a[96:97], v16 offset:34816
ds_read_b64_tr_b16 a[98:99], v16 offset:35840
s_add_u32 s13, s24, 55296
s_mov_b32 s36, s56
s_mov_b32 s37, s57
v_mfma_f32_32x32x16_bf16 v[144:159], v[180:183], v[84:87], v[144:159]
ds_read_b64_tr_b16 a[100:101], v16 offset:36864
ds_read_b64_tr_b16 a[102:103], v16 offset:37888
v_readlane_b32 s3, v245, 0
v_cvt_pk_bf16_f32 v96, v128, v129
v_cvt_pk_bf16_f32 v97, v130, v131
v_cvt_pk_bf16_f32 v98, v132, v133
v_cvt_pk_bf16_f32 v99, v134, v135
v_mfma_f32_32x32x16_bf16 v[144:159], v[184:187], v[88:91], v[144:159]
s_waitcnt vmcnt(14)
s_barrier
ds_read_b64_tr_b16 a[104:105], v16 offset:38912
ds_read_b64_tr_b16 a[106:107], v16 offset:39936
v_mfma_f32_32x32x16_bf16 v[144:159], v[188:191], v[92:95], v[144:159]
ds_read_b64_tr_b16 a[108:109], v16 offset:40960
ds_read_b64_tr_b16 a[110:111], v16 offset:41984
buffer_load_dwordx4 v3, s[52:55], s69 offen offset:2048 lds
buffer_store_dwordx4 v[96:99], v253, s[56:59], s3 offen offset:0 sc1
v_mfma_f32_32x32x16_bf16 v[144:159], v[192:195], a[208:211], v[144:159]
ds_read_b64_tr_b16 v[192:193], v5 offset:34816
ds_read_b64_tr_b16 v[194:195], v5 offset:35840
s_mov_b32 s44, s56
s_mov_b32 s45, s57
s_mov_b32 s48, s56
s_nop 0
v_mfma_f32_32x32x16_bf16 v[144:159], v[196:199], a[212:215], v[144:159]
ds_read_b64_tr_b16 v[196:197], v5 offset:36864
ds_read_b64_tr_b16 v[198:199], v5 offset:37888
buffer_load_dwordx4 v4, s[52:55], s69 offen offset:3072 lds
v_mfma_f32_32x32x16_bf16 v[144:159], v[200:203], a[216:219], v[144:159]
v_readlane_b32 s70, v244, 21
ds_read_b64_tr_b16 v[200:201], v5 offset:38912
ds_read_b64_tr_b16 v[202:203], v5 offset:39936
v_cvt_pk_bf16_f32 v100, v136, v137
v_cvt_pk_bf16_f32 v101, v138, v139
v_cvt_pk_bf16_f32 v102, v140, v141
v_cvt_pk_bf16_f32 v103, v142, v143
v_mfma_f32_32x32x16_bf16 v[144:159], v[204:207], a[220:223], v[144:159]
ds_read_b64_tr_b16 v[204:205], v5 offset:40960
ds_read_b64_tr_b16 v[206:207], v5 offset:41984
buffer_store_dwordx4 v[100:103], v253, s[56:59], s3 offen offset:1024 sc1
v_mfma_f32_32x32x16_bf16 v[160:175], a[0:3], v[80:83], v[160:175]
s_add_u32 m0, s73, 104448
ds_read_b64_tr_b16 a[0:1], v16 offset:17408
ds_read_b64_tr_b16 a[2:3], v16 offset:18432
buffer_load_dwordx4 v1, s[52:55], s70 offen offset:0 lds
s_mov_b32 s49, s57
s_nop 0
v_mfma_f32_32x32x16_bf16 v[160:175], a[4:7], v[84:87], v[160:175]
ds_read_b64_tr_b16 a[4:5], v16 offset:19456
ds_read_b64_tr_b16 a[6:7], v16 offset:20480
s_lshr_b32 s20, s22, 5
s_lshr_b32 s21, s23, 5
v_mfma_f32_32x32x16_bf16 v[160:175], a[8:11], v[88:91], v[160:175]
s_cmp_eq_u32 s33, 0
s_cselect_b32 s38, s58, 0
s_waitcnt vmcnt(15)
s_barrier
ds_read_b64_tr_b16 a[8:9], v16 offset:21504
ds_read_b64_tr_b16 a[10:11], v16 offset:22528
v_mfma_f32_32x32x16_bf16 v[160:175], a[12:15], v[92:95], v[160:175]
ds_read_b64_tr_b16 a[12:13], v16 offset:23552
ds_read_b64_tr_b16 a[14:15], v16 offset:24576
buffer_load_dwordx4 v2, s[52:55], s70 offen offset:1024 lds
v_add3_u32 v120, v96, v97, v98
v_mfma_f32_32x32x16_bf16 v[160:175], a[16:19], a[208:211], v[160:175]
ds_read_b64_tr_b16 a[16:17], v5 offset:17408
ds_read_b64_tr_b16 a[18:19], v5 offset:18432
v_add3_u32 v120, v120, v99, v100
v_add3_u32 v120, v120, v101, v102
v_add_u32 v120, v120, v103
v_sub_u32 v120, s63, v120
v_mfma_f32_32x32x16_bf16 v[160:175], a[20:23], a[212:215], v[160:175]
ds_read_b64_tr_b16 a[20:21], v5 offset:19456
ds_read_b64_tr_b16 a[22:23], v5 offset:20480
buffer_store_dword v120, v246, s[56:59], s3 offen offset:2048 sc1
v_mfma_f32_32x32x16_bf16 v[160:175], a[24:27], a[216:219], v[160:175]
ds_read_b64_tr_b16 a[24:25], v5 offset:21504
ds_read_b64_tr_b16 a[26:27], v5 offset:22528
buffer_load_dwordx4 v3, s[52:55], s70 offen offset:2048 lds
v_mfma_f32_32x32x16_bf16 v[160:175], a[28:31], a[220:223], v[160:175]
ds_read_b64_tr_b16 a[28:29], v5 offset:23552
ds_read_b64_tr_b16 a[30:31], v5 offset:24576
v_readlane_b32 s3, v245, 4
v_cvt_pk_bf16_f32 v104, v144, v145
v_cvt_pk_bf16_f32 v105, v146, v147
v_cvt_pk_bf16_f32 v106, v148, v149
v_mfma_f32_32x32x16_bf16 v[176:191], a[64:67], v[32:35], 0
s_cmp_eq_u32 s20, s34
s_cselect_b32 s46, s38, 0
ds_read_b64_tr_b16 a[64:65], v16 offset:52224
ds_read_b64_tr_b16 a[66:67], v16 offset:53248
v_cvt_pk_bf16_f32 v107, v150, v151
v_mfma_f32_32x32x16_bf16 v[176:191], a[68:71], v[36:39], v[176:191]
ds_read_b64_tr_b16 a[68:69], v16 offset:54272
ds_read_b64_tr_b16 a[70:71], v16 offset:55296
buffer_load_dwordx4 v4, s[52:55], s70 offen offset:3072 lds
buffer_store_dwordx4 v[104:107], v253, s[56:59], s3 offen offset:0 sc1
v_mfma_f32_32x32x16_bf16 v[176:191], a[72:75], v[40:43], v[176:191]
s_cmp_eq_u32 s21, s34
s_cselect_b32 s50, s38, 0
s_or_b32 s20, s46, s50
s_cselect_b64 s[60:61], -1, 0
v_readlane_b32 s69, v244, 22
ds_read_b64_tr_b16 a[72:73], v16 offset:56320
ds_read_b64_tr_b16 a[74:75], v16 offset:57344
v_mfma_f32_32x32x16_bf16 v[176:191], a[32:35], v[44:47], v[176:191]
ds_read_b64_tr_b16 a[32:33], v16 offset:58368
ds_read_b64_tr_b16 a[34:35], v16 offset:59392
v_lshrrev_b32 v254, 1, v0
v_lshlrev_b32 v254, 10, v254
v_mfma_f32_32x32x16_bf16 v[176:191], a[36:39], a[160:163], v[176:191]
s_add_u32 m0, s73, 121856
ds_read_b64_tr_b16 a[36:37], v5 offset:52224
ds_read_b64_tr_b16 a[38:39], v5 offset:53248
buffer_load_dwordx4 v1, s[52:55], s69 offen offset:0 lds
v_cvt_pk_bf16_f32 v108, v152, v153
v_cvt_pk_bf16_f32 v109, v154, v155
v_mfma_f32_32x32x16_bf16 v[176:191], a[40:43], a[164:167], v[176:191]
ds_read_b64_tr_b16 a[40:41], v5 offset:54272
ds_read_b64_tr_b16 a[42:43], v5 offset:55296
v_cvt_pk_bf16_f32 v110, v156, v157
v_cvt_pk_bf16_f32 v111, v158, v159
v_and_b32_e64 v31, 1, v0
v_mfma_f32_32x32x16_bf16 v[176:191], a[44:47], a[168:171], v[176:191]
ds_read_b64_tr_b16 a[44:45], v5 offset:56320
ds_read_b64_tr_b16 a[46:47], v5 offset:57344
buffer_store_dwordx4 v[108:111], v253, s[56:59], s3 offen offset:1024 sc1
v_mfma_f32_32x32x16_bf16 v[176:191], a[76:79], a[172:175], v[176:191]
ds_read_b64_tr_b16 a[76:77], v5 offset:58368
ds_read_b64_tr_b16 a[78:79], v5 offset:59392
buffer_load_dwordx4 v2, s[52:55], s69 offen offset:1024 lds
v_lshl_add_u32 v254, v31, 4, v254
v_mfma_f32_32x32x16_bf16 v[176:191], a[48:51], v[48:51], v[176:191]
v_mov_b32 v31, 2130706432
v_cndmask_b32 v254, v31, v254, s[60:61]
s_add_u32 s75, s12, 16908288
s_mov_b32 s40, s28
s_mov_b32 s41, s29
v_mfma_f32_32x32x16_bf16 v[176:191], a[52:55], v[52:55], v[176:191]
v_add3_u32 v121, v104, v105, v106
v_add3_u32 v121, v121, v107, v108
v_add3_u32 v121, v121, v109, v110
v_add_u32 v121, v121, v111
v_sub_u32 v121, s63, v121
v_mfma_f32_32x32x16_bf16 v[176:191], a[56:59], v[56:59], v[176:191]
s_waitcnt vmcnt(19)
s_barrier
ds_read_b64_tr_b16 a[48:49], v17 offset:4096
ds_read_b64_tr_b16 a[50:51], v17 offset:5120
v_mfma_f32_32x32x16_bf16 v[176:191], a[60:63], v[60:63], v[176:191]
ds_read_b64_tr_b16 a[52:53], v17 offset:6144
ds_read_b64_tr_b16 a[54:55], v17 offset:7168
buffer_load_dwordx4 v3, s[52:55], s69 offen offset:2048 lds
buffer_store_dword v121, v246, s[56:59], s3 offen offset:2048 sc1
v_mfma_f32_32x32x16_bf16 v[176:191], a[80:83], a[176:179], v[176:191]
ds_read_b64_tr_b16 a[56:57], v17 offset:8192
ds_read_b64_tr_b16 a[58:59], v17 offset:9216
s_mov_b32 s42, 1835008
s_mov_b32 s78, 0xbfb8aa3b
s_mov_b32 s79, 1.0
v_mfma_f32_32x32x16_bf16 v[176:191], a[84:87], a[180:183], v[176:191]
s_waitcnt lgkmcnt(15)
ds_read_b64_tr_b16 a[60:61], v17 offset:10240
ds_read_b64_tr_b16 a[62:63], v17 offset:11264
buffer_load_dwordx4 v4, s[52:55], s69 offen offset:3072 lds
v_readlane_b32 s3, v245, 8
v_cvt_pk_bf16_f32 v112, v160, v161
v_mfma_f32_32x32x16_bf16 v[176:191], a[88:91], a[184:187], v[176:191]
v_readlane_b32 s70, v244, 23
ds_read_b64_tr_b16 a[80:81], v6 offset:4096
ds_read_b64_tr_b16 a[82:83], v6 offset:5120
v_cvt_pk_bf16_f32 v113, v162, v163
v_cvt_pk_bf16_f32 v114, v164, v165
v_cvt_pk_bf16_f32 v115, v166, v167
v_mfma_f32_32x32x16_bf16 v[176:191], a[92:95], a[188:191], v[176:191]
ds_read_b64_tr_b16 a[84:85], v6 offset:6144
ds_read_b64_tr_b16 a[86:87], v6 offset:7168
buffer_store_dwordx4 v[112:115], v253, s[56:59], s3 offen offset:0 sc1
v_mfma_f32_32x32x16_bf16 v[176:191], v[208:211], v[64:67], v[176:191]
s_add_u32 m0, s73, 0
s_nop 0
ds_read_b64_tr_b16 v[208:209], v6 offset:8192
ds_read_b64_tr_b16 v[210:211], v6 offset:9216
buffer_load_dwordx4 v1, s[52:55], s70 offen offset:0 lds
v_mfma_f32_32x32x16_bf16 v[176:191], v[212:215], v[68:71], v[176:191]
ds_read_b64_tr_b16 v[212:213], v6 offset:10240
ds_read_b64_tr_b16 v[214:215], v6 offset:11264
v_accvgpr_read_b32 v125, a225
v_mfma_f32_32x32x16_bf16 v[176:191], v[216:219], v[72:75], v[176:191]
v_cvt_pk_bf16_f32 v116, v168, v169
v_cvt_pk_bf16_f32 v117, v170, v171
v_cvt_pk_bf16_f32 v118, v172, v173
v_cvt_pk_bf16_f32 v119, v174, v175
v_mfma_f32_32x32x16_bf16 v[176:191], v[220:223], v[76:79], v[176:191]
buffer_load_dwordx4 v2, s[52:55], s70 offen offset:1024 lds
v_accvgpr_read_b32 v124, a224
v_mfma_f32_32x32x16_bf16 v[176:191], v[224:227], a[192:195], v[176:191]
buffer_store_dwordx4 v[116:119], v253, s[56:59], s3 offen offset:1024 sc1
v_mfma_f32_32x32x16_bf16 v[176:191], v[228:231], a[196:199], v[176:191]
v_rcp_f32_e64 v125, v125
v_accvgpr_read_b32 v9, a240
v_lshlrev_b32_e64 v8, 16, v9
v_mfma_f32_32x32x16_bf16 v[176:191], v[232:235], a[200:203], v[176:191]
buffer_load_dwordx4 v3, s[52:55], s70 offen offset:2048 lds
v_and_b32_e64 v9, s74, v9
v_mfma_f32_32x32x16_bf16 v[176:191], v[236:239], a[204:207], v[176:191]
v_add3_u32 v122, v112, v113, v114
v_add3_u32 v122, v122, v115, v116
v_add3_u32 v122, v122, v117, v118
v_mfma_f32_32x32x16_bf16 v[176:191], a[96:99], v[80:83], v[176:191]
v_readlane_b32 s69, v244, 24
v_add_u32 v122, v122, v119
v_sub_u32 v122, s63, v122
v_sub_f32 v8, v8, v124
v_sub_f32 v9, v9, v124
v_mfma_f32_32x32x16_bf16 v[176:191], a[100:103], v[84:87], v[176:191]
buffer_load_dwordx4 v4, s[52:55], s70 offen offset:3072 lds
buffer_store_dword v122, v246, s[56:59], s3 offen offset:2048 sc1
v_mfma_f32_32x32x16_bf16 v[176:191], a[104:107], v[88:91], v[176:191]
s_barrier
s_nop 0
v_mfma_f32_32x32x16_bf16 v[176:191], a[108:111], v[92:95], v[176:191]
buffer_load_dwordx4 v[248:251], v254, s[56:59], s17 offen sc1
v_cvt_pk_bf16_f32 v9, v8, v9
v_mfma_f32_32x32x16_bf16 v[176:191], v[192:195], a[208:211], v[176:191]
s_add_u32 m0, s73, 34816
s_nop 0
buffer_load_dwordx4 v1, s[52:55], s69 offen offset:0 lds
v_lshlrev_b32 v8, 16, v9
v_mfma_f32_32x32x16_bf16 v[176:191], v[196:199], a[212:215], v[176:191]
v_and_b32 v9, s74, v9
v_mul_f32 v8, v8, v125
v_mul_f32_e64 v9, v9, v125
v_cvt_pk_bf16_f32 v9, v8, v9
v_mfma_f32_32x32x16_bf16 v[176:191], v[200:203], a[216:219], v[176:191]
v_lshlrev_b32 v8, 16, v9
v_and_b32 v9, s74, v9
v_accvgpr_read_b32 v11, a241
v_mfma_f32_32x32x16_bf16 v[176:191], v[204:207], a[220:223], v[176:191]
buffer_load_dwordx4 v2, s[52:55], s69 offen offset:1024 lds
v_lshlrev_b32_e64 v10, 16, v11
v_mfma_f32_32x32x16_bf16 v[128:143], a[0:3], v[32:35], 0
v_and_b32 v11, s74, v11
v_sub_f32 v10, v10, v124
v_sub_f32_e64 v11, v11, v124
v_mfma_f32_32x32x16_bf16 v[128:143], a[4:7], v[36:39], v[128:143]
v_readlane_b32 s3, v245, 12
v_cvt_pk_bf16_f32 v96, v176, v177
v_cvt_pk_bf16_f32 v97, v178, v179
v_cvt_pk_bf16_f32 v98, v180, v181
v_mfma_f32_32x32x16_bf16 v[128:143], a[8:11], v[40:43], v[128:143]
buffer_load_dwordx4 v3, s[52:55], s69 offen offset:2048 lds
v_cvt_pk_bf16_f32 v99, v182, v183
v_cvt_pk_bf16_f32 v11, v10, v11
v_mfma_f32_32x32x16_bf16 v[128:143], a[12:15], v[44:47], v[128:143]
buffer_store_dwordx4 v[96:99], v253, s[56:59], s3 offen offset:0 sc1
v_mfma_f32_32x32x16_bf16 v[128:143], a[16:19], a[160:163], v[128:143]
v_lshlrev_b32 v10, 16, v11
v_and_b32 v11, s74, v11
v_mul_f32_e64 v10, v10, v125
v_mfma_f32_32x32x16_bf16 v[128:143], a[20:23], a[164:167], v[128:143]
buffer_load_dwordx4 v4, s[52:55], s69 offen offset:3072 lds
v_mul_f32_e64 v11, v11, v125
v_mfma_f32_32x32x16_bf16 v[128:143], a[24:27], a[168:171], v[128:143]
v_readlane_b32 s70, v244, 25
v_cvt_pk_bf16_f32 v100, v184, v185
v_cvt_pk_bf16_f32 v101, v186, v187
v_cvt_pk_bf16_f32 v102, v188, v189
v_cvt_pk_bf16_f32 v103, v190, v191
v_mfma_f32_32x32x16_bf16 v[128:143], a[28:31], a[172:175], v[128:143]
buffer_store_dwordx4 v[100:103], v253, s[56:59], s3 offen offset:1024 sc1
v_mfma_f32_32x32x16_bf16 v[128:143], a[64:67], v[48:51], v[128:143]
s_add_u32 m0, s73, 17408
s_nop 0
buffer_load_dwordx4 v1, s[52:55], s70 offen offset:0 lds
v_cvt_pk_bf16_f32 v11, v10, v11
v_mfma_f32_32x32x16_bf16 v[128:143], a[68:71], v[52:55], v[128:143]
v_lshlrev_b32 v10, 16, v11
v_and_b32_e64 v11, s74, v11
v_accvgpr_read_b32 v13, a242
v_lshlrev_b32_e64 v12, 16, v13
v_mfma_f32_32x32x16_bf16 v[128:143], a[72:75], v[56:59], v[128:143]
s_waitcnt vmcnt(33) lgkmcnt(15)
s_barrier
v_mfma_f32_32x32x16_bf16 v[128:143], a[32:35], v[60:63], v[128:143]
buffer_load_dwordx4 v2, s[52:55], s70 offen offset:1024 lds
v_add3_u32 v120, v96, v97, v98
v_mfma_f32_32x32x16_bf16 v[128:143], a[36:39], a[176:179], v[128:143]
v_add3_u32 v120, v120, v99, v100
v_add3_u32 v120, v120, v101, v102
v_add_u32 v120, v120, v103
v_sub_u32 v120, s63, v120
v_mfma_f32_32x32x16_bf16 v[128:143], a[40:43], a[180:183], v[128:143]
buffer_store_dword v120, v246, s[56:59], s3 offen offset:2048 sc1
v_mfma_f32_32x32x16_bf16 v[128:143], a[44:47], a[184:187], v[128:143]
buffer_load_dwordx4 v3, s[52:55], s70 offen offset:2048 lds
v_and_b32 v13, s74, v13
v_sub_f32 v12, v12, v124
v_mfma_f32_32x32x16_bf16 v[128:143], a[76:79], a[188:191], v[128:143]
s_waitcnt lgkmcnt(12)
v_sub_f32 v13, v13, v124
v_cvt_pk_bf16_f32 v13, v12, v13
v_lshlrev_b32_e64 v12, 16, v13
v_mfma_f32_32x32x16_bf16 v[128:143], a[48:51], v[64:67], v[128:143]
v_and_b32 v13, s74, v13
v_mul_f32 v12, v12, v125
v_mul_f32 v13, v13, v125
v_mfma_f32_32x32x16_bf16 v[128:143], a[52:55], v[68:71], v[128:143]
s_waitcnt lgkmcnt(8)
buffer_load_dwordx4 v4, s[52:55], s70 offen offset:3072 lds
v_cvt_pk_bf16_f32 v13, v12, v13
v_mfma_f32_32x32x16_bf16 v[128:143], a[56:59], v[72:75], v[128:143]
v_readlane_b32 s69, v244, 26
ds_read_b64_tr_b16 a[128:129], v18 offset:8192
ds_read_b64_tr_b16 a[130:131], v18 offset:9216
v_lshlrev_b32_e64 v12, 16, v13
v_and_b32 v13, s74, v13
v_mfma_f32_32x32x16_bf16 v[128:143], a[60:63], v[76:79], v[128:143]
s_waitcnt lgkmcnt(6)
ds_read_b64_tr_b16 a[132:133], v18 offset:10240
ds_read_b64_tr_b16 a[134:135], v18 offset:11264
v_accvgpr_read_b32 v15, a243
v_mfma_f32_32x32x16_bf16 v[128:143], a[80:83], a[192:195], v[128:143]
s_add_u32 m0, s73, 52224
ds_read_b64_tr_b16 a[136:137], v18 offset:12288
ds_read_b64_tr_b16 a[138:139], v18 offset:13312
buffer_load_dwordx4 v1, s[52:55], s69 offen offset:0 lds
v_mfma_f32_32x32x16_bf16 v[128:143], a[84:87], a[196:199], v[128:143]
s_waitcnt lgkmcnt(6)
ds_read_b64_tr_b16 a[140:141], v18 offset:14336
ds_read_b64_tr_b16 a[142:143], v18 offset:15360
v_lshlrev_b32 v14, 16, v15
v_mfma_f32_32x32x16_bf16 v[128:143], v[208:211], a[200:203], v[128:143]
ds_read_b64_tr_b16 a[144:145], v7 offset:8192
ds_read_b64_tr_b16 a[146:147], v7 offset:9216
v_and_b32_e64 v15, s74, v15
v_sub_f32 v14, v14, v124
v_mfma_f32_32x32x16_bf16 v[128:143], v[212:215], a[204:207], v[128:143]
s_waitcnt lgkmcnt(6)
ds_read_b64_tr_b16 a[148:149], v7 offset:10240
ds_read_b64_tr_b16 a[150:151], v7 offset:11264
buffer_load_dwordx4 v2, s[52:55], s69 offen offset:1024 lds
v_mfma_f32_32x32x16_bf16 v[128:143], a[128:131], v[80:83], v[128:143]
ds_read_b64_tr_b16 a[152:153], v7 offset:12288
ds_read_b64_tr_b16 a[154:155], v7 offset:13312
v_sub_f32 v15, v15, v124
v_mfma_f32_32x32x16_bf16 v[128:143], a[132:135], v[84:87], v[128:143]
s_waitcnt vmcnt(13) lgkmcnt(8)
ds_read_b64_tr_b16 a[156:157], v7 offset:14336
ds_read_b64_tr_b16 a[158:159], v7 offset:15360
v_cvt_pk_bf16_f32 v15, v14, v15
v_min3_u32 v248, v248, v249, v250
v_min_u32_e64 v248, v248, v251
v_cmp_eq_u32 s[18:19], 0, v248
v_mfma_f32_32x32x16_bf16 v[128:143], a[136:139], v[88:91], v[128:143]
s_and_b64 s[18:19], s[18:19], s[60:61]
s_cbranch_scc1 recurrent_scan__sliding_block_cached__moe_arch_mod__prompt_kernel_fp
recurrent_scan__sliding_block_cached__moe_arch_mod__prompt_kernel_fpback:
s_waitcnt lgkmcnt(8)
s_barrier
ds_read_b64_tr_b16 a[128:129], v17 offset:21504
ds_read_b64_tr_b16 a[130:131], v17 offset:22528
v_mfma_f32_32x32x16_bf16 v[128:143], a[140:143], v[92:95], v[128:143]
s_waitcnt lgkmcnt(6)
s_nop 0
ds_read_b64_tr_b16 a[132:133], v17 offset:23552
ds_read_b64_tr_b16 a[134:135], v17 offset:24576
buffer_load_dwordx4 v3, s[52:55], s69 offen offset:2048 lds
v_mfma_f32_32x32x16_bf16 v[128:143], a[144:147], a[208:211], v[128:143]
ds_read_b64_tr_b16 a[136:137], v17 offset:25600
ds_read_b64_tr_b16 a[138:139], v17 offset:26624
v_lshlrev_b32 v14, 16, v15
v_mfma_f32_32x32x16_bf16 v[128:143], a[148:151], a[212:215], v[128:143]
s_waitcnt lgkmcnt(6)
ds_read_b64_tr_b16 a[140:141], v17 offset:27648
ds_read_b64_tr_b16 a[142:143], v17 offset:28672
buffer_load_dwordx4 v4, s[52:55], s69 offen offset:3072 lds
v_mfma_f32_32x32x16_bf16 v[128:143], a[152:155], a[216:219], v[128:143]
v_readlane_b32 s70, v244, 27
ds_read_b64_tr_b16 a[144:145], v6 offset:21504
ds_read_b64_tr_b16 a[146:147], v6 offset:22528
v_and_b32_e64 v15, s74, v15
v_mul_f32 v14, v14, v125
v_mfma_f32_32x32x16_bf16 v[128:143], a[156:159], a[220:223], v[128:143]
s_waitcnt lgkmcnt(6)
ds_read_b64_tr_b16 a[148:149], v6 offset:23552
ds_read_b64_tr_b16 a[150:151], v6 offset:24576
v_mul_f32_e64 v15, v15, v125
v_mfma_f32_32x32x16_bf16 v[144:159], a[128:131], v[32:35], 0
s_add_u32 m0, s73, 69632
ds_read_b64_tr_b16 a[152:153], v6 offset:25600
ds_read_b64_tr_b16 a[154:155], v6 offset:26624
buffer_load_dwordx4 v1, s[52:55], s70 offen offset:0 lds
v_mfma_f32_32x32x16_bf16 v[144:159], a[132:135], v[36:39], v[144:159]
s_waitcnt lgkmcnt(6)
s_nop 0
ds_read_b64_tr_b16 a[156:157], v6 offset:27648
ds_read_b64_tr_b16 a[158:159], v6 offset:28672
v_readlane_b32 s3, v245, 16
v_cvt_pk_bf16_f32 v104, v128, v129
v_cvt_pk_bf16_f32 v105, v130, v131
v_cvt_pk_bf16_f32 v106, v132, v133
v_mfma_f32_32x32x16_bf16 v[144:159], a[136:139], v[40:43], v[144:159]
ds_read_b64_tr_b16 a[128:129], v17 offset:38912
ds_read_b64_tr_b16 a[130:131], v17 offset:39936
v_cvt_pk_bf16_f32 v107, v134, v135
v_mfma_f32_32x32x16_bf16 v[144:159], a[140:143], v[44:47], v[144:159]
s_waitcnt lgkmcnt(6)
s_nop 0
ds_read_b64_tr_b16 a[132:133], v17 offset:40960
ds_read_b64_tr_b16 a[134:135], v17 offset:41984
buffer_load_dwordx4 v2, s[52:55], s70 offen offset:1024 lds
buffer_store_dwordx4 v[104:107], v253, s[56:59], s3 offen offset:0 sc1
v_mfma_f32_32x32x16_bf16 v[144:159], a[144:147], a[160:163], v[144:159]
ds_read_b64_tr_b16 a[136:137], v17 offset:43008
ds_read_b64_tr_b16 a[138:139], v17 offset:44032
v_cvt_pk_bf16_f32 v15, v14, v15
v_mfma_f32_32x32x16_bf16 v[144:159], a[148:151], a[164:167], v[144:159]
s_waitcnt lgkmcnt(6)
ds_read_b64_tr_b16 a[140:141], v17 offset:45056
ds_read_b64_tr_b16 a[142:143], v17 offset:46080
v_lshlrev_b32 v14, 16, v15
v_and_b32_e64 v15, s74, v15
v_mfma_f32_32x32x16_bf16 v[144:159], a[152:155], a[168:171], v[144:159]
ds_read_b64_tr_b16 a[144:145], v6 offset:38912
ds_read_b64_tr_b16 a[146:147], v6 offset:39936
buffer_load_dwordx4 v3, s[52:55], s70 offen offset:2048 lds
v_cvt_pk_bf16_f32 v108, v136, v137
v_cvt_pk_bf16_f32 v109, v138, v139
v_mfma_f32_32x32x16_bf16 v[144:159], a[156:159], a[172:175], v[144:159]
s_waitcnt lgkmcnt(6)
s_nop 0
ds_read_b64_tr_b16 a[148:149], v6 offset:40960
ds_read_b64_tr_b16 a[150:151], v6 offset:41984
v_cvt_pk_bf16_f32 v110, v140, v141
v_cvt_pk_bf16_f32 v111, v142, v143
v_mfma_f32_32x32x16_bf16 v[144:159], a[128:131], v[48:51], v[144:159]
ds_read_b64_tr_b16 a[152:153], v6 offset:43008
ds_read_b64_tr_b16 a[154:155], v6 offset:44032
buffer_store_dwordx4 v[108:111], v253, s[56:59], s3 offen offset:1024 sc1
v_mfma_f32_32x32x16_bf16 v[144:159], a[132:135], v[52:55], v[144:159]
s_waitcnt lgkmcnt(8)
ds_read_b64_tr_b16 a[156:157], v6 offset:45056
ds_read_b64_tr_b16 a[158:159], v6 offset:46080
buffer_load_dwordx4 v4, s[52:55], s70 offen offset:3072 lds
buffer_load_dwordx4 v[128:131], v123, s[44:47], s75 offen offset:0 sc1
v_mfma_f32_32x32x16_bf16 v[144:159], a[136:139], v[56:59], v[144:159]
s_waitcnt lgkmcnt(8)
s_barrier
ds_read_b64_tr_b16 a[128:129], v17 offset:56320
ds_read_b64_tr_b16 a[130:131], v17 offset:57344
v_mfma_f32_32x32x16_bf16 v[144:159], a[140:143], v[60:63], v[144:159]
s_waitcnt lgkmcnt(6)
ds_read_b64_tr_b16 a[132:133], v17 offset:58368
ds_read_b64_tr_b16 a[134:135], v17 offset:59392
v_add3_u32 v121, v104, v105, v106
v_add3_u32 v121, v121, v107, v108
v_add3_u32 v121, v121, v109, v110
v_mfma_f32_32x32x16_bf16 v[144:159], a[144:147], a[176:179], v[144:159]
ds_read_b64_tr_b16 a[136:137], v17 offset:60416
ds_read_b64_tr_b16 a[138:139], v17 offset:61440
buffer_load_dwordx4 v[136:139], v123, s[44:47], s75 offen offset:1024 sc1
v_add_u32_e64 v121, v121, v111
v_sub_u32 v121, s63, v121
v_mfma_f32_32x32x16_bf16 v[144:159], a[148:151], a[180:183], v[144:159]
s_waitcnt lgkmcnt(6)
ds_read_b64_tr_b16 a[140:141], v17 offset:62464
ds_read_b64_tr_b16 a[142:143], v17 offset:63488
buffer_store_dword v121, v246, s[56:59], s3 offen offset:2048 sc1
buffer_load_dwordx4 v[132:135], v123, s[44:47], s75 offen offset:32 sc1
v_mfma_f32_32x32x16_bf16 v[144:159], a[152:155], a[184:187], v[144:159]
ds_read_b64_tr_b16 a[144:145], v6 offset:56320
ds_read_b64_tr_b16 a[146:147], v6 offset:57344
buffer_load_dwordx4 v[140:143], v123, s[44:47], s75 offen offset:1056 sc1
v_accvgpr_read_b32 v23, a244
v_mfma_f32_32x32x16_bf16 v[144:159], a[156:159], a[188:191], v[144:159]
s_waitcnt lgkmcnt(6)
ds_read_b64_tr_b16 a[148:149], v6 offset:58368
ds_read_b64_tr_b16 a[150:151], v6 offset:59392
buffer_load_dwordx4 v[96:99], v123, s[48:51], s75 offen offset:2048 sc1
v_lshlrev_b32 v22, 16, v23
v_mfma_f32_32x32x16_bf16 v[144:159], a[128:131], v[64:67], v[144:159]
ds_read_b64_tr_b16 a[152:153], v6 offset:60416
ds_read_b64_tr_b16 a[154:155], v6 offset:61440
v_and_b32_e64 v23, s74, v23
v_sub_f32 v22, v22, v124
v_mfma_f32_32x32x16_bf16 v[144:159], a[132:135], v[68:71], v[144:159]
s_waitcnt lgkmcnt(6)
ds_read_b64_tr_b16 a[156:157], v6 offset:62464
ds_read_b64_tr_b16 a[158:159], v6 offset:63488
buffer_load_dwordx4 v[104:107], v123, s[48:51], s75 offen offset:3072 sc1
v_sub_f32_e64 v23, v23, v124
v_mfma_f32_32x32x16_bf16 v[144:159], a[136:139], v[72:75], v[144:159]
ds_read_b64_tr_b16 a[128:129], v16 offset:0
ds_read_b64_tr_b16 a[130:131], v16 offset:1024
buffer_load_dwordx4 v[100:103], v123, s[48:51], s75 offen offset:2080 sc1
v_cvt_pk_bf16_f32 v23, v22, v23
v_mfma_f32_32x32x16_bf16 v[144:159], a[140:143], v[76:79], v[144:159]
s_waitcnt lgkmcnt(6)
ds_read_b64_tr_b16 a[132:133], v16 offset:2048
ds_read_b64_tr_b16 a[134:135], v16 offset:3072
buffer_load_dwordx4 v[108:111], v123, s[48:51], s75 offen offset:3104 sc1
v_lshlrev_b32 v22, 16, v23
v_mfma_f32_32x32x16_bf16 v[144:159], a[144:147], a[192:195], v[144:159]
ds_read_b64_tr_b16 a[136:137], v16 offset:4096
ds_read_b64_tr_b16 a[138:139], v16 offset:5120
buffer_load_dwordx4 v[176:179], v253, s[36:39], s24 offen offset:0
v_and_b32_e64 v23, s74, v23
v_mul_f32 v22, v22, v125
v_mfma_f32_32x32x16_bf16 v[144:159], a[148:151], a[196:199], v[144:159]
s_waitcnt lgkmcnt(6)
ds_read_b64_tr_b16 a[140:141], v16 offset:6144
ds_read_b64_tr_b16 a[142:143], v16 offset:7168
buffer_load_dwordx4 v[180:183], v253, s[36:39], s24 offen offset:1024
v_mul_f32_e64 v23, v23, v125
v_mfma_f32_32x32x16_bf16 v[144:159], a[152:155], a[200:203], v[144:159]
ds_read_b64_tr_b16 a[144:145], v5 offset:0
ds_read_b64_tr_b16 a[146:147], v5 offset:1024
buffer_load_dword v232, v246, s[36:39], s24 offen offset:2048
v_cvt_pk_bf16_f32 v23, v22, v23
v_mfma_f32_32x32x16_bf16 v[144:159], a[156:159], a[204:207], v[144:159]
s_waitcnt lgkmcnt(6)
ds_read_b64_tr_b16 a[148:149], v5 offset:2048
ds_read_b64_tr_b16 a[150:151], v5 offset:3072
v_lshlrev_b32 v22, 16, v23
v_and_b32_e64 v23, s74, v23
v_mfma_f32_32x32x16_bf16 v[144:159], a[128:131], v[80:83], v[144:159]
ds_read_b64_tr_b16 a[152:153], v5 offset:4096
ds_read_b64_tr_b16 a[154:155], v5 offset:5120
buffer_load_dwordx4 v[184:187], v253, s[36:39], s25 offen offset:0
v_accvgpr_read_b32 v25, a245
v_mfma_f32_32x32x16_bf16 v[144:159], a[132:135], v[84:87], v[144:159]
s_waitcnt lgkmcnt(8)
ds_read_b64_tr_b16 a[156:157], v5 offset:6144
ds_read_b64_tr_b16 a[158:159], v5 offset:7168
buffer_load_dwordx4 v[188:191], v253, s[36:39], s25 offen offset:1024
v_lshlrev_b32 v24, 16, v25
v_mfma_f32_32x32x16_bf16 v[144:159], a[136:139], v[88:91], v[144:159]
s_waitcnt vmcnt(24) lgkmcnt(8)
s_barrier
ds_read_b64_tr_b16 a[128:129], v16 offset:34816
ds_read_b64_tr_b16 a[130:131], v16 offset:35840
v_mfma_f32_32x32x16_bf16 v[144:159], a[140:143], v[92:95], v[144:159]
s_waitcnt lgkmcnt(6)
ds_read_b64_tr_b16 a[132:133], v16 offset:36864
ds_read_b64_tr_b16 a[134:135], v16 offset:37888
buffer_load_dword v233, v246, s[36:39], s25 offen offset:2048
v_and_b32 v25, s74, v25
v_mfma_f32_32x32x16_bf16 v[144:159], a[144:147], a[208:211], v[144:159]
ds_read_b64_tr_b16 a[136:137], v16 offset:38912
ds_read_b64_tr_b16 a[138:139], v16 offset:39936
v_sub_f32_e64 v24, v24, v124
v_sub_f32 v25, v25, v124
v_mfma_f32_32x32x16_bf16 v[144:159], a[148:151], a[212:215], v[144:159]
s_waitcnt lgkmcnt(6)
ds_read_b64_tr_b16 a[140:141], v16 offset:40960
ds_read_b64_tr_b16 a[142:143], v16 offset:41984
buffer_load_dwordx4 v[192:195], v253, s[36:39], s26 offen offset:0
v_cvt_pk_bf16_f32 v25, v24, v25
v_mfma_f32_32x32x16_bf16 v[144:159], a[152:155], a[216:219], v[144:159]
ds_read_b64_tr_b16 a[144:145], v5 offset:34816
ds_read_b64_tr_b16 a[146:147], v5 offset:35840
buffer_load_dwordx4 v[196:199], v253, s[36:39], s26 offen offset:1024
v_lshlrev_b32 v24, 16, v25
v_mfma_f32_32x32x16_bf16 v[144:159], a[156:159], a[220:223], v[144:159]
s_waitcnt lgkmcnt(6)
ds_read_b64_tr_b16 a[148:149], v5 offset:36864
ds_read_b64_tr_b16 a[150:151], v5 offset:37888
buffer_load_dword v234, v246, s[36:39], s26 offen offset:2048
v_and_b32_e64 v25, s74, v25
v_mfma_f32_32x32x16_bf16 v[160:175], a[128:131], v[32:35], 0
ds_read_b64_tr_b16 a[152:153], v5 offset:38912
ds_read_b64_tr_b16 a[154:155], v5 offset:39936
v_mul_f32_e64 v24, v24, v125
v_mul_f32 v25, v25, v125
v_mfma_f32_32x32x16_bf16 v[160:175], a[132:135], v[36:39], v[160:175]
s_waitcnt lgkmcnt(6)
ds_read_b64_tr_b16 a[156:157], v5 offset:40960
ds_read_b64_tr_b16 a[158:159], v5 offset:41984
v_readlane_b32 s3, v245, 20
v_cvt_pk_bf16_f32 v112, v144, v145
v_cvt_pk_bf16_f32 v113, v146, v147
v_mfma_f32_32x32x16_bf16 v[160:175], a[136:139], v[40:43], v[160:175]
ds_read_b64_tr_b16 a[128:129], v16 offset:17408
ds_read_b64_tr_b16 a[130:131], v16 offset:18432
v_cvt_pk_bf16_f32 v114, v148, v149
v_cvt_pk_bf16_f32 v115, v150, v151
v_mfma_f32_32x32x16_bf16 v[160:175], a[140:143], v[44:47], v[160:175]
s_waitcnt lgkmcnt(6)
s_nop 0
ds_read_b64_tr_b16 a[132:133], v16 offset:19456
ds_read_b64_tr_b16 a[134:135], v16 offset:20480
buffer_store_dwordx4 v[112:115], v253, s[56:59], s3 offen offset:0 sc1
v_mfma_f32_32x32x16_bf16 v[160:175], a[144:147], a[160:163], v[160:175]
ds_read_b64_tr_b16 a[136:137], v16 offset:21504
ds_read_b64_tr_b16 a[138:139], v16 offset:22528
v_cvt_pk_bf16_f32 v25, v24, v25
v_mfma_f32_32x32x16_bf16 v[160:175], a[148:151], a[164:167], v[160:175]
s_waitcnt lgkmcnt(6)
ds_read_b64_tr_b16 a[140:141], v16 offset:23552
ds_read_b64_tr_b16 a[142:143], v16 offset:24576
v_lshlrev_b32 v24, 16, v25
v_mfma_f32_32x32x16_bf16 v[160:175], a[152:155], a[168:171], v[160:175]
ds_read_b64_tr_b16 a[144:145], v5 offset:17408
ds_read_b64_tr_b16 a[146:147], v5 offset:18432
v_cvt_pk_bf16_f32 v116, v152, v153
v_cvt_pk_bf16_f32 v117, v154, v155
v_cvt_pk_bf16_f32 v118, v156, v157
v_mfma_f32_32x32x16_bf16 v[160:175], a[156:159], a[172:175], v[160:175]
s_waitcnt lgkmcnt(6)
ds_read_b64_tr_b16 a[148:149], v5 offset:19456
ds_read_b64_tr_b16 a[150:151], v5 offset:20480
v_cvt_pk_bf16_f32 v119, v158, v159
v_and_b32 v25, s74, v25
v_mfma_f32_32x32x16_bf16 v[160:175], a[128:131], v[48:51], v[160:175]
ds_read_b64_tr_b16 a[152:153], v5 offset:21504
ds_read_b64_tr_b16 a[154:155], v5 offset:22528
buffer_store_dwordx4 v[116:119], v253, s[56:59], s3 offen offset:1024 sc1
v_mfma_f32_32x32x16_bf16 v[160:175], a[132:135], v[52:55], v[160:175]
s_waitcnt lgkmcnt(8)
ds_read_b64_tr_b16 a[156:157], v5 offset:23552
ds_read_b64_tr_b16 a[158:159], v5 offset:24576
v_accvgpr_read_b32 v27, a246
v_mfma_f32_32x32x16_bf16 v[160:175], a[136:139], v[56:59], v[160:175]
s_waitcnt vmcnt(20) lgkmcnt(8)
s_barrier
ds_read_b64_tr_b16 a[128:129], v16 offset:52224
ds_read_b64_tr_b16 a[130:131], v16 offset:53248
v_mfma_f32_32x32x16_bf16 v[160:175], a[140:143], v[60:63], v[160:175]
s_waitcnt lgkmcnt(6)
ds_read_b64_tr_b16 a[132:133], v16 offset:54272
ds_read_b64_tr_b16 a[134:135], v16 offset:55296
v_add3_u32 v122, v112, v113, v114
v_add3_u32 v122, v122, v115, v116
v_add3_u32 v122, v122, v117, v118
v_mfma_f32_32x32x16_bf16 v[160:175], a[144:147], a[176:179], v[160:175]
ds_read_b64_tr_b16 a[136:137], v16 offset:56320
ds_read_b64_tr_b16 a[138:139], v16 offset:57344
v_add_u32_e64 v122, v122, v119
v_sub_u32 v122, s63, v122
v_mfma_f32_32x32x16_bf16 v[160:175], a[148:151], a[180:183], v[160:175]
s_waitcnt lgkmcnt(6)
ds_read_b64_tr_b16 a[140:141], v16 offset:58368
ds_read_b64_tr_b16 a[142:143], v16 offset:59392
buffer_store_dword v122, v246, s[56:59], s3 offen offset:2048 sc1
v_mfma_f32_32x32x16_bf16 v[160:175], a[152:155], a[184:187], v[160:175]
ds_read_b64_tr_b16 a[144:145], v5 offset:52224
ds_read_b64_tr_b16 a[146:147], v5 offset:53248
v_lshlrev_b32 v26, 16, v27
v_mfma_f32_32x32x16_bf16 v[160:175], a[156:159], a[188:191], v[160:175]
s_waitcnt lgkmcnt(6)
ds_read_b64_tr_b16 a[148:149], v5 offset:54272
ds_read_b64_tr_b16 a[150:151], v5 offset:55296
v_and_b32_e64 v27, s74, v27
v_mfma_f32_32x32x16_bf16 v[160:175], a[128:131], v[64:67], v[160:175]
ds_read_b64_tr_b16 a[152:153], v5 offset:56320
ds_read_b64_tr_b16 a[154:155], v5 offset:57344
v_sub_f32_e64 v26, v26, v124
v_sub_f32 v27, v27, v124
v_mfma_f32_32x32x16_bf16 v[160:175], a[132:135], v[68:71], v[160:175]
s_waitcnt lgkmcnt(6)
ds_read_b64_tr_b16 a[156:157], v5 offset:58368
ds_read_b64_tr_b16 a[158:159], v5 offset:59392
v_cvt_pk_bf16_f32 v27, v26, v27
v_mfma_f32_32x32x16_bf16 v[160:175], a[136:139], v[72:75], v[160:175]
ds_read_b64_tr_b16 a[128:129], v17 offset:4096
ds_read_b64_tr_b16 a[130:131], v17 offset:5120
v_lshlrev_b32 v26, 16, v27
v_mfma_f32_32x32x16_bf16 v[160:175], a[140:143], v[76:79], v[160:175]
s_waitcnt lgkmcnt(6)
ds_read_b64_tr_b16 a[132:133], v17 offset:6144
ds_read_b64_tr_b16 a[134:135], v17 offset:7168
v_and_b32 v27, s74, v27
v_mul_f32 v26, v26, v125
v_mfma_f32_32x32x16_bf16 v[160:175], a[144:147], a[192:195], v[160:175]
ds_read_b64_tr_b16 a[136:137], v17 offset:8192
ds_read_b64_tr_b16 a[138:139], v17 offset:9216
v_mul_f32 v27, v27, v125
v_mfma_f32_32x32x16_bf16 v[160:175], a[148:151], a[196:199], v[160:175]
s_waitcnt lgkmcnt(6)
ds_read_b64_tr_b16 a[140:141], v17 offset:10240
ds_read_b64_tr_b16 a[142:143], v17 offset:11264
v_cvt_pk_bf16_f32 v27, v26, v27
v_mfma_f32_32x32x16_bf16 v[160:175], a[152:155], a[200:203], v[160:175]
ds_read_b64_tr_b16 a[144:145], v6 offset:4096
ds_read_b64_tr_b16 a[146:147], v6 offset:5120
v_lshlrev_b32 v26, 16, v27
v_mfma_f32_32x32x16_bf16 v[160:175], a[156:159], a[204:207], v[160:175]
s_waitcnt lgkmcnt(6)
ds_read_b64_tr_b16 a[148:149], v6 offset:6144
ds_read_b64_tr_b16 a[150:151], v6 offset:7168
v_and_b32_e64 v27, s74, v27
v_accvgpr_read_b32 v29, a247
v_mfma_f32_32x32x16_bf16 v[160:175], a[128:131], v[80:83], v[160:175]
ds_read_b64_tr_b16 a[152:153], v6 offset:8192
ds_read_b64_tr_b16 a[154:155], v6 offset:9216
v_lshlrev_b32 v28, 16, v29
v_mfma_f32_32x32x16_bf16 v[160:175], a[132:135], v[84:87], v[160:175]
s_waitcnt lgkmcnt(6)
ds_read_b64_tr_b16 a[156:157], v6 offset:10240
ds_read_b64_tr_b16 a[158:159], v6 offset:11264
v_and_b32_e64 v29, s74, v29
v_mfma_f32_32x32x16_bf16 v[160:175], a[136:139], v[88:91], v[160:175]
v_sub_f32 v28, v28, v124
v_sub_f32 v29, v29, v124
v_cvt_pk_bf16_f32 v29, v28, v29
v_mfma_f32_32x32x16_bf16 v[160:175], a[140:143], v[92:95], v[160:175]
s_waitcnt lgkmcnt(4)
v_lshlrev_b32 v28, 16, v29
v_and_b32 v29, s74, v29
v_mul_f32 v28, v28, v125
v_mul_f32_e64 v29, v29, v125
v_mfma_f32_32x32x16_bf16 v[160:175], a[144:147], a[208:211], v[160:175]
v_cvt_pk_bf16_f32 v29, v28, v29
v_lshlrev_b32_e64 v28, 16, v29
v_and_b32 v29, s74, v29
v_mfma_f32_32x32x16_bf16 v[160:175], a[148:151], a[212:215], v[160:175]
s_waitcnt lgkmcnt(0)
v_mfma_f32_32x32x16_bf16 v[160:175], a[152:155], a[216:219], v[160:175]
v_mfma_f32_32x32x16_bf16 v[160:175], a[156:159], a[220:223], v[160:175]
s_cmp_lg_u32 s33, 0
s_cbranch_scc1 recurrent_scan__sliding_block_cached__moe_arch_mod__prompt_kernel_last
buffer_load_dwordx4 v[200:203], v253, s[36:39], s27 offen offset:0
buffer_load_dwordx4 v[204:207], v253, s[36:39], s27 offen offset:1024
buffer_load_dword v235, v246, s[36:39], s27 offen offset:2048
buffer_load_dwordx4 v[208:211], v253, s[36:39], s30 offen offset:0
buffer_load_dwordx4 v[212:215], v253, s[36:39], s30 offen offset:1024
buffer_load_dword v236, v246, s[36:39], s30 offen offset:2048
v_mov_b32 v70, 0x3f80
v_mov_b32 v71, 1.0
s_waitcnt vmcnt(9)
v_add3_u32 v48, v176, v177, v178
v_add3_u32 v48, v48, v179, v180
v_add3_u32 v48, v48, v181, v182
v_add3_u32 v48, v48, v183, v232
v_cmp_ne_u32 vcc, s63, v48
s_nop 0
v_add3_u32 v49, v184, v185, v186
v_add3_u32 v49, v49, v187, v188
v_add3_u32 v49, v49, v189, v190
v_add3_u32 v49, v49, v191, v233
v_cmp_ne_u32 s[18:19], s63, v49
s_nop 0
s_or_b64 vcc, vcc, s[18:19]
v_add3_u32 v50, v192, v193, v194
v_add3_u32 v50, v50, v195, v196
v_add3_u32 v50, v50, v197, v198
v_add3_u32 v50, v50, v199, v234
v_cmp_ne_u32 s[18:19], s63, v50
s_nop 0
s_or_b64 vcc, vcc, s[18:19]
s_cbranch_vccnz recurrent_scan__sliding_block_cached__moe_arch_mod__prompt_kernel_rt0
recurrent_scan__sliding_block_cached__moe_arch_mod__prompt_kernel_rtb0:
s_nop 0
v_dot2_f32_bf16 v160, v176, v70, v160
v_dot2_f32_bf16 v161, v176, v71, v161
v_dot2_f32_bf16 v162, v177, v70, v162
v_dot2_f32_bf16 v163, v177, v71, v163
v_dot2_f32_bf16 v164, v178, v70, v164
v_dot2_f32_bf16 v165, v178, v71, v165
v_dot2_f32_bf16 v166, v179, v70, v166
v_dot2_f32_bf16 v167, v179, v71, v167
v_dot2_f32_bf16 v168, v180, v70, v168
v_dot2_f32_bf16 v169, v180, v71, v169
v_dot2_f32_bf16 v170, v181, v70, v170
v_dot2_f32_bf16 v171, v181, v71, v171
v_dot2_f32_bf16 v172, v182, v70, v172
v_dot2_f32_bf16 v173, v182, v71, v173
v_dot2_f32_bf16 v174, v183, v70, v174
v_dot2_f32_bf16 v175, v183, v71, v175
v_dot2_f32_bf16 v160, v184, v70, v160
v_dot2_f32_bf16 v161, v184, v71, v161
v_dot2_f32_bf16 v162, v185, v70, v162
v_dot2_f32_bf16 v163, v185, v71, v163
v_dot2_f32_bf16 v164, v186, v70, v164
v_dot2_f32_bf16 v165, v186, v71, v165
v_dot2_f32_bf16 v166, v187, v70, v166
v_dot2_f32_bf16 v167, v187, v71, v167
v_dot2_f32_bf16 v168, v188, v70, v168
v_dot2_f32_bf16 v169, v188, v71, v169
v_dot2_f32_bf16 v170, v189, v70, v170
v_dot2_f32_bf16 v171, v189, v71, v171
v_dot2_f32_bf16 v172, v190, v70, v172
v_dot2_f32_bf16 v173, v190, v71, v173
v_dot2_f32_bf16 v174, v191, v70, v174
v_dot2_f32_bf16 v175, v191, v71, v175
v_dot2_f32_bf16 v160, v192, v70, v160
v_dot2_f32_bf16 v161, v192, v71, v161
v_dot2_f32_bf16 v162, v193, v70, v162
v_dot2_f32_bf16 v163, v193, v71, v163
v_dot2_f32_bf16 v164, v194, v70, v164
v_dot2_f32_bf16 v165, v194, v71, v165
v_dot2_f32_bf16 v166, v195, v70, v166
v_dot2_f32_bf16 v167, v195, v71, v167
v_dot2_f32_bf16 v168, v196, v70, v168
v_dot2_f32_bf16 v169, v196, v71, v169
v_dot2_f32_bf16 v170, v197, v70, v170
v_dot2_f32_bf16 v171, v197, v71, v171
v_dot2_f32_bf16 v172, v198, v70, v172
buffer_load_dwordx4 v[216:219], v253, s[36:39], s31 offen offset:0
buffer_load_dwordx4 v[220:223], v253, s[36:39], s31 offen offset:1024
buffer_load_dword v237, v246, s[36:39], s31 offen offset:2048
buffer_load_dwordx4 v[224:227], v253, s[36:39], s13 offen offset:0
buffer_load_dwordx4 v[228:231], v253, s[36:39], s13 offen offset:1024
buffer_load_dword v238, v246, s[36:39], s13 offen offset:2048
v_dot2_f32_bf16 v173, v198, v71, v173
v_dot2_f32_bf16 v174, v199, v70, v174
v_dot2_f32_bf16 v175, v199, v71, v175
s_cmp_lg_u32 s46, 0
s_cbranch_scc1 recurrent_scan__sliding_block_cached__moe_arch_mod__prompt_kernel_own0
recurrent_scan__sliding_block_cached__moe_arch_mod__prompt_kernel_ownb0:
s_cmp_lg_u32 s50, 0
s_cbranch_scc1 recurrent_scan__sliding_block_cached__moe_arch_mod__prompt_kernel_own1
recurrent_scan__sliding_block_cached__moe_arch_mod__prompt_kernel_ownb1:
v_pk_mul_f32 v[72:73], v[8:9], s[78:79] op_sel:[0,0] op_sel_hi:[1,0]
v_pk_mul_f32 v[74:75], v[10:11], s[78:79] op_sel:[0,0] op_sel_hi:[1,0]
v_pk_mul_f32 v[76:77], v[12:13], s[78:79] op_sel:[0,0] op_sel_hi:[1,0]
v_pk_mul_f32 v[78:79], v[14:15], s[78:79] op_sel:[0,0] op_sel_hi:[1,0]
v_pk_mul_f32 v[80:81], v[22:23], s[78:79] op_sel:[0,0] op_sel_hi:[1,0]
v_pk_mul_f32 v[82:83], v[24:25], s[78:79] op_sel:[0,0] op_sel_hi:[1,0]
v_pk_mul_f32 v[84:85], v[26:27], s[78:79] op_sel:[0,0] op_sel_hi:[1,0]
v_pk_mul_f32 v[86:87], v[28:29], s[78:79] op_sel:[0,0] op_sel_hi:[1,0]
v_exp_f32 v72, v72
v_exp_f32 v73, v73
v_exp_f32 v74, v74
v_exp_f32 v75, v75
v_exp_f32 v76, v76
v_exp_f32 v77, v77
v_exp_f32 v78, v78
v_exp_f32 v79, v79
v_exp_f32 v80, v80
v_exp_f32 v81, v81
v_exp_f32 v82, v82
v_exp_f32 v83, v83
v_exp_f32 v84, v84
v_exp_f32 v85, v85
v_exp_f32 v86, v86
v_exp_f32 v87, v87
v_pk_add_f32 v[72:73], v[72:73], s[78:79] op_sel:[0,1] op_sel_hi:[1,1]
v_pk_add_f32 v[74:75], v[74:75], s[78:79] op_sel:[0,1] op_sel_hi:[1,1]
v_pk_add_f32 v[76:77], v[76:77], s[78:79] op_sel:[0,1] op_sel_hi:[1,1]
v_pk_add_f32 v[78:79], v[78:79], s[78:79] op_sel:[0,1] op_sel_hi:[1,1]
v_pk_add_f32 v[80:81], v[80:81], s[78:79] op_sel:[0,1] op_sel_hi:[1,1]
v_pk_add_f32 v[82:83], v[82:83], s[78:79] op_sel:[0,1] op_sel_hi:[1,1]
v_pk_add_f32 v[84:85], v[84:85], s[78:79] op_sel:[0,1] op_sel_hi:[1,1]
v_pk_add_f32 v[86:87], v[86:87], s[78:79] op_sel:[0,1] op_sel_hi:[1,1]
v_rcp_f32 v72, v72
v_rcp_f32 v73, v73
v_rcp_f32 v74, v74
v_rcp_f32 v75, v75
v_rcp_f32 v76, v76
v_rcp_f32 v77, v77
v_rcp_f32 v78, v78
v_rcp_f32 v79, v79
v_rcp_f32 v80, v80
v_rcp_f32 v81, v81
v_rcp_f32 v82, v82
v_rcp_f32 v83, v83
v_rcp_f32 v84, v84
v_rcp_f32 v85, v85
v_rcp_f32 v86, v86
v_rcp_f32 v87, v87
v_accvgpr_read_b32 v33, a240
v_accvgpr_read_b32 v35, a241
v_accvgpr_read_b32 v37, a242
v_accvgpr_read_b32 v39, a243
v_accvgpr_read_b32 v41, a244
v_accvgpr_read_b32 v43, a245
v_accvgpr_read_b32 v45, a246
v_accvgpr_read_b32 v47, a247
v_pk_mul_f32 v[8:9], v[8:9], v[72:73]
v_pk_mul_f32 v[10:11], v[10:11], v[74:75]
v_pk_mul_f32 v[12:13], v[12:13], v[76:77]
v_pk_mul_f32 v[14:15], v[14:15], v[78:79]
v_pk_mul_f32 v[22:23], v[22:23], v[80:81]
v_pk_mul_f32 v[24:25], v[24:25], v[82:83]
v_pk_mul_f32 v[26:27], v[26:27], v[84:85]
v_pk_mul_f32 v[28:29], v[28:29], v[86:87]
v_cvt_pk_bf16_f32 v9, v8, v9
v_lshlrev_b32 v8, 16, v9
v_and_b32 v9, s74, v9
v_cvt_pk_bf16_f32 v11, v10, v11
v_lshlrev_b32 v10, 16, v11
v_and_b32 v11, s74, v11
v_cvt_pk_bf16_f32 v13, v12, v13
v_lshlrev_b32 v12, 16, v13
v_and_b32 v13, s74, v13
v_cvt_pk_bf16_f32 v15, v14, v15
v_lshlrev_b32 v14, 16, v15
v_and_b32 v15, s74, v15
v_cvt_pk_bf16_f32 v23, v22, v23
v_lshlrev_b32 v22, 16, v23
v_and_b32 v23, s74, v23
v_cvt_pk_bf16_f32 v25, v24, v25
v_lshlrev_b32 v24, 16, v25
v_and_b32 v25, s74, v25
v_cvt_pk_bf16_f32 v27, v26, v27
v_lshlrev_b32 v26, 16, v27
v_and_b32 v27, s74, v27
v_cvt_pk_bf16_f32 v29, v28, v29
v_lshlrev_b32 v28, 16, v29
v_and_b32 v29, s74, v29
v_lshlrev_b32 v32, 16, v33
v_and_b32 v33, s74, v33
v_lshlrev_b32 v34, 16, v35
v_and_b32 v35, s74, v35
v_lshlrev_b32 v36, 16, v37
v_and_b32 v37, s74, v37
v_lshlrev_b32 v38, 16, v39
v_and_b32 v39, s74, v39
v_lshlrev_b32 v40, 16, v41
v_and_b32 v41, s74, v41
v_lshlrev_b32 v42, 16, v43
v_and_b32 v43, s74, v43
v_lshlrev_b32 v44, 16, v45
v_and_b32 v45, s74, v45
v_lshlrev_b32_e64 v46, 16, v47
v_and_b32 v47, s74, v47
s_waitcnt vmcnt(6)
v_add3_u32 v48, v200, v201, v202
v_add3_u32 v48, v48, v203, v204
v_add3_u32 v48, v48, v205, v206
v_add3_u32 v48, v48, v207, v235
v_cmp_ne_u32 vcc, s63, v48
v_add3_u32 v49, v208, v209, v210
v_add3_u32 v49, v49, v211, v212
v_add3_u32 v49, v49, v213, v214
v_add3_u32 v49, v49, v215, v236
v_cmp_ne_u32 s[18:19], s63, v49
s_nop 0
s_or_b64 vcc, vcc, s[18:19]
s_cbranch_vccnz recurrent_scan__sliding_block_cached__moe_arch_mod__prompt_kernel_rt1
recurrent_scan__sliding_block_cached__moe_arch_mod__prompt_kernel_rtb1:
v_dot2_f32_bf16 v160, v200, v70, v160
v_dot2_f32_bf16 v161, v200, v71, v161
v_dot2_f32_bf16 v162, v201, v70, v162
v_dot2_f32_bf16 v163, v201, v71, v163
v_dot2_f32_bf16 v164, v202, v70, v164
v_dot2_f32_bf16 v165, v202, v71, v165
v_dot2_f32_bf16 v166, v203, v70, v166
v_dot2_f32_bf16 v167, v203, v71, v167
v_dot2_f32_bf16 v168, v204, v70, v168
v_dot2_f32_bf16 v169, v204, v71, v169
v_dot2_f32_bf16 v170, v205, v70, v170
v_dot2_f32_bf16 v171, v205, v71, v171
v_dot2_f32_bf16 v172, v206, v70, v172
v_dot2_f32_bf16 v173, v206, v71, v173
v_dot2_f32_bf16 v174, v207, v70, v174
v_dot2_f32_bf16 v175, v207, v71, v175
v_dot2_f32_bf16 v160, v208, v70, v160
v_dot2_f32_bf16 v161, v208, v71, v161
v_dot2_f32_bf16 v162, v209, v70, v162
v_dot2_f32_bf16 v163, v209, v71, v163
v_dot2_f32_bf16 v164, v210, v70, v164
v_dot2_f32_bf16 v165, v210, v71, v165
v_dot2_f32_bf16 v166, v211, v70, v166
v_dot2_f32_bf16 v167, v211, v71, v167
v_dot2_f32_bf16 v168, v212, v70, v168
v_dot2_f32_bf16 v169, v212, v71, v169
v_dot2_f32_bf16 v170, v213, v70, v170
v_dot2_f32_bf16 v171, v213, v71, v171
v_dot2_f32_bf16 v172, v214, v70, v172
v_dot2_f32_bf16 v173, v214, v71, v173
v_dot2_f32_bf16 v174, v215, v70, v174
v_dot2_f32_bf16 v175, v215, v71, v175
s_waitcnt vmcnt(0)
v_add3_u32 v48, v216, v217, v218
v_add3_u32 v48, v48, v219, v220
v_add3_u32 v48, v48, v221, v222
v_add3_u32 v48, v48, v223, v237
v_cmp_ne_u32 vcc, s63, v48
v_add3_u32 v49, v224, v225, v226
v_add3_u32 v49, v49, v227, v228
v_add3_u32 v49, v49, v229, v230
v_add3_u32 v49, v49, v231, v238
v_cmp_ne_u32 s[18:19], s63, v49
s_nop 0
s_or_b64 vcc, vcc, s[18:19]
s_cbranch_vccnz recurrent_scan__sliding_block_cached__moe_arch_mod__prompt_kernel_rt2
recurrent_scan__sliding_block_cached__moe_arch_mod__prompt_kernel_rtb2:
s_nop 0
v_dot2_f32_bf16 v160, v216, v70, v160
v_dot2_f32_bf16 v161, v216, v71, v161
v_dot2_f32_bf16 v162, v217, v70, v162
v_dot2_f32_bf16 v163, v217, v71, v163
v_dot2_f32_bf16 v164, v218, v70, v164
v_dot2_f32_bf16 v165, v218, v71, v165
v_dot2_f32_bf16 v166, v219, v70, v166
v_dot2_f32_bf16 v167, v219, v71, v167
v_dot2_f32_bf16 v160, v224, v70, v160
v_dot2_f32_bf16 v161, v224, v71, v161
v_dot2_f32_bf16 v162, v225, v70, v162
v_dot2_f32_bf16 v163, v225, v71, v163
v_dot2_f32_bf16 v164, v226, v70, v164
v_dot2_f32_bf16 v165, v226, v71, v165
v_dot2_f32_bf16 v166, v227, v70, v166
v_dot2_f32_bf16 v167, v227, v71, v167
v_cvt_pk_bf16_f32 v161, v160, v161
v_lshlrev_b32 v160, 16, v161
v_and_b32 v161, s74, v161
v_cvt_pk_bf16_f32 v163, v162, v163
v_lshlrev_b32 v162, 16, v163
v_and_b32 v163, s74, v163
v_cvt_pk_bf16_f32 v165, v164, v165
v_lshlrev_b32 v164, 16, v165
v_and_b32 v165, s74, v165
v_cvt_pk_bf16_f32 v167, v166, v167
v_lshlrev_b32 v166, 16, v167
v_and_b32 v167, s74, v167
v_pk_mul_f32 v[160:161], v[160:161], v[8:9]
v_pk_mul_f32 v[162:163], v[162:163], v[10:11]
v_pk_mul_f32 v[164:165], v[164:165], v[12:13]
v_pk_mul_f32 v[166:167], v[166:167], v[14:15]
v_cvt_pk_bf16_f32 v161, v160, v161
v_lshlrev_b32 v160, 16, v161
v_and_b32 v161, s74, v161
v_cvt_pk_bf16_f32 v163, v162, v163
v_lshlrev_b32 v162, 16, v163
v_and_b32 v163, s74, v163
v_cvt_pk_bf16_f32 v165, v164, v165
v_lshlrev_b32 v164, 16, v165
v_and_b32 v165, s74, v165
v_cvt_pk_bf16_f32 v167, v166, v167
v_lshlrev_b32 v166, 16, v167
v_and_b32 v167, s74, v167
v_pk_add_f32 v[160:161], v[160:161], v[32:33]
v_pk_add_f32 v[162:163], v[162:163], v[34:35]
v_pk_add_f32 v[164:165], v[164:165], v[36:37]
v_pk_add_f32 v[166:167], v[166:167], v[38:39]
v_cvt_pk_bf16_f32 v72, v160, v161
v_cvt_pk_bf16_f32 v73, v162, v163
v_cvt_pk_bf16_f32 v74, v164, v165
v_cvt_pk_bf16_f32 v75, v166, v167
buffer_store_dwordx4 v[72:75], v247, s[40:43], s12 offen offset:0
v_dot2_f32_bf16 v168, v220, v70, v168
v_dot2_f32_bf16 v169, v220, v71, v169
v_dot2_f32_bf16 v170, v221, v70, v170
v_dot2_f32_bf16 v171, v221, v71, v171
v_dot2_f32_bf16 v172, v222, v70, v172
v_dot2_f32_bf16 v173, v222, v71, v173
v_dot2_f32_bf16 v174, v223, v70, v174
v_dot2_f32_bf16 v175, v223, v71, v175
v_dot2_f32_bf16 v168, v228, v70, v168
v_dot2_f32_bf16 v169, v228, v71, v169
v_dot2_f32_bf16 v170, v229, v70, v170
v_dot2_f32_bf16 v171, v229, v71, v171
v_dot2_f32_bf16 v172, v230, v70, v172
v_dot2_f32_bf16 v173, v230, v71, v173
v_dot2_f32_bf16 v174, v231, v70, v174
v_dot2_f32_bf16 v175, v231, v71, v175
v_cvt_pk_bf16_f32 v169, v168, v169
v_lshlrev_b32 v168, 16, v169
v_and_b32 v169, s74, v169
v_cvt_pk_bf16_f32 v171, v170, v171
v_lshlrev_b32 v170, 16, v171
v_and_b32 v171, s74, v171
v_cvt_pk_bf16_f32 v173, v172, v173
v_lshlrev_b32 v172, 16, v173
v_and_b32 v173, s74, v173
v_cvt_pk_bf16_f32 v175, v174, v175
v_lshlrev_b32 v174, 16, v175
v_and_b32 v175, s74, v175
v_pk_mul_f32 v[168:169], v[168:169], v[22:23]
v_pk_mul_f32 v[170:171], v[170:171], v[24:25]
v_pk_mul_f32 v[172:173], v[172:173], v[26:27]
v_pk_mul_f32 v[174:175], v[174:175], v[28:29]
v_cvt_pk_bf16_f32 v169, v168, v169
v_lshlrev_b32 v168, 16, v169
v_and_b32 v169, s74, v169
v_cvt_pk_bf16_f32 v171, v170, v171
v_lshlrev_b32 v170, 16, v171
v_and_b32 v171, s74, v171
v_cvt_pk_bf16_f32 v173, v172, v173
v_lshlrev_b32 v172, 16, v173
v_and_b32 v173, s74, v173
v_cvt_pk_bf16_f32 v175, v174, v175
v_lshlrev_b32 v174, 16, v175
v_and_b32 v175, s74, v175
v_pk_add_f32 v[168:169], v[168:169], v[40:41]
v_pk_add_f32 v[170:171], v[170:171], v[42:43]
v_pk_add_f32 v[172:173], v[172:173], v[44:45]
v_pk_add_f32 v[174:175], v[174:175], v[46:47]
v_cvt_pk_bf16_f32 v76, v168, v169
v_cvt_pk_bf16_f32 v77, v170, v171
v_cvt_pk_bf16_f32 v78, v172, v173
v_cvt_pk_bf16_f32 v79, v174, v175
buffer_store_dwordx4 v[76:79], v247, s[40:43], s12 offen offset:32
recurrent_scan__sliding_block_cached__moe_arch_mod__prompt_kernel_fin:
recurrent_scan__sliding_block_cached__moe_arch_mod__prompt_kernel_exit:
s_endpgm
recurrent_scan__sliding_block_cached__moe_arch_mod__prompt_kernel_poll:
s_mov_b32 s20, 20000
recurrent_scan__sliding_block_cached__moe_arch_mod__prompt_kernel_poll1:
s_sleep 8
buffer_load_dwordx2 v[10:11], v8, s[8:11], 0 offen sc1
s_sub_u32 s20, s20, 1
s_cbranch_scc1 recurrent_scan__sliding_block_cached__moe_arch_mod__prompt_kernel_poll2
s_waitcnt vmcnt(0)
v_and_b32 v225, 1, v10
v_cmp_eq_u32 s[18:19], 0, v225
s_nop 1
s_cmp_lg_u64 s[18:19], 0
s_cbranch_scc1 recurrent_scan__sliding_block_cached__moe_arch_mod__prompt_kernel_poll1
recurrent_scan__sliding_block_cached__moe_arch_mod__prompt_kernel_poll2:
s_waitcnt vmcnt(0)
s_branch recurrent_scan__sliding_block_cached__moe_arch_mod__prompt_kernel_pollback
recurrent_scan__sliding_block_cached__moe_arch_mod__prompt_kernel_fp:
s_mov_b32 s20, 20000
recurrent_scan__sliding_block_cached__moe_arch_mod__prompt_kernel_fp1:
s_sleep 8
buffer_load_dwordx4 v[248:251], v254, s[56:59], s17 offen sc1
s_sub_u32 s20, s20, 1
s_cbranch_scc1 recurrent_scan__sliding_block_cached__moe_arch_mod__prompt_kernel_fp2
s_waitcnt vmcnt(0)
v_min3_u32 v248, v248, v249, v250
v_min_u32 v248, v248, v251
v_cmp_eq_u32 s[18:19], 0, v248
s_nop 1
s_and_b64 s[18:19], s[18:19], s[60:61]
s_cbranch_scc1 recurrent_scan__sliding_block_cached__moe_arch_mod__prompt_kernel_fp1
recurrent_scan__sliding_block_cached__moe_arch_mod__prompt_kernel_fp2:
s_waitcnt vmcnt(0)
s_branch recurrent_scan__sliding_block_cached__moe_arch_mod__prompt_kernel_fpback
recurrent_scan__sliding_block_cached__moe_arch_mod__prompt_kernel_last:
s_nop 7
s_nop 3
v_readlane_b32 s3, v245, 24
v_cvt_pk_bf16_f32 v32, v160, v161
v_cvt_pk_bf16_f32 v33, v162, v163
v_cvt_pk_bf16_f32 v34, v164, v165
v_cvt_pk_bf16_f32 v35, v166, v167
s_nop 0
buffer_store_dwordx4 v[32:35], v253, s[56:59], s3 offen offset:0 sc1
v_cvt_pk_bf16_f32 v36, v168, v169
v_cvt_pk_bf16_f32 v37, v170, v171
v_cvt_pk_bf16_f32 v38, v172, v173
v_cvt_pk_bf16_f32 v39, v174, v175
buffer_store_dwordx4 v[36:39], v253, s[56:59], s3 offen offset:1024 sc1
v_add3_u32 v40, v32, v33, v34
v_add3_u32 v40, v40, v35, v36
v_add3_u32 v40, v40, v37, v38
v_add_u32_e64 v40, v40, v39
v_sub_u32 v40, s63, v40
buffer_store_dword v40, v246, s[56:59], s3 offen offset:2048 sc1
s_branch recurrent_scan__sliding_block_cached__moe_arch_mod__prompt_kernel_fin
recurrent_scan__sliding_block_cached__moe_arch_mod__prompt_kernel_rt0:
s_mov_b32 s20, 20000
recurrent_scan__sliding_block_cached__moe_arch_mod__prompt_kernel_rt0a:
buffer_load_dwordx4 v[176:179], v253, s[36:39], s24 offen offset:0 sc1
buffer_load_dwordx4 v[180:183], v253, s[36:39], s24 offen offset:1024 sc1
buffer_load_dword v232, v246, s[36:39], s24 offen offset:2048 sc1
buffer_load_dwordx4 v[184:187], v253, s[36:39], s25 offen offset:0 sc1
buffer_load_dwordx4 v[188:191], v253, s[36:39], s25 offen offset:1024 sc1
buffer_load_dword v233, v246, s[36:39], s25 offen offset:2048 sc1
buffer_load_dwordx4 v[192:195], v253, s[36:39], s26 offen offset:0 sc1
buffer_load_dwordx4 v[196:199], v253, s[36:39], s26 offen offset:1024 sc1
buffer_load_dword v234, v246, s[36:39], s26 offen offset:2048 sc1
s_sub_u32 s20, s20, 1
s_cbranch_scc1 recurrent_scan__sliding_block_cached__moe_arch_mod__prompt_kernel_rt0b
s_waitcnt vmcnt(0)
v_add3_u32 v48, v176, v177, v178
v_add3_u32 v48, v48, v179, v180
v_add3_u32 v48, v48, v181, v182
v_add3_u32 v48, v48, v183, v232
v_cmp_ne_u32 vcc, s63, v48
v_add3_u32 v49, v184, v185, v186
v_add3_u32 v49, v49, v187, v188
v_add3_u32 v49, v49, v189, v190
v_add3_u32 v49, v49, v191, v233
v_cmp_ne_u32 s[18:19], s63, v49
s_nop 0
s_or_b64 vcc, vcc, s[18:19]
v_add3_u32 v50, v192, v193, v194
v_add3_u32 v50, v50, v195, v196
v_add3_u32 v50, v50, v197, v198
v_add3_u32 v50, v50, v199, v234
v_cmp_ne_u32 s[18:19], s63, v50
s_nop 0
s_or_b64 vcc, vcc, s[18:19]
s_nop 1
s_cbranch_vccnz recurrent_scan__sliding_block_cached__moe_arch_mod__prompt_kernel_rt0a
recurrent_scan__sliding_block_cached__moe_arch_mod__prompt_kernel_rt0b:
s_waitcnt vmcnt(0)
s_branch recurrent_scan__sliding_block_cached__moe_arch_mod__prompt_kernel_rtb0
recurrent_scan__sliding_block_cached__moe_arch_mod__prompt_kernel_rt1:
s_mov_b32 s20, 20000
recurrent_scan__sliding_block_cached__moe_arch_mod__prompt_kernel_rt1a:
buffer_load_dwordx4 v[200:203], v253, s[36:39], s27 offen offset:0 sc1
buffer_load_dwordx4 v[204:207], v253, s[36:39], s27 offen offset:1024 sc1
buffer_load_dword v235, v246, s[36:39], s27 offen offset:2048 sc1
buffer_load_dwordx4 v[208:211], v253, s[36:39], s30 offen offset:0 sc1
buffer_load_dwordx4 v[212:215], v253, s[36:39], s30 offen offset:1024 sc1
buffer_load_dword v236, v246, s[36:39], s30 offen offset:2048 sc1
s_sub_u32 s20, s20, 1
s_cbranch_scc1 recurrent_scan__sliding_block_cached__moe_arch_mod__prompt_kernel_rt1b
s_waitcnt vmcnt(0)
v_add3_u32 v48, v200, v201, v202
v_add3_u32 v48, v48, v203, v204
v_add3_u32 v48, v48, v205, v206
v_add3_u32 v48, v48, v207, v235
v_cmp_ne_u32 vcc, s63, v48
v_add3_u32 v49, v208, v209, v210
v_add3_u32 v49, v49, v211, v212
v_add3_u32 v49, v49, v213, v214
v_add3_u32 v49, v49, v215, v236
v_cmp_ne_u32 s[18:19], s63, v49
s_nop 0
s_or_b64 vcc, vcc, s[18:19]
s_nop 1
s_cbranch_vccnz recurrent_scan__sliding_block_cached__moe_arch_mod__prompt_kernel_rt1a
recurrent_scan__sliding_block_cached__moe_arch_mod__prompt_kernel_rt1b:
s_waitcnt vmcnt(0)
s_branch recurrent_scan__sliding_block_cached__moe_arch_mod__prompt_kernel_rtb1
recurrent_scan__sliding_block_cached__moe_arch_mod__prompt_kernel_rt2:
s_mov_b32 s20, 20000
recurrent_scan__sliding_block_cached__moe_arch_mod__prompt_kernel_rt2a:
buffer_load_dwordx4 v[216:219], v253, s[36:39], s31 offen offset:0 sc1
buffer_load_dwordx4 v[220:223], v253, s[36:39], s31 offen offset:1024 sc1
buffer_load_dword v237, v246, s[36:39], s31 offen offset:2048 sc1
buffer_load_dwordx4 v[224:227], v253, s[36:39], s13 offen offset:0 sc1
buffer_load_dwordx4 v[228:231], v253, s[36:39], s13 offen offset:1024 sc1
buffer_load_dword v238, v246, s[36:39], s13 offen offset:2048 sc1
s_sub_u32 s20, s20, 1
s_cbranch_scc1 recurrent_scan__sliding_block_cached__moe_arch_mod__prompt_kernel_rt2b
s_waitcnt vmcnt(0)
v_add3_u32 v48, v216, v217, v218
v_add3_u32 v48, v48, v219, v220
v_add3_u32 v48, v48, v221, v222
v_add3_u32 v48, v48, v223, v237
v_cmp_ne_u32 vcc, s63, v48
v_add3_u32 v49, v224, v225, v226
v_add3_u32 v49, v49, v227, v228
v_add3_u32 v49, v49, v229, v230
v_add3_u32 v49, v49, v231, v238
v_cmp_ne_u32 s[18:19], s63, v49
s_nop 0
s_or_b64 vcc, vcc, s[18:19]
s_nop 1
s_cbranch_vccnz recurrent_scan__sliding_block_cached__moe_arch_mod__prompt_kernel_rt2a
recurrent_scan__sliding_block_cached__moe_arch_mod__prompt_kernel_rt2b:
s_waitcnt vmcnt(0)
s_branch recurrent_scan__sliding_block_cached__moe_arch_mod__prompt_kernel_rtb2
recurrent_scan__sliding_block_cached__moe_arch_mod__prompt_kernel_own0:
s_waitcnt vmcnt(24)
v_mov_b32 v68, s4
v_ashrrev_i32 v69, 31, v68
v_not_b32 v69, v69
v_or_b32 v69, 0x80000000, v69
v_xor_b32 v68, v68, v69
v_and_b32 v68, s74, v68
v_mul_f32 v68, s78, v68
v_exp_f32 v68, v68
v_cmp_eq_u32 vcc, s22, v30
v_add_f32 v68, 1.0, v68
v_rcp_f32_e64 v68, v68
v_add_f32_dpp v128, v128, v128 quad_perm:[1,0,3,2]
v_add_f32_dpp v129, v129, v129 quad_perm:[1,0,3,2]
v_add_f32_dpp v130, v130, v130 quad_perm:[1,0,3,2]
v_add_f32_dpp v131, v131, v131 quad_perm:[1,0,3,2]
v_add_f32_dpp v132, v132, v132 quad_perm:[1,0,3,2]
v_add_f32_dpp v133, v133, v133 quad_perm:[1,0,3,2]
v_add_f32_dpp v134, v134, v134 quad_perm:[1,0,3,2]
v_add_f32_dpp v135, v135, v135 quad_perm:[1,0,3,2]
v_add_f32_dpp v136, v136, v136 quad_perm:[1,0,3,2]
v_add_f32_dpp v137, v137, v137 quad_perm:[1,0,3,2]
v_add_f32_dpp v138, v138, v138 quad_perm:[1,0,3,2]
v_add_f32_dpp v139, v139, v139 quad_perm:[1,0,3,2]
v_add_f32_dpp v140, v140, v140 quad_perm:[1,0,3,2]
v_add_f32_dpp v141, v141, v141 quad_perm:[1,0,3,2]
v_add_f32_dpp v142, v142, v142 quad_perm:[1,0,3,2]
v_add_f32_dpp v143, v143, v143 quad_perm:[1,0,3,2]
v_add_f32_dpp v128, v128, v128 quad_perm:[2,3,0,1]
v_add_f32_dpp v129, v129, v129 quad_perm:[2,3,0,1]
v_add_f32_dpp v130, v130, v130 quad_perm:[2,3,0,1]
v_add_f32_dpp v131, v131, v131 quad_perm:[2,3,0,1]
v_add_f32_dpp v132, v132, v132 quad_perm:[2,3,0,1]
v_add_f32_dpp v133, v133, v133 quad_perm:[2,3,0,1]
v_add_f32_dpp v134, v134, v134 quad_perm:[2,3,0,1]
v_add_f32_dpp v135, v135, v135 quad_perm:[2,3,0,1]
v_add_f32_dpp v136, v136, v136 quad_perm:[2,3,0,1]
v_add_f32_dpp v137, v137, v137 quad_perm:[2,3,0,1]
v_add_f32_dpp v138, v138, v138 quad_perm:[2,3,0,1]
v_add_f32_dpp v139, v139, v139 quad_perm:[2,3,0,1]
v_add_f32_dpp v140, v140, v140 quad_perm:[2,3,0,1]
v_add_f32_dpp v141, v141, v141 quad_perm:[2,3,0,1]
v_add_f32_dpp v142, v142, v142 quad_perm:[2,3,0,1]
v_add_f32_dpp v143, v143, v143 quad_perm:[2,3,0,1]
v_add_f32_dpp v128, v128, v128 row_half_mirror
v_add_f32_dpp v129, v129, v129 row_half_mirror
v_add_f32_dpp v130, v130, v130 row_half_mirror
v_add_f32_dpp v131, v131, v131 row_half_mirror
v_add_f32_dpp v132, v132, v132 row_half_mirror
v_add_f32_dpp v133, v133, v133 row_half_mirror
v_add_f32_dpp v134, v134, v134 row_half_mirror
v_add_f32_dpp v135, v135, v135 row_half_mirror
v_add_f32_dpp v136, v136, v136 row_half_mirror
v_add_f32_dpp v137, v137, v137 row_half_mirror
v_add_f32_dpp v138, v138, v138 row_half_mirror
v_add_f32_dpp v139, v139, v139 row_half_mirror
v_add_f32_dpp v140, v140, v140 row_half_mirror
v_add_f32_dpp v141, v141, v141 row_half_mirror
v_add_f32_dpp v142, v142, v142 row_half_mirror
v_add_f32_dpp v143, v143, v143 row_half_mirror
v_cvt_pk_bf16_f32 v68, v68, v68
v_and_b32 v68, s74, v68
s_mov_b64 exec, vcc
v_cvt_pk_bf16_f32 v33, v128, v136
v_cvt_pk_bf16_f32 v35, v129, v137
v_cvt_pk_bf16_f32 v37, v130, v138
v_cvt_pk_bf16_f32 v39, v131, v139
v_cvt_pk_bf16_f32 v41, v132, v140
v_cvt_pk_bf16_f32 v43, v133, v141
v_cvt_pk_bf16_f32 v45, v134, v142
v_cvt_pk_bf16_f32 v47, v135, v143
v_lshlrev_b32 v32, 16, v33
v_and_b32 v33, s74, v33
v_pk_mul_f32 v[32:33], v[32:33], v[68:69] op_sel:[0,0] op_sel_hi:[1,0]
v_cvt_pk_bf16_f32 v33, v32, v33
v_lshlrev_b32 v32, 16, v33
v_and_b32 v33, s74, v33
v_pk_add_f32 v[8:9], v[32:33], v[8:9]
v_cvt_pk_bf16_f32 v9, v8, v9
v_lshlrev_b32 v8, 16, v9
v_and_b32 v9, s74, v9
v_lshlrev_b32 v34, 16, v35
v_and_b32 v35, s74, v35
v_pk_mul_f32 v[34:35], v[34:35], v[68:69] op_sel:[0,0] op_sel_hi:[1,0]
v_cvt_pk_bf16_f32 v35, v34, v35
v_lshlrev_b32 v34, 16, v35
v_and_b32 v35, s74, v35
v_pk_add_f32 v[10:11], v[34:35], v[10:11]
v_cvt_pk_bf16_f32 v11, v10, v11
v_lshlrev_b32 v10, 16, v11
v_and_b32 v11, s74, v11
v_lshlrev_b32 v36, 16, v37
v_and_b32 v37, s74, v37
v_pk_mul_f32 v[36:37], v[36:37], v[68:69] op_sel:[0,0] op_sel_hi:[1,0]
v_cvt_pk_bf16_f32 v37, v36, v37
v_lshlrev_b32 v36, 16, v37
v_and_b32 v37, s74, v37
v_pk_add_f32 v[12:13], v[36:37], v[12:13]
v_cvt_pk_bf16_f32 v13, v12, v13
v_lshlrev_b32 v12, 16, v13
v_and_b32 v13, s74, v13
v_lshlrev_b32 v38, 16, v39
v_and_b32 v39, s74, v39
v_pk_mul_f32 v[38:39], v[38:39], v[68:69] op_sel:[0,0] op_sel_hi:[1,0]
v_cvt_pk_bf16_f32 v39, v38, v39
v_lshlrev_b32 v38, 16, v39
v_and_b32 v39, s74, v39
v_pk_add_f32 v[14:15], v[38:39], v[14:15]
v_cvt_pk_bf16_f32 v15, v14, v15
v_lshlrev_b32 v14, 16, v15
v_and_b32 v15, s74, v15
v_lshlrev_b32 v40, 16, v41
v_and_b32 v41, s74, v41
v_pk_mul_f32 v[40:41], v[40:41], v[68:69] op_sel:[0,0] op_sel_hi:[1,0]
v_cvt_pk_bf16_f32 v41, v40, v41
v_lshlrev_b32 v40, 16, v41
v_and_b32 v41, s74, v41
v_pk_add_f32 v[22:23], v[40:41], v[22:23]
v_cvt_pk_bf16_f32 v23, v22, v23
v_lshlrev_b32 v22, 16, v23
v_and_b32 v23, s74, v23
v_lshlrev_b32 v42, 16, v43
v_and_b32 v43, s74, v43
v_pk_mul_f32 v[42:43], v[42:43], v[68:69] op_sel:[0,0] op_sel_hi:[1,0]
v_cvt_pk_bf16_f32 v43, v42, v43
v_lshlrev_b32 v42, 16, v43
v_and_b32 v43, s74, v43
v_pk_add_f32 v[24:25], v[42:43], v[24:25]
v_cvt_pk_bf16_f32 v25, v24, v25
v_lshlrev_b32 v24, 16, v25
v_and_b32 v25, s74, v25
v_lshlrev_b32 v44, 16, v45
v_and_b32 v45, s74, v45
v_pk_mul_f32 v[44:45], v[44:45], v[68:69] op_sel:[0,0] op_sel_hi:[1,0]
v_cvt_pk_bf16_f32 v45, v44, v45
v_lshlrev_b32 v44, 16, v45
v_and_b32 v45, s74, v45
v_pk_add_f32 v[26:27], v[44:45], v[26:27]
v_cvt_pk_bf16_f32 v27, v26, v27
v_lshlrev_b32 v26, 16, v27
v_and_b32 v27, s74, v27
v_lshlrev_b32 v46, 16, v47
v_and_b32 v47, s74, v47
v_pk_mul_f32 v[46:47], v[46:47], v[68:69] op_sel:[0,0] op_sel_hi:[1,0]
v_cvt_pk_bf16_f32 v47, v46, v47
v_lshlrev_b32 v46, 16, v47
v_and_b32 v47, s74, v47
v_pk_add_f32 v[28:29], v[46:47], v[28:29]
v_cvt_pk_bf16_f32 v29, v28, v29
v_lshlrev_b32 v28, 16, v29
v_and_b32 v29, s74, v29
s_mov_b64 exec, -1
s_branch recurrent_scan__sliding_block_cached__moe_arch_mod__prompt_kernel_ownb0
recurrent_scan__sliding_block_cached__moe_arch_mod__prompt_kernel_own1:
s_waitcnt vmcnt(24)
v_mov_b32 v68, s5
v_ashrrev_i32 v69, 31, v68
v_not_b32 v69, v69
v_or_b32 v69, 0x80000000, v69
v_xor_b32 v68, v68, v69
v_and_b32 v68, s74, v68
v_mul_f32 v68, s78, v68
v_exp_f32 v68, v68
v_cmp_eq_u32 vcc, s23, v30
v_add_f32 v68, 1.0, v68
v_rcp_f32_e64 v68, v68
v_add_f32_dpp v96, v96, v96 quad_perm:[1,0,3,2]
v_add_f32_dpp v97, v97, v97 quad_perm:[1,0,3,2]
v_add_f32_dpp v98, v98, v98 quad_perm:[1,0,3,2]
v_add_f32_dpp v99, v99, v99 quad_perm:[1,0,3,2]
v_add_f32_dpp v100, v100, v100 quad_perm:[1,0,3,2]
v_add_f32_dpp v101, v101, v101 quad_perm:[1,0,3,2]
v_add_f32_dpp v102, v102, v102 quad_perm:[1,0,3,2]
v_add_f32_dpp v103, v103, v103 quad_perm:[1,0,3,2]
v_add_f32_dpp v104, v104, v104 quad_perm:[1,0,3,2]
v_add_f32_dpp v105, v105, v105 quad_perm:[1,0,3,2]
v_add_f32_dpp v106, v106, v106 quad_perm:[1,0,3,2]
v_add_f32_dpp v107, v107, v107 quad_perm:[1,0,3,2]
v_add_f32_dpp v108, v108, v108 quad_perm:[1,0,3,2]
v_add_f32_dpp v109, v109, v109 quad_perm:[1,0,3,2]
v_add_f32_dpp v110, v110, v110 quad_perm:[1,0,3,2]
v_add_f32_dpp v111, v111, v111 quad_perm:[1,0,3,2]
v_add_f32_dpp v96, v96, v96 quad_perm:[2,3,0,1]
v_add_f32_dpp v97, v97, v97 quad_perm:[2,3,0,1]
v_add_f32_dpp v98, v98, v98 quad_perm:[2,3,0,1]
v_add_f32_dpp v99, v99, v99 quad_perm:[2,3,0,1]
v_add_f32_dpp v100, v100, v100 quad_perm:[2,3,0,1]
v_add_f32_dpp v101, v101, v101 quad_perm:[2,3,0,1]
v_add_f32_dpp v102, v102, v102 quad_perm:[2,3,0,1]
v_add_f32_dpp v103, v103, v103 quad_perm:[2,3,0,1]
v_add_f32_dpp v104, v104, v104 quad_perm:[2,3,0,1]
v_add_f32_dpp v105, v105, v105 quad_perm:[2,3,0,1]
v_add_f32_dpp v106, v106, v106 quad_perm:[2,3,0,1]
v_add_f32_dpp v107, v107, v107 quad_perm:[2,3,0,1]
v_add_f32_dpp v108, v108, v108 quad_perm:[2,3,0,1]
v_add_f32_dpp v109, v109, v109 quad_perm:[2,3,0,1]
v_add_f32_dpp v110, v110, v110 quad_perm:[2,3,0,1]
v_add_f32_dpp v111, v111, v111 quad_perm:[2,3,0,1]
v_add_f32_dpp v96, v96, v96 row_half_mirror
v_add_f32_dpp v97, v97, v97 row_half_mirror
v_add_f32_dpp v98, v98, v98 row_half_mirror
v_add_f32_dpp v99, v99, v99 row_half_mirror
v_add_f32_dpp v100, v100, v100 row_half_mirror
v_add_f32_dpp v101, v101, v101 row_half_mirror
v_add_f32_dpp v102, v102, v102 row_half_mirror
v_add_f32_dpp v103, v103, v103 row_half_mirror
v_add_f32_dpp v104, v104, v104 row_half_mirror
v_add_f32_dpp v105, v105, v105 row_half_mirror
v_add_f32_dpp v106, v106, v106 row_half_mirror
v_add_f32_dpp v107, v107, v107 row_half_mirror
v_add_f32_dpp v108, v108, v108 row_half_mirror
v_add_f32_dpp v109, v109, v109 row_half_mirror
v_add_f32_dpp v110, v110, v110 row_half_mirror
v_add_f32_dpp v111, v111, v111 row_half_mirror
v_cvt_pk_bf16_f32 v68, v68, v68
v_and_b32 v68, s74, v68
s_mov_b64 exec, vcc
v_cvt_pk_bf16_f32 v33, v96, v104
v_cvt_pk_bf16_f32 v35, v97, v105
v_cvt_pk_bf16_f32 v37, v98, v106
v_cvt_pk_bf16_f32 v39, v99, v107
v_cvt_pk_bf16_f32 v41, v100, v108
v_cvt_pk_bf16_f32 v43, v101, v109
v_cvt_pk_bf16_f32 v45, v102, v110
v_cvt_pk_bf16_f32 v47, v103, v111
v_lshlrev_b32 v32, 16, v33
v_and_b32 v33, s74, v33
v_pk_mul_f32 v[32:33], v[32:33], v[68:69] op_sel:[0,0] op_sel_hi:[1,0]
v_cvt_pk_bf16_f32 v33, v32, v33
v_lshlrev_b32 v32, 16, v33
v_and_b32 v33, s74, v33
v_pk_add_f32 v[8:9], v[32:33], v[8:9]
v_cvt_pk_bf16_f32 v9, v8, v9
v_lshlrev_b32 v8, 16, v9
v_and_b32 v9, s74, v9
v_lshlrev_b32 v34, 16, v35
v_and_b32 v35, s74, v35
v_pk_mul_f32 v[34:35], v[34:35], v[68:69] op_sel:[0,0] op_sel_hi:[1,0]
v_cvt_pk_bf16_f32 v35, v34, v35
v_lshlrev_b32 v34, 16, v35
v_and_b32 v35, s74, v35
v_pk_add_f32 v[10:11], v[34:35], v[10:11]
v_cvt_pk_bf16_f32 v11, v10, v11
v_lshlrev_b32 v10, 16, v11
v_and_b32 v11, s74, v11
v_lshlrev_b32 v36, 16, v37
v_and_b32 v37, s74, v37
v_pk_mul_f32 v[36:37], v[36:37], v[68:69] op_sel:[0,0] op_sel_hi:[1,0]
v_cvt_pk_bf16_f32 v37, v36, v37
v_lshlrev_b32 v36, 16, v37
v_and_b32 v37, s74, v37
v_pk_add_f32 v[12:13], v[36:37], v[12:13]
v_cvt_pk_bf16_f32 v13, v12, v13
v_lshlrev_b32 v12, 16, v13
v_and_b32 v13, s74, v13
v_lshlrev_b32 v38, 16, v39
v_and_b32 v39, s74, v39
v_pk_mul_f32 v[38:39], v[38:39], v[68:69] op_sel:[0,0] op_sel_hi:[1,0]
v_cvt_pk_bf16_f32 v39, v38, v39
v_lshlrev_b32 v38, 16, v39
v_and_b32 v39, s74, v39
v_pk_add_f32 v[14:15], v[38:39], v[14:15]
v_cvt_pk_bf16_f32 v15, v14, v15
v_lshlrev_b32 v14, 16, v15
v_and_b32 v15, s74, v15
v_lshlrev_b32 v40, 16, v41
v_and_b32 v41, s74, v41
v_pk_mul_f32 v[40:41], v[40:41], v[68:69] op_sel:[0,0] op_sel_hi:[1,0]
v_cvt_pk_bf16_f32 v41, v40, v41
v_lshlrev_b32 v40, 16, v41
v_and_b32 v41, s74, v41
v_pk_add_f32 v[22:23], v[40:41], v[22:23]
v_cvt_pk_bf16_f32 v23, v22, v23
v_lshlrev_b32 v22, 16, v23
v_and_b32 v23, s74, v23
v_lshlrev_b32 v42, 16, v43
v_and_b32 v43, s74, v43
v_pk_mul_f32 v[42:43], v[42:43], v[68:69] op_sel:[0,0] op_sel_hi:[1,0]
v_cvt_pk_bf16_f32 v43, v42, v43
v_lshlrev_b32 v42, 16, v43
v_and_b32 v43, s74, v43
v_pk_add_f32 v[24:25], v[42:43], v[24:25]
v_cvt_pk_bf16_f32 v25, v24, v25
v_lshlrev_b32 v24, 16, v25
v_and_b32 v25, s74, v25
v_lshlrev_b32 v44, 16, v45
v_and_b32 v45, s74, v45
v_pk_mul_f32 v[44:45], v[44:45], v[68:69] op_sel:[0,0] op_sel_hi:[1,0]
v_cvt_pk_bf16_f32 v45, v44, v45
v_lshlrev_b32 v44, 16, v45
v_and_b32 v45, s74, v45
v_pk_add_f32 v[26:27], v[44:45], v[26:27]
v_cvt_pk_bf16_f32 v27, v26, v27
v_lshlrev_b32 v26, 16, v27
v_and_b32 v27, s74, v27
v_lshlrev_b32 v46, 16, v47
v_and_b32 v47, s74, v47
v_pk_mul_f32 v[46:47], v[46:47], v[68:69] op_sel:[0,0] op_sel_hi:[1,0]
v_cvt_pk_bf16_f32 v47, v46, v47
v_lshlrev_b32 v46, 16, v47
v_and_b32 v47, s74, v47
v_pk_add_f32 v[28:29], v[46:47], v[28:29]
v_cvt_pk_bf16_f32 v29, v28, v29
v_lshlrev_b32 v28, 16, v29
v_and_b32 v29, s74, v29
s_mov_b64 exec, -1
s_branch recurrent_scan__sliding_block_cached__moe_arch_mod__prompt_kernel_ownb1
recurrent_scan__sliding_block_cached__moe_arch_mod__prompt_kernel_stub0:
s_mov_b32 vcc_lo, 4286578688
s_mov_b32 vcc_hi, 0
s_call_b64 s[100:101], recurrent_scan__sliding_block_cached__moe_arch_mod__prompt_kernel_rare0
s_branch recurrent_scan__sliding_block_cached__moe_arch_mod__prompt_kernel_back0
recurrent_scan__sliding_block_cached__moe_arch_mod__prompt_kernel_stub1:
s_mov_b32 vcc_lo, 0
s_mov_b32 vcc_hi, 0
s_call_b64 s[100:101], recurrent_scan__sliding_block_cached__moe_arch_mod__prompt_kernel_rare1
s_branch recurrent_scan__sliding_block_cached__moe_arch_mod__prompt_kernel_back1
recurrent_scan__sliding_block_cached__moe_arch_mod__prompt_kernel_stub2:
s_mov_b32 vcc_lo, 0
s_mov_b32 vcc_hi, 0
s_call_b64 s[100:101], recurrent_scan__sliding_block_cached__moe_arch_mod__prompt_kernel_rare0
s_branch recurrent_scan__sliding_block_cached__moe_arch_mod__prompt_kernel_back2
recurrent_scan__sliding_block_cached__moe_arch_mod__prompt_kernel_stub3:
s_mov_b32 vcc_lo, 0
s_mov_b32 vcc_hi, 0
s_call_b64 s[100:101], recurrent_scan__sliding_block_cached__moe_arch_mod__prompt_kernel_rare1
s_branch recurrent_scan__sliding_block_cached__moe_arch_mod__prompt_kernel_back3
recurrent_scan__sliding_block_cached__moe_arch_mod__prompt_kernel_stub4:
s_mov_b32 vcc_lo, 0
s_mov_b32 vcc_hi, 0
s_call_b64 s[100:101], recurrent_scan__sliding_block_cached__moe_arch_mod__prompt_kernel_rare0
s_branch recurrent_scan__sliding_block_cached__moe_arch_mod__prompt_kernel_back4
recurrent_scan__sliding_block_cached__moe_arch_mod__prompt_kernel_stub5:
s_mov_b32 vcc_lo, 0
s_mov_b32 vcc_hi, 0
s_call_b64 s[100:101], recurrent_scan__sliding_block_cached__moe_arch_mod__prompt_kernel_rare1
s_branch recurrent_scan__sliding_block_cached__moe_arch_mod__prompt_kernel_back5
recurrent_scan__sliding_block_cached__moe_arch_mod__prompt_kernel_stub6:
s_mov_b32 vcc_lo, 0
s_mov_b32 vcc_hi, 0
s_call_b64 s[100:101], recurrent_scan__sliding_block_cached__moe_arch_mod__prompt_kernel_rare0
s_branch recurrent_scan__sliding_block_cached__moe_arch_mod__prompt_kernel_back6
recurrent_scan__sliding_block_cached__moe_arch_mod__prompt_kernel_stub7:
s_mov_b32 vcc_lo, 0
s_mov_b32 vcc_hi, 1
s_call_b64 s[100:101], recurrent_scan__sliding_block_cached__moe_arch_mod__prompt_kernel_rare1
s_branch recurrent_scan__sliding_block_cached__moe_arch_mod__prompt_kernel_back7
recurrent_scan__sliding_block_cached__moe_arch_mod__prompt_kernel_rare0:
s_nop 7
s_nop 7
s_nop 7
v_max_f32_e64 v248, v96, v97
v_max3_f32 v248, v248, v98, v99
v_max3_f32 v248, v248, v100, v101
v_max3_f32 v248, v248, v102, v103
v_max3_f32 v248, v248, v104, v105
v_max3_f32 v248, v248, v106, v107
v_max3_f32 v248, v248, v108, v109
v_max3_f32 v248, v248, v110, v111
v_max3_f32 v248, v248, v112, v113
v_max3_f32 v248, v248, v114, v115
v_max3_f32 v248, v248, v116, v117
v_max3_f32 v248, v248, v118, v119
v_max3_f32 v248, v248, v120, v121
v_max3_f32 v248, v248, v122, v123
v_max3_f32 v248, v248, v124, v125
v_max3_f32 v248, v248, v126, v127
v_mov_b32 v249, v248
s_nop 1
v_permlane32_swap_b32 v248, v249
v_max_f32 v248, v248, v249
v_max_f32 v248, vcc_lo, v248
v_sub_f32 v249, 0, v248
v_min_f32 v249, 0, v249
v_exp_f32 v249, v249
v_sub_f32 v96, v96, v248
v_sub_f32 v97, v97, v248
v_sub_f32 v98, v98, v248
v_sub_f32 v99, v99, v248
v_sub_f32 v100, v100, v248
v_sub_f32 v101, v101, v248
v_sub_f32 v102, v102, v248
v_sub_f32 v103, v103, v248
v_sub_f32 v104, v104, v248
v_sub_f32 v105, v105, v248
v_sub_f32 v106, v106, v248
v_sub_f32 v107, v107, v248
v_sub_f32 v108, v108, v248
v_sub_f32 v109, v109, v248
v_sub_f32 v110, v110, v248
v_sub_f32 v111, v111, v248
v_sub_f32 v112, v112, v248
v_sub_f32 v113, v113, v248
v_sub_f32 v114, v114, v248
v_sub_f32 v115, v115, v248
v_sub_f32 v116, v116, v248
v_sub_f32 v117, v117, v248
v_sub_f32 v118, v118, v248
v_sub_f32 v119, v119, v248
v_sub_f32 v120, v120, v248
v_sub_f32 v121, v121, v248
v_sub_f32 v122, v122, v248
v_sub_f32 v123, v123, v248
v_sub_f32 v124, v124, v248
v_sub_f32 v125, v125, v248
v_sub_f32 v126, v126, v248
v_sub_f32 v127, v127, v248
v_sub_f32 v176, v176, v248
v_sub_f32 v177, v177, v248
v_sub_f32 v178, v178, v248
v_sub_f32 v179, v179, v248
v_sub_f32 v180, v180, v248
v_sub_f32 v181, v181, v248
v_sub_f32 v182, v182, v248
v_sub_f32 v183, v183, v248
v_sub_f32 v184, v184, v248
v_sub_f32 v185, v185, v248
v_sub_f32 v186, v186, v248
v_sub_f32 v187, v187, v248
v_sub_f32 v188, v188, v248
v_sub_f32 v189, v189, v248
v_sub_f32 v190, v190, v248
v_sub_f32 v191, v191, v248
v_sub_f32 v192, v192, v248
v_sub_f32 v193, v193, v248
v_sub_f32 v194, v194, v248
v_sub_f32 v195, v195, v248
v_sub_f32 v196, v196, v248
v_sub_f32 v197, v197, v248
v_sub_f32 v198, v198, v248
v_sub_f32 v199, v199, v248
v_sub_f32 v200, v200, v248
v_sub_f32 v201, v201, v248
v_sub_f32 v202, v202, v248
v_sub_f32 v203, v203, v248
v_sub_f32 v204, v204, v248
v_sub_f32 v205, v205, v248
v_sub_f32 v206, v206, v248
v_sub_f32 v207, v207, v248
v_sub_f32 v208, v208, v248
v_sub_f32 v209, v209, v248
v_sub_f32 v210, v210, v248
v_sub_f32 v211, v211, v248
v_sub_f32 v212, v212, v248
v_sub_f32 v213, v213, v248
v_sub_f32 v214, v214, v248
v_sub_f32 v215, v215, v248
v_sub_f32 v216, v216, v248
v_sub_f32 v217, v217, v248
v_sub_f32 v218, v218, v248
v_sub_f32 v219, v219, v248
v_sub_f32 v220, v220, v248
v_sub_f32 v221, v221, v248
v_sub_f32 v222, v222, v248
v_sub_f32 v223, v223, v248
v_mul_f32_e64 v30, v30, v249
v_accvgpr_read_b32 v240, a0
v_mul_f32_e64 v240, v240, v249
v_accvgpr_write_b32 a0, v240
v_accvgpr_read_b32 v241, a1
v_mul_f32_e64 v241, v241, v249
v_accvgpr_write_b32 a1, v241
v_accvgpr_read_b32 v242, a2
v_mul_f32_e64 v242, v242, v249
v_accvgpr_write_b32 a2, v242
v_accvgpr_read_b32 v243, a3
v_mul_f32_e64 v243, v243, v249
v_accvgpr_write_b32 a3, v243
v_accvgpr_read_b32 v240, a4
v_mul_f32_e64 v240, v240, v249
v_accvgpr_write_b32 a4, v240
v_accvgpr_read_b32 v241, a5
v_mul_f32_e64 v241, v241, v249
v_accvgpr_write_b32 a5, v241
v_accvgpr_read_b32 v242, a6
v_mul_f32_e64 v242, v242, v249
v_accvgpr_write_b32 a6, v242
v_accvgpr_read_b32 v243, a7
v_mul_f32_e64 v243, v243, v249
v_accvgpr_write_b32 a7, v243
v_accvgpr_read_b32 v240, a8
v_mul_f32_e64 v240, v240, v249
v_accvgpr_write_b32 a8, v240
v_accvgpr_read_b32 v241, a9
v_mul_f32_e64 v241, v241, v249
v_accvgpr_write_b32 a9, v241
v_accvgpr_read_b32 v242, a10
v_mul_f32_e64 v242, v242, v249
v_accvgpr_write_b32 a10, v242
v_accvgpr_read_b32 v243, a11
v_mul_f32_e64 v243, v243, v249
v_accvgpr_write_b32 a11, v243
v_accvgpr_read_b32 v240, a12
v_mul_f32_e64 v240, v240, v249
v_accvgpr_write_b32 a12, v240
v_accvgpr_read_b32 v241, a13
v_mul_f32_e64 v241, v241, v249
v_accvgpr_write_b32 a13, v241
v_accvgpr_read_b32 v242, a14
v_mul_f32_e64 v242, v242, v249
v_accvgpr_write_b32 a14, v242
v_accvgpr_read_b32 v243, a15
v_mul_f32_e64 v243, v243, v249
v_accvgpr_write_b32 a15, v243
v_accvgpr_read_b32 v240, a16
v_mul_f32_e64 v240, v240, v249
v_accvgpr_write_b32 a16, v240
v_accvgpr_read_b32 v241, a17
v_mul_f32_e64 v241, v241, v249
v_accvgpr_write_b32 a17, v241
v_accvgpr_read_b32 v242, a18
v_mul_f32_e64 v242, v242, v249
v_accvgpr_write_b32 a18, v242
v_accvgpr_read_b32 v243, a19
v_mul_f32_e64 v243, v243, v249
v_accvgpr_write_b32 a19, v243
v_accvgpr_read_b32 v240, a20
v_mul_f32_e64 v240, v240, v249
v_accvgpr_write_b32 a20, v240
v_accvgpr_read_b32 v241, a21
v_mul_f32_e64 v241, v241, v249
v_accvgpr_write_b32 a21, v241
v_accvgpr_read_b32 v242, a22
v_mul_f32_e64 v242, v242, v249
v_accvgpr_write_b32 a22, v242
v_accvgpr_read_b32 v243, a23
v_mul_f32_e64 v243, v243, v249
v_accvgpr_write_b32 a23, v243
v_accvgpr_read_b32 v240, a24
v_mul_f32_e64 v240, v240, v249
v_accvgpr_write_b32 a24, v240
v_accvgpr_read_b32 v241, a25
v_mul_f32_e64 v241, v241, v249
v_accvgpr_write_b32 a25, v241
v_accvgpr_read_b32 v242, a26
v_mul_f32_e64 v242, v242, v249
v_accvgpr_write_b32 a26, v242
v_accvgpr_read_b32 v243, a27
v_mul_f32_e64 v243, v243, v249
v_accvgpr_write_b32 a27, v243
v_accvgpr_read_b32 v240, a28
v_mul_f32_e64 v240, v240, v249
v_accvgpr_write_b32 a28, v240
v_accvgpr_read_b32 v241, a29
v_mul_f32_e64 v241, v241, v249
v_accvgpr_write_b32 a29, v241
v_accvgpr_read_b32 v242, a30
v_mul_f32_e64 v242, v242, v249
v_accvgpr_write_b32 a30, v242
v_accvgpr_read_b32 v243, a31
v_mul_f32_e64 v243, v243, v249
v_accvgpr_write_b32 a31, v243
v_accvgpr_read_b32 v240, a32
v_mul_f32_e64 v240, v240, v249
v_accvgpr_write_b32 a32, v240
v_accvgpr_read_b32 v241, a33
v_mul_f32_e64 v241, v241, v249
v_accvgpr_write_b32 a33, v241
v_accvgpr_read_b32 v242, a34
v_mul_f32_e64 v242, v242, v249
v_accvgpr_write_b32 a34, v242
v_accvgpr_read_b32 v243, a35
v_mul_f32_e64 v243, v243, v249
v_accvgpr_write_b32 a35, v243
v_accvgpr_read_b32 v240, a36
v_mul_f32_e64 v240, v240, v249
v_accvgpr_write_b32 a36, v240
v_accvgpr_read_b32 v241, a37
v_mul_f32_e64 v241, v241, v249
v_accvgpr_write_b32 a37, v241
v_accvgpr_read_b32 v242, a38
v_mul_f32_e64 v242, v242, v249
v_accvgpr_write_b32 a38, v242
v_accvgpr_read_b32 v243, a39
v_mul_f32_e64 v243, v243, v249
v_accvgpr_write_b32 a39, v243
v_accvgpr_read_b32 v240, a40
v_mul_f32_e64 v240, v240, v249
v_accvgpr_write_b32 a40, v240
v_accvgpr_read_b32 v241, a41
v_mul_f32_e64 v241, v241, v249
v_accvgpr_write_b32 a41, v241
v_accvgpr_read_b32 v242, a42
v_mul_f32_e64 v242, v242, v249
v_accvgpr_write_b32 a42, v242
v_accvgpr_read_b32 v243, a43
v_mul_f32_e64 v243, v243, v249
v_accvgpr_write_b32 a43, v243
v_accvgpr_read_b32 v240, a44
v_mul_f32_e64 v240, v240, v249
v_accvgpr_write_b32 a44, v240
v_accvgpr_read_b32 v241, a45
v_mul_f32_e64 v241, v241, v249
v_accvgpr_write_b32 a45, v241
v_accvgpr_read_b32 v242, a46
v_mul_f32_e64 v242, v242, v249
v_accvgpr_write_b32 a46, v242
v_accvgpr_read_b32 v243, a47
v_mul_f32_e64 v243, v243, v249
v_accvgpr_write_b32 a47, v243
v_accvgpr_read_b32 v240, a48
v_mul_f32_e64 v240, v240, v249
v_accvgpr_write_b32 a48, v240
v_accvgpr_read_b32 v241, a49
v_mul_f32_e64 v241, v241, v249
v_accvgpr_write_b32 a49, v241
v_accvgpr_read_b32 v242, a50
v_mul_f32_e64 v242, v242, v249
v_accvgpr_write_b32 a50, v242
v_accvgpr_read_b32 v243, a51
v_mul_f32_e64 v243, v243, v249
v_accvgpr_write_b32 a51, v243
v_accvgpr_read_b32 v240, a52
v_mul_f32_e64 v240, v240, v249
v_accvgpr_write_b32 a52, v240
v_accvgpr_read_b32 v241, a53
v_mul_f32_e64 v241, v241, v249
v_accvgpr_write_b32 a53, v241
v_accvgpr_read_b32 v242, a54
v_mul_f32_e64 v242, v242, v249
v_accvgpr_write_b32 a54, v242
v_accvgpr_read_b32 v243, a55
v_mul_f32_e64 v243, v243, v249
v_accvgpr_write_b32 a55, v243
v_accvgpr_read_b32 v240, a56
v_mul_f32_e64 v240, v240, v249
v_accvgpr_write_b32 a56, v240
v_accvgpr_read_b32 v241, a57
v_mul_f32_e64 v241, v241, v249
v_accvgpr_write_b32 a57, v241
v_accvgpr_read_b32 v242, a58
v_mul_f32_e64 v242, v242, v249
v_accvgpr_write_b32 a58, v242
v_accvgpr_read_b32 v243, a59
v_mul_f32_e64 v243, v243, v249
v_accvgpr_write_b32 a59, v243
v_accvgpr_read_b32 v240, a60
v_mul_f32_e64 v240, v240, v249
v_accvgpr_write_b32 a60, v240
v_accvgpr_read_b32 v241, a61
v_mul_f32_e64 v241, v241, v249
v_accvgpr_write_b32 a61, v241
v_accvgpr_read_b32 v242, a62
v_mul_f32_e64 v242, v242, v249
v_accvgpr_write_b32 a62, v242
v_accvgpr_read_b32 v243, a63
v_mul_f32_e64 v243, v243, v249
v_accvgpr_write_b32 a63, v243
v_accvgpr_read_b32 v240, a64
v_mul_f32_e64 v240, v240, v249
v_accvgpr_write_b32 a64, v240
v_accvgpr_read_b32 v241, a65
v_mul_f32_e64 v241, v241, v249
v_accvgpr_write_b32 a65, v241
v_accvgpr_read_b32 v242, a66
v_mul_f32_e64 v242, v242, v249
v_accvgpr_write_b32 a66, v242
v_accvgpr_read_b32 v243, a67
v_mul_f32_e64 v243, v243, v249
v_accvgpr_write_b32 a67, v243
v_accvgpr_read_b32 v240, a68
v_mul_f32_e64 v240, v240, v249
v_accvgpr_write_b32 a68, v240
v_accvgpr_read_b32 v241, a69
v_mul_f32_e64 v241, v241, v249
v_accvgpr_write_b32 a69, v241
v_accvgpr_read_b32 v242, a70
v_mul_f32_e64 v242, v242, v249
v_accvgpr_write_b32 a70, v242
v_accvgpr_read_b32 v243, a71
v_mul_f32_e64 v243, v243, v249
v_accvgpr_write_b32 a71, v243
v_accvgpr_read_b32 v240, a72
v_mul_f32_e64 v240, v240, v249
v_accvgpr_write_b32 a72, v240
v_accvgpr_read_b32 v241, a73
v_mul_f32_e64 v241, v241, v249
v_accvgpr_write_b32 a73, v241
v_accvgpr_read_b32 v242, a74
v_mul_f32_e64 v242, v242, v249
v_accvgpr_write_b32 a74, v242
v_accvgpr_read_b32 v243, a75
v_mul_f32_e64 v243, v243, v249
v_accvgpr_write_b32 a75, v243
v_accvgpr_read_b32 v240, a76
v_mul_f32_e64 v240, v240, v249
v_accvgpr_write_b32 a76, v240
v_accvgpr_read_b32 v241, a77
v_mul_f32_e64 v241, v241, v249
v_accvgpr_write_b32 a77, v241
v_accvgpr_read_b32 v242, a78
v_mul_f32_e64 v242, v242, v249
v_accvgpr_write_b32 a78, v242
v_accvgpr_read_b32 v243, a79
v_mul_f32_e64 v243, v243, v249
v_accvgpr_write_b32 a79, v243
v_accvgpr_read_b32 v240, a80
v_mul_f32_e64 v240, v240, v249
v_accvgpr_write_b32 a80, v240
v_accvgpr_read_b32 v241, a81
v_mul_f32_e64 v241, v241, v249
v_accvgpr_write_b32 a81, v241
v_accvgpr_read_b32 v242, a82
v_mul_f32_e64 v242, v242, v249
v_accvgpr_write_b32 a82, v242
v_accvgpr_read_b32 v243, a83
v_mul_f32_e64 v243, v243, v249
v_accvgpr_write_b32 a83, v243
v_accvgpr_read_b32 v240, a84
v_mul_f32_e64 v240, v240, v249
v_accvgpr_write_b32 a84, v240
v_accvgpr_read_b32 v241, a85
v_mul_f32_e64 v241, v241, v249
v_accvgpr_write_b32 a85, v241
v_accvgpr_read_b32 v242, a86
v_mul_f32_e64 v242, v242, v249
v_accvgpr_write_b32 a86, v242
v_accvgpr_read_b32 v243, a87
v_mul_f32_e64 v243, v243, v249
v_accvgpr_write_b32 a87, v243
v_accvgpr_read_b32 v240, a88
v_mul_f32_e64 v240, v240, v249
v_accvgpr_write_b32 a88, v240
v_accvgpr_read_b32 v241, a89
v_mul_f32_e64 v241, v241, v249
v_accvgpr_write_b32 a89, v241
v_accvgpr_read_b32 v242, a90
v_mul_f32_e64 v242, v242, v249
v_accvgpr_write_b32 a90, v242
v_accvgpr_read_b32 v243, a91
v_mul_f32_e64 v243, v243, v249
v_accvgpr_write_b32 a91, v243
v_accvgpr_read_b32 v240, a92
v_mul_f32_e64 v240, v240, v249
v_accvgpr_write_b32 a92, v240
v_accvgpr_read_b32 v241, a93
v_mul_f32_e64 v241, v241, v249
v_accvgpr_write_b32 a93, v241
v_accvgpr_read_b32 v242, a94
v_mul_f32_e64 v242, v242, v249
v_accvgpr_write_b32 a94, v242
v_accvgpr_read_b32 v243, a95
v_mul_f32_e64 v243, v243, v249
v_accvgpr_write_b32 a95, v243
v_accvgpr_read_b32 v240, a96
v_mul_f32_e64 v240, v240, v249
v_accvgpr_write_b32 a96, v240
v_accvgpr_read_b32 v241, a97
v_mul_f32_e64 v241, v241, v249
v_accvgpr_write_b32 a97, v241
v_accvgpr_read_b32 v242, a98
v_mul_f32_e64 v242, v242, v249
v_accvgpr_write_b32 a98, v242
v_accvgpr_read_b32 v243, a99
v_mul_f32_e64 v243, v243, v249
v_accvgpr_write_b32 a99, v243
v_accvgpr_read_b32 v240, a100
v_mul_f32_e64 v240, v240, v249
v_accvgpr_write_b32 a100, v240
v_accvgpr_read_b32 v241, a101
v_mul_f32_e64 v241, v241, v249
v_accvgpr_write_b32 a101, v241
v_accvgpr_read_b32 v242, a102
v_mul_f32_e64 v242, v242, v249
v_accvgpr_write_b32 a102, v242
v_accvgpr_read_b32 v243, a103
v_mul_f32_e64 v243, v243, v249
v_accvgpr_write_b32 a103, v243
v_accvgpr_read_b32 v240, a104
v_mul_f32_e64 v240, v240, v249
v_accvgpr_write_b32 a104, v240
v_accvgpr_read_b32 v241, a105
v_mul_f32_e64 v241, v241, v249
v_accvgpr_write_b32 a105, v241
v_accvgpr_read_b32 v242, a106
v_mul_f32_e64 v242, v242, v249
v_accvgpr_write_b32 a106, v242
v_accvgpr_read_b32 v243, a107
v_mul_f32_e64 v243, v243, v249
v_accvgpr_write_b32 a107, v243
v_accvgpr_read_b32 v240, a108
v_mul_f32_e64 v240, v240, v249
v_accvgpr_write_b32 a108, v240
v_accvgpr_read_b32 v241, a109
v_mul_f32_e64 v241, v241, v249
v_accvgpr_write_b32 a109, v241
v_accvgpr_read_b32 v242, a110
v_mul_f32_e64 v242, v242, v249
v_accvgpr_write_b32 a110, v242
v_accvgpr_read_b32 v243, a111
v_mul_f32_e64 v243, v243, v249
v_accvgpr_write_b32 a111, v243
v_accvgpr_read_b32 v240, a112
v_mul_f32_e64 v240, v240, v249
v_accvgpr_write_b32 a112, v240
v_accvgpr_read_b32 v241, a113
v_mul_f32_e64 v241, v241, v249
v_accvgpr_write_b32 a113, v241
v_accvgpr_read_b32 v242, a114
v_mul_f32_e64 v242, v242, v249
v_accvgpr_write_b32 a114, v242
v_accvgpr_read_b32 v243, a115
v_mul_f32_e64 v243, v243, v249
v_accvgpr_write_b32 a115, v243
v_accvgpr_read_b32 v240, a116
v_mul_f32_e64 v240, v240, v249
v_accvgpr_write_b32 a116, v240
v_accvgpr_read_b32 v241, a117
v_mul_f32_e64 v241, v241, v249
v_accvgpr_write_b32 a117, v241
v_accvgpr_read_b32 v242, a118
v_mul_f32_e64 v242, v242, v249
v_accvgpr_write_b32 a118, v242
v_accvgpr_read_b32 v243, a119
v_mul_f32_e64 v243, v243, v249
v_accvgpr_write_b32 a119, v243
v_accvgpr_read_b32 v240, a120
v_mul_f32_e64 v240, v240, v249
v_accvgpr_write_b32 a120, v240
v_accvgpr_read_b32 v241, a121
v_mul_f32_e64 v241, v241, v249
v_accvgpr_write_b32 a121, v241
v_accvgpr_read_b32 v242, a122
v_mul_f32_e64 v242, v242, v249
v_accvgpr_write_b32 a122, v242
v_accvgpr_read_b32 v243, a123
v_mul_f32_e64 v243, v243, v249
v_accvgpr_write_b32 a123, v243
v_accvgpr_read_b32 v240, a124
v_mul_f32_e64 v240, v240, v249
v_accvgpr_write_b32 a124, v240
v_accvgpr_read_b32 v241, a125
v_mul_f32_e64 v241, v241, v249
v_accvgpr_write_b32 a125, v241
v_accvgpr_read_b32 v242, a126
v_mul_f32_e64 v242, v242, v249
v_accvgpr_write_b32 a126, v242
v_accvgpr_read_b32 v243, a127
v_mul_f32_e64 v243, v243, v249
v_accvgpr_write_b32 a127, v243
v_mov_b32 v31, 0
v_exp_f32 v240, v96
v_exp_f32 v241, v97
v_add_f32 v31, v31, v240
v_add_f32_e64 v31, v31, v241
v_cvt_pk_bf16_f32 v128, v240, v241
v_exp_f32 v242, v98
v_exp_f32 v243, v99
v_add_f32 v31, v31, v242
v_add_f32 v31, v31, v243
v_cvt_pk_bf16_f32 v129, v242, v243
v_exp_f32 v240, v100
v_exp_f32 v241, v101
v_add_f32 v31, v31, v240
v_add_f32 v31, v31, v241
v_cvt_pk_bf16_f32 v130, v240, v241
v_exp_f32 v242, v102
v_exp_f32 v243, v103
v_add_f32 v31, v31, v242
v_add_f32 v31, v31, v243
v_cvt_pk_bf16_f32 v131, v242, v243
v_exp_f32 v240, v104
v_exp_f32 v241, v105
v_add_f32 v31, v31, v240
v_add_f32 v31, v31, v241
v_cvt_pk_bf16_f32 v132, v240, v241
v_exp_f32 v242, v106
v_exp_f32 v243, v107
v_add_f32 v31, v31, v242
v_add_f32 v31, v31, v243
v_cvt_pk_bf16_f32 v133, v242, v243
v_exp_f32 v240, v108
v_exp_f32 v241, v109
v_add_f32 v31, v31, v240
v_add_f32 v31, v31, v241
v_cvt_pk_bf16_f32 v134, v240, v241
v_exp_f32 v242, v110
v_exp_f32 v243, v111
v_add_f32 v31, v31, v242
v_add_f32 v31, v31, v243
v_cvt_pk_bf16_f32 v135, v242, v243
v_exp_f32 v240, v112
v_exp_f32 v241, v113
v_add_f32 v31, v31, v240
v_add_f32 v31, v31, v241
v_cvt_pk_bf16_f32 v136, v240, v241
v_exp_f32 v242, v114
v_exp_f32 v243, v115
v_add_f32 v31, v31, v242
v_add_f32 v31, v31, v243
v_cvt_pk_bf16_f32 v137, v242, v243
v_exp_f32 v240, v116
v_exp_f32 v241, v117
v_add_f32 v31, v31, v240
v_add_f32 v31, v31, v241
v_cvt_pk_bf16_f32 v138, v240, v241
v_exp_f32 v242, v118
v_exp_f32 v243, v119
v_add_f32 v31, v31, v242
v_add_f32 v31, v31, v243
v_cvt_pk_bf16_f32 v139, v242, v243
v_exp_f32 v240, v120
v_exp_f32 v241, v121
v_add_f32 v31, v31, v240
v_add_f32 v31, v31, v241
v_cvt_pk_bf16_f32 v140, v240, v241
v_exp_f32 v242, v122
v_exp_f32 v243, v123
v_add_f32 v31, v31, v242
v_add_f32 v31, v31, v243
v_cvt_pk_bf16_f32 v141, v242, v243
v_exp_f32 v240, v124
v_exp_f32 v241, v125
v_add_f32 v31, v31, v240
v_add_f32 v31, v31, v241
v_cvt_pk_bf16_f32 v142, v240, v241
v_exp_f32 v242, v126
v_exp_f32 v243, v127
v_add_f32 v31, v31, v242
v_add_f32 v31, v31, v243
v_cvt_pk_bf16_f32 v143, v242, v243
s_nop 7
s_setpc_b64 s[100:101]
recurrent_scan__sliding_block_cached__moe_arch_mod__prompt_kernel_rare1:
s_nop 7
s_nop 7
s_nop 7
v_max_f32 v248, v176, v177
v_max3_f32 v248, v248, v178, v179
v_max3_f32 v248, v248, v180, v181
v_max3_f32 v248, v248, v182, v183
v_max3_f32 v248, v248, v184, v185
v_max3_f32 v248, v248, v186, v187
v_max3_f32 v248, v248, v188, v189
v_max3_f32 v248, v248, v190, v191
v_max3_f32 v248, v248, v192, v193
v_max3_f32 v248, v248, v194, v195
v_max3_f32 v248, v248, v196, v197
v_max3_f32 v248, v248, v198, v199
v_max3_f32 v248, v248, v200, v201
v_max3_f32 v248, v248, v202, v203
v_max3_f32 v248, v248, v204, v205
v_max3_f32 v248, v248, v206, v207
v_mov_b32 v249, v248
s_nop 1
v_permlane32_swap_b32 v248, v249
v_max_f32 v248, v248, v249
v_max_f32 v248, vcc_lo, v248
v_sub_f32 v249, 0, v248
v_min_f32 v249, 0, v249
v_exp_f32 v249, v249
v_sub_f32 v176, v176, v248
v_sub_f32 v177, v177, v248
v_sub_f32 v178, v178, v248
v_sub_f32 v179, v179, v248
v_sub_f32 v180, v180, v248
v_sub_f32 v181, v181, v248
v_sub_f32 v182, v182, v248
v_sub_f32 v183, v183, v248
v_sub_f32 v184, v184, v248
v_sub_f32 v185, v185, v248
v_sub_f32 v186, v186, v248
v_sub_f32 v187, v187, v248
v_sub_f32 v188, v188, v248
v_sub_f32 v189, v189, v248
v_sub_f32 v190, v190, v248
v_sub_f32 v191, v191, v248
v_sub_f32 v192, v192, v248
v_sub_f32 v193, v193, v248
v_sub_f32 v194, v194, v248
v_sub_f32 v195, v195, v248
v_sub_f32 v196, v196, v248
v_sub_f32 v197, v197, v248
v_sub_f32 v198, v198, v248
v_sub_f32 v199, v199, v248
v_sub_f32 v200, v200, v248
v_sub_f32 v201, v201, v248
v_sub_f32 v202, v202, v248
v_sub_f32 v203, v203, v248
v_sub_f32 v204, v204, v248
v_sub_f32 v205, v205, v248
v_sub_f32 v206, v206, v248
v_sub_f32 v207, v207, v248
s_cmp_lg_u32 vcc_hi, 0
s_cbranch_scc1 recurrent_scan__sliding_block_cached__moe_arch_mod__prompt_kernel_rskip
v_sub_f32 v96, v96, v248
v_sub_f32 v97, v97, v248
v_sub_f32 v98, v98, v248
v_sub_f32 v99, v99, v248
v_sub_f32 v100, v100, v248
v_sub_f32 v101, v101, v248
v_sub_f32 v102, v102, v248
v_sub_f32 v103, v103, v248
v_sub_f32 v104, v104, v248
v_sub_f32 v105, v105, v248
v_sub_f32 v106, v106, v248
v_sub_f32 v107, v107, v248
v_sub_f32 v108, v108, v248
v_sub_f32 v109, v109, v248
v_sub_f32 v110, v110, v248
v_sub_f32 v111, v111, v248
v_sub_f32 v112, v112, v248
v_sub_f32 v113, v113, v248
v_sub_f32 v114, v114, v248
v_sub_f32 v115, v115, v248
v_sub_f32 v116, v116, v248
v_sub_f32 v117, v117, v248
v_sub_f32 v118, v118, v248
v_sub_f32 v119, v119, v248
v_sub_f32 v120, v120, v248
v_sub_f32 v121, v121, v248
v_sub_f32 v122, v122, v248
v_sub_f32 v123, v123, v248
v_sub_f32 v124, v124, v248
v_sub_f32 v125, v125, v248
v_sub_f32 v126, v126, v248
v_sub_f32 v127, v127, v248
v_sub_f32 v208, v208, v248
v_sub_f32 v209, v209, v248
v_sub_f32 v210, v210, v248
v_sub_f32 v211, v211, v248
v_sub_f32 v212, v212, v248
v_sub_f32 v213, v213, v248
v_sub_f32 v214, v214, v248
v_sub_f32 v215, v215, v248
v_sub_f32 v216, v216, v248
v_sub_f32 v217, v217, v248
v_sub_f32 v218, v218, v248
v_sub_f32 v219, v219, v248
v_sub_f32 v220, v220, v248
v_sub_f32 v221, v221, v248
v_sub_f32 v222, v222, v248
v_sub_f32 v223, v223, v248
recurrent_scan__sliding_block_cached__moe_arch_mod__prompt_kernel_rskip:
v_mul_f32_e64 v30, v30, v249
v_accvgpr_read_b32 v240, a0
v_mul_f32_e64 v240, v240, v249
v_accvgpr_write_b32 a0, v240
v_accvgpr_read_b32 v241, a1
v_mul_f32_e64 v241, v241, v249
v_accvgpr_write_b32 a1, v241
v_accvgpr_read_b32 v242, a2
v_mul_f32_e64 v242, v242, v249
v_accvgpr_write_b32 a2, v242
v_accvgpr_read_b32 v243, a3
v_mul_f32_e64 v243, v243, v249
v_accvgpr_write_b32 a3, v243
v_accvgpr_read_b32 v240, a4
v_mul_f32_e64 v240, v240, v249
v_accvgpr_write_b32 a4, v240
v_accvgpr_read_b32 v241, a5
v_mul_f32_e64 v241, v241, v249
v_accvgpr_write_b32 a5, v241
v_accvgpr_read_b32 v242, a6
v_mul_f32_e64 v242, v242, v249
v_accvgpr_write_b32 a6, v242
v_accvgpr_read_b32 v243, a7
v_mul_f32_e64 v243, v243, v249
v_accvgpr_write_b32 a7, v243
v_accvgpr_read_b32 v240, a8
v_mul_f32_e64 v240, v240, v249
v_accvgpr_write_b32 a8, v240
v_accvgpr_read_b32 v241, a9
v_mul_f32_e64 v241, v241, v249
v_accvgpr_write_b32 a9, v241
v_accvgpr_read_b32 v242, a10
v_mul_f32_e64 v242, v242, v249
v_accvgpr_write_b32 a10, v242
v_accvgpr_read_b32 v243, a11
v_mul_f32_e64 v243, v243, v249
v_accvgpr_write_b32 a11, v243
v_accvgpr_read_b32 v240, a12
v_mul_f32_e64 v240, v240, v249
v_accvgpr_write_b32 a12, v240
v_accvgpr_read_b32 v241, a13
v_mul_f32_e64 v241, v241, v249
v_accvgpr_write_b32 a13, v241
v_accvgpr_read_b32 v242, a14
v_mul_f32_e64 v242, v242, v249
v_accvgpr_write_b32 a14, v242
v_accvgpr_read_b32 v243, a15
v_mul_f32_e64 v243, v243, v249
v_accvgpr_write_b32 a15, v243
v_accvgpr_read_b32 v240, a16
v_mul_f32_e64 v240, v240, v249
v_accvgpr_write_b32 a16, v240
v_accvgpr_read_b32 v241, a17
v_mul_f32_e64 v241, v241, v249
v_accvgpr_write_b32 a17, v241
v_accvgpr_read_b32 v242, a18
v_mul_f32_e64 v242, v242, v249
v_accvgpr_write_b32 a18, v242
v_accvgpr_read_b32 v243, a19
v_mul_f32_e64 v243, v243, v249
v_accvgpr_write_b32 a19, v243
v_accvgpr_read_b32 v240, a20
v_mul_f32_e64 v240, v240, v249
v_accvgpr_write_b32 a20, v240
v_accvgpr_read_b32 v241, a21
v_mul_f32_e64 v241, v241, v249
v_accvgpr_write_b32 a21, v241
v_accvgpr_read_b32 v242, a22
v_mul_f32_e64 v242, v242, v249
v_accvgpr_write_b32 a22, v242
v_accvgpr_read_b32 v243, a23
v_mul_f32_e64 v243, v243, v249
v_accvgpr_write_b32 a23, v243
v_accvgpr_read_b32 v240, a24
v_mul_f32_e64 v240, v240, v249
v_accvgpr_write_b32 a24, v240
v_accvgpr_read_b32 v241, a25
v_mul_f32_e64 v241, v241, v249
v_accvgpr_write_b32 a25, v241
v_accvgpr_read_b32 v242, a26
v_mul_f32_e64 v242, v242, v249
v_accvgpr_write_b32 a26, v242
v_accvgpr_read_b32 v243, a27
v_mul_f32_e64 v243, v243, v249
v_accvgpr_write_b32 a27, v243
v_accvgpr_read_b32 v240, a28
v_mul_f32_e64 v240, v240, v249
v_accvgpr_write_b32 a28, v240
v_accvgpr_read_b32 v241, a29
v_mul_f32_e64 v241, v241, v249
v_accvgpr_write_b32 a29, v241
v_accvgpr_read_b32 v242, a30
v_mul_f32_e64 v242, v242, v249
v_accvgpr_write_b32 a30, v242
v_accvgpr_read_b32 v243, a31
v_mul_f32_e64 v243, v243, v249
v_accvgpr_write_b32 a31, v243
v_accvgpr_read_b32 v240, a32
v_mul_f32_e64 v240, v240, v249
v_accvgpr_write_b32 a32, v240
v_accvgpr_read_b32 v241, a33
v_mul_f32_e64 v241, v241, v249
v_accvgpr_write_b32 a33, v241
v_accvgpr_read_b32 v242, a34
v_mul_f32_e64 v242, v242, v249
v_accvgpr_write_b32 a34, v242
v_accvgpr_read_b32 v243, a35
v_mul_f32_e64 v243, v243, v249
v_accvgpr_write_b32 a35, v243
v_accvgpr_read_b32 v240, a36
v_mul_f32_e64 v240, v240, v249
v_accvgpr_write_b32 a36, v240
v_accvgpr_read_b32 v241, a37
v_mul_f32_e64 v241, v241, v249
v_accvgpr_write_b32 a37, v241
v_accvgpr_read_b32 v242, a38
v_mul_f32_e64 v242, v242, v249
v_accvgpr_write_b32 a38, v242
v_accvgpr_read_b32 v243, a39
v_mul_f32_e64 v243, v243, v249
v_accvgpr_write_b32 a39, v243
v_accvgpr_read_b32 v240, a40
v_mul_f32_e64 v240, v240, v249
v_accvgpr_write_b32 a40, v240
v_accvgpr_read_b32 v241, a41
v_mul_f32_e64 v241, v241, v249
v_accvgpr_write_b32 a41, v241
v_accvgpr_read_b32 v242, a42
v_mul_f32_e64 v242, v242, v249
v_accvgpr_write_b32 a42, v242
v_accvgpr_read_b32 v243, a43
v_mul_f32_e64 v243, v243, v249
v_accvgpr_write_b32 a43, v243
v_accvgpr_read_b32 v240, a44
v_mul_f32_e64 v240, v240, v249
v_accvgpr_write_b32 a44, v240
v_accvgpr_read_b32 v241, a45
v_mul_f32_e64 v241, v241, v249
v_accvgpr_write_b32 a45, v241
v_accvgpr_read_b32 v242, a46
v_mul_f32_e64 v242, v242, v249
v_accvgpr_write_b32 a46, v242
v_accvgpr_read_b32 v243, a47
v_mul_f32_e64 v243, v243, v249
v_accvgpr_write_b32 a47, v243
v_accvgpr_read_b32 v240, a48
v_mul_f32_e64 v240, v240, v249
v_accvgpr_write_b32 a48, v240
v_accvgpr_read_b32 v241, a49
v_mul_f32_e64 v241, v241, v249
v_accvgpr_write_b32 a49, v241
v_accvgpr_read_b32 v242, a50
v_mul_f32_e64 v242, v242, v249
v_accvgpr_write_b32 a50, v242
v_accvgpr_read_b32 v243, a51
v_mul_f32_e64 v243, v243, v249
v_accvgpr_write_b32 a51, v243
v_accvgpr_read_b32 v240, a52
v_mul_f32_e64 v240, v240, v249
v_accvgpr_write_b32 a52, v240
v_accvgpr_read_b32 v241, a53
v_mul_f32_e64 v241, v241, v249
v_accvgpr_write_b32 a53, v241
v_accvgpr_read_b32 v242, a54
v_mul_f32_e64 v242, v242, v249
v_accvgpr_write_b32 a54, v242
v_accvgpr_read_b32 v243, a55
v_mul_f32_e64 v243, v243, v249
v_accvgpr_write_b32 a55, v243
v_accvgpr_read_b32 v240, a56
v_mul_f32_e64 v240, v240, v249
v_accvgpr_write_b32 a56, v240
v_accvgpr_read_b32 v241, a57
v_mul_f32_e64 v241, v241, v249
v_accvgpr_write_b32 a57, v241
v_accvgpr_read_b32 v242, a58
v_mul_f32_e64 v242, v242, v249
v_accvgpr_write_b32 a58, v242
v_accvgpr_read_b32 v243, a59
v_mul_f32_e64 v243, v243, v249
v_accvgpr_write_b32 a59, v243
v_accvgpr_read_b32 v240, a60
v_mul_f32_e64 v240, v240, v249
v_accvgpr_write_b32 a60, v240
v_accvgpr_read_b32 v241, a61
v_mul_f32_e64 v241, v241, v249
v_accvgpr_write_b32 a61, v241
v_accvgpr_read_b32 v242, a62
v_mul_f32_e64 v242, v242, v249
v_accvgpr_write_b32 a62, v242
v_accvgpr_read_b32 v243, a63
v_mul_f32_e64 v243, v243, v249
v_accvgpr_write_b32 a63, v243
v_accvgpr_read_b32 v240, a64
v_mul_f32_e64 v240, v240, v249
v_accvgpr_write_b32 a64, v240
v_accvgpr_read_b32 v241, a65
v_mul_f32_e64 v241, v241, v249
v_accvgpr_write_b32 a65, v241
v_accvgpr_read_b32 v242, a66
v_mul_f32_e64 v242, v242, v249
v_accvgpr_write_b32 a66, v242
v_accvgpr_read_b32 v243, a67
v_mul_f32_e64 v243, v243, v249
v_accvgpr_write_b32 a67, v243
v_accvgpr_read_b32 v240, a68
v_mul_f32_e64 v240, v240, v249
v_accvgpr_write_b32 a68, v240
v_accvgpr_read_b32 v241, a69
v_mul_f32_e64 v241, v241, v249
v_accvgpr_write_b32 a69, v241
v_accvgpr_read_b32 v242, a70
v_mul_f32_e64 v242, v242, v249
v_accvgpr_write_b32 a70, v242
v_accvgpr_read_b32 v243, a71
v_mul_f32_e64 v243, v243, v249
v_accvgpr_write_b32 a71, v243
v_accvgpr_read_b32 v240, a72
v_mul_f32_e64 v240, v240, v249
v_accvgpr_write_b32 a72, v240
v_accvgpr_read_b32 v241, a73
v_mul_f32_e64 v241, v241, v249
v_accvgpr_write_b32 a73, v241
v_accvgpr_read_b32 v242, a74
v_mul_f32_e64 v242, v242, v249
v_accvgpr_write_b32 a74, v242
v_accvgpr_read_b32 v243, a75
v_mul_f32_e64 v243, v243, v249
v_accvgpr_write_b32 a75, v243
v_accvgpr_read_b32 v240, a76
v_mul_f32_e64 v240, v240, v249
v_accvgpr_write_b32 a76, v240
v_accvgpr_read_b32 v241, a77
v_mul_f32_e64 v241, v241, v249
v_accvgpr_write_b32 a77, v241
v_accvgpr_read_b32 v242, a78
v_mul_f32_e64 v242, v242, v249
v_accvgpr_write_b32 a78, v242
v_accvgpr_read_b32 v243, a79
v_mul_f32_e64 v243, v243, v249
v_accvgpr_write_b32 a79, v243
v_accvgpr_read_b32 v240, a80
v_mul_f32_e64 v240, v240, v249
v_accvgpr_write_b32 a80, v240
v_accvgpr_read_b32 v241, a81
v_mul_f32_e64 v241, v241, v249
v_accvgpr_write_b32 a81, v241
v_accvgpr_read_b32 v242, a82
v_mul_f32_e64 v242, v242, v249
v_accvgpr_write_b32 a82, v242
v_accvgpr_read_b32 v243, a83
v_mul_f32_e64 v243, v243, v249
v_accvgpr_write_b32 a83, v243
v_accvgpr_read_b32 v240, a84
v_mul_f32_e64 v240, v240, v249
v_accvgpr_write_b32 a84, v240
v_accvgpr_read_b32 v241, a85
v_mul_f32_e64 v241, v241, v249
v_accvgpr_write_b32 a85, v241
v_accvgpr_read_b32 v242, a86
v_mul_f32_e64 v242, v242, v249
v_accvgpr_write_b32 a86, v242
v_accvgpr_read_b32 v243, a87
v_mul_f32_e64 v243, v243, v249
v_accvgpr_write_b32 a87, v243
v_accvgpr_read_b32 v240, a88
v_mul_f32_e64 v240, v240, v249
v_accvgpr_write_b32 a88, v240
v_accvgpr_read_b32 v241, a89
v_mul_f32_e64 v241, v241, v249
v_accvgpr_write_b32 a89, v241
v_accvgpr_read_b32 v242, a90
v_mul_f32_e64 v242, v242, v249
v_accvgpr_write_b32 a90, v242
v_accvgpr_read_b32 v243, a91
v_mul_f32_e64 v243, v243, v249
v_accvgpr_write_b32 a91, v243
v_accvgpr_read_b32 v240, a92
v_mul_f32_e64 v240, v240, v249
v_accvgpr_write_b32 a92, v240
v_accvgpr_read_b32 v241, a93
v_mul_f32_e64 v241, v241, v249
v_accvgpr_write_b32 a93, v241
v_accvgpr_read_b32 v242, a94
v_mul_f32_e64 v242, v242, v249
v_accvgpr_write_b32 a94, v242
v_accvgpr_read_b32 v243, a95
v_mul_f32_e64 v243, v243, v249
v_accvgpr_write_b32 a95, v243
v_accvgpr_read_b32 v240, a96
v_mul_f32_e64 v240, v240, v249
v_accvgpr_write_b32 a96, v240
v_accvgpr_read_b32 v241, a97
v_mul_f32_e64 v241, v241, v249
v_accvgpr_write_b32 a97, v241
v_accvgpr_read_b32 v242, a98
v_mul_f32_e64 v242, v242, v249
v_accvgpr_write_b32 a98, v242
v_accvgpr_read_b32 v243, a99
v_mul_f32_e64 v243, v243, v249
v_accvgpr_write_b32 a99, v243
v_accvgpr_read_b32 v240, a100
v_mul_f32_e64 v240, v240, v249
v_accvgpr_write_b32 a100, v240
v_accvgpr_read_b32 v241, a101
v_mul_f32_e64 v241, v241, v249
v_accvgpr_write_b32 a101, v241
v_accvgpr_read_b32 v242, a102
v_mul_f32_e64 v242, v242, v249
v_accvgpr_write_b32 a102, v242
v_accvgpr_read_b32 v243, a103
v_mul_f32_e64 v243, v243, v249
v_accvgpr_write_b32 a103, v243
v_accvgpr_read_b32 v240, a104
v_mul_f32_e64 v240, v240, v249
v_accvgpr_write_b32 a104, v240
v_accvgpr_read_b32 v241, a105
v_mul_f32_e64 v241, v241, v249
v_accvgpr_write_b32 a105, v241
v_accvgpr_read_b32 v242, a106
v_mul_f32_e64 v242, v242, v249
v_accvgpr_write_b32 a106, v242
v_accvgpr_read_b32 v243, a107
v_mul_f32_e64 v243, v243, v249
v_accvgpr_write_b32 a107, v243
v_accvgpr_read_b32 v240, a108
v_mul_f32_e64 v240, v240, v249
v_accvgpr_write_b32 a108, v240
v_accvgpr_read_b32 v241, a109
v_mul_f32_e64 v241, v241, v249
v_accvgpr_write_b32 a109, v241
v_accvgpr_read_b32 v242, a110
v_mul_f32_e64 v242, v242, v249
v_accvgpr_write_b32 a110, v242
v_accvgpr_read_b32 v243, a111
v_mul_f32_e64 v243, v243, v249
v_accvgpr_write_b32 a111, v243
v_accvgpr_read_b32 v240, a112
v_mul_f32_e64 v240, v240, v249
v_accvgpr_write_b32 a112, v240
v_accvgpr_read_b32 v241, a113
v_mul_f32_e64 v241, v241, v249
v_accvgpr_write_b32 a113, v241
v_accvgpr_read_b32 v242, a114
v_mul_f32_e64 v242, v242, v249
v_accvgpr_write_b32 a114, v242
v_accvgpr_read_b32 v243, a115
v_mul_f32_e64 v243, v243, v249
v_accvgpr_write_b32 a115, v243
v_accvgpr_read_b32 v240, a116
v_mul_f32_e64 v240, v240, v249
v_accvgpr_write_b32 a116, v240
v_accvgpr_read_b32 v241, a117
v_mul_f32_e64 v241, v241, v249
v_accvgpr_write_b32 a117, v241
v_accvgpr_read_b32 v242, a118
v_mul_f32_e64 v242, v242, v249
v_accvgpr_write_b32 a118, v242
v_accvgpr_read_b32 v243, a119
v_mul_f32_e64 v243, v243, v249
v_accvgpr_write_b32 a119, v243
v_accvgpr_read_b32 v240, a120
v_mul_f32_e64 v240, v240, v249
v_accvgpr_write_b32 a120, v240
v_accvgpr_read_b32 v241, a121
v_mul_f32_e64 v241, v241, v249
v_accvgpr_write_b32 a121, v241
v_accvgpr_read_b32 v242, a122
v_mul_f32_e64 v242, v242, v249
v_accvgpr_write_b32 a122, v242
v_accvgpr_read_b32 v243, a123
v_mul_f32_e64 v243, v243, v249
v_accvgpr_write_b32 a123, v243
v_accvgpr_read_b32 v240, a124
v_mul_f32_e64 v240, v240, v249
v_accvgpr_write_b32 a124, v240
v_accvgpr_read_b32 v241, a125
v_mul_f32_e64 v241, v241, v249
v_accvgpr_write_b32 a125, v241
v_accvgpr_read_b32 v242, a126
v_mul_f32_e64 v242, v242, v249
v_accvgpr_write_b32 a126, v242
v_accvgpr_read_b32 v243, a127
v_mul_f32_e64 v243, v243, v249
v_accvgpr_write_b32 a127, v243
v_mov_b32 v31, 0
v_exp_f32 v240, v176
v_exp_f32 v241, v177
v_add_f32 v31, v31, v240
v_add_f32_e64 v31, v31, v241
v_cvt_pk_bf16_f32 v144, v240, v241
v_exp_f32 v242, v178
v_exp_f32 v243, v179
v_add_f32 v31, v31, v242
v_add_f32 v31, v31, v243
v_cvt_pk_bf16_f32 v145, v242, v243
v_exp_f32 v240, v180
v_exp_f32 v241, v181
v_add_f32 v31, v31, v240
v_add_f32 v31, v31, v241
v_cvt_pk_bf16_f32 v146, v240, v241
v_exp_f32 v242, v182
v_exp_f32 v243, v183
v_add_f32 v31, v31, v242
v_add_f32 v31, v31, v243
v_cvt_pk_bf16_f32 v147, v242, v243
v_exp_f32 v240, v184
v_exp_f32 v241, v185
v_add_f32 v31, v31, v240
v_add_f32 v31, v31, v241
v_cvt_pk_bf16_f32 v148, v240, v241
v_exp_f32 v242, v186
v_exp_f32 v243, v187
v_add_f32 v31, v31, v242
v_add_f32 v31, v31, v243
v_cvt_pk_bf16_f32 v149, v242, v243
v_exp_f32 v240, v188
v_exp_f32 v241, v189
v_add_f32 v31, v31, v240
v_add_f32 v31, v31, v241
v_cvt_pk_bf16_f32 v150, v240, v241
v_exp_f32 v242, v190
v_exp_f32 v243, v191
v_add_f32 v31, v31, v242
v_add_f32 v31, v31, v243
v_cvt_pk_bf16_f32 v151, v242, v243
v_exp_f32 v240, v192
v_exp_f32 v241, v193
v_add_f32 v31, v31, v240
v_add_f32 v31, v31, v241
v_cvt_pk_bf16_f32 v152, v240, v241
v_exp_f32 v242, v194
v_exp_f32 v243, v195
v_add_f32 v31, v31, v242
v_add_f32 v31, v31, v243
v_cvt_pk_bf16_f32 v153, v242, v243
v_exp_f32 v240, v196
v_exp_f32 v241, v197
v_add_f32 v31, v31, v240
v_add_f32 v31, v31, v241
v_cvt_pk_bf16_f32 v154, v240, v241
v_exp_f32 v242, v198
v_exp_f32 v243, v199
v_add_f32 v31, v31, v242
v_add_f32 v31, v31, v243
v_cvt_pk_bf16_f32 v155, v242, v243
v_exp_f32 v240, v200
v_exp_f32 v241, v201
v_add_f32 v31, v31, v240
v_add_f32 v31, v31, v241
v_cvt_pk_bf16_f32 v156, v240, v241
v_exp_f32 v242, v202
v_exp_f32 v243, v203
v_add_f32 v31, v31, v242
v_add_f32 v31, v31, v243
v_cvt_pk_bf16_f32 v157, v242, v243
v_exp_f32 v240, v204
v_exp_f32 v241, v205
v_add_f32 v31, v31, v240
v_add_f32 v31, v31, v241
v_cvt_pk_bf16_f32 v158, v240, v241
v_exp_f32 v242, v206
v_exp_f32 v243, v207
v_add_f32 v31, v31, v242
v_add_f32 v31, v31, v243
v_cvt_pk_bf16_f32 v159, v242, v243
s_nop 7
s_setpc_b64 s[100:101]
.p2align 8
.fill 4096, 4, 0xbf800000
.section .rodata,"a"

.p2align 6
.amdhsa_kernel recurrent_scan__sliding_block_cached__moe_arch_mod__prompt_kernel
  .amdhsa_next_free_vgpr 512
  .amdhsa_next_free_sgpr 102
  .amdhsa_accum_offset 256
  .amdhsa_group_segment_fixed_size 0
  .amdhsa_kernarg_size 104
  .amdhsa_user_sgpr_count 2
  .amdhsa_user_sgpr_kernarg_segment_ptr 1
  .amdhsa_system_sgpr_workgroup_id_x 1
.end_amdhsa_kernel
```
